```python
import torch

def _softmax(x, axis=-1):
    return torch.softmax(x, dim=axis)
def _gelu(x):
    return torch.nn.functional.gelu(x, approximate="tanh")
def _silu(x):
    return torch.nn.functional.silu(x)
def _sigmoid(x):
    return torch.sigmoid(x)
def _layernorm(x, axis=-1, eps=1e-5):
    m = x.mean(dim=axis, keepdim=True)
    v = x.var(dim=axis, keepdim=True, unbiased=False)
    return (x - m) / torch.sqrt(v + eps)
def _scatter_add(tgt, idx, src, axis=0):
    return tgt.clone().index_add_(axis, idx, src)
def _segment_sum(src, seg, n):
    out = torch.zeros((n,) + src.shape[1:], dtype=src.dtype)
    return out.index_add_(0, seg, src)
def _pad(x, pw):
    flat = tuple(v for pair in reversed(pw) for v in pair)
    return torch.nn.functional.pad(x, flat)

kernel_name = 'sequential_preLN__grouped_kv_mqa__swiglu_ffn__prompt'

def setup_inputs():

    _w = (lambda a: (lambda t: t.to(torch.bfloat16) if t.is_floating_point() else t)(torch.as_tensor(a)))
    def _A_setup():
        B, S, D, H = 1, 2048, 640, 32
        Dh = D // H
        return {
            "x": _w((lambda *s: torch.randn(*s, dtype=torch.bfloat16) * 0.05)(B, S, D)),
            "wq": _w((lambda *s: torch.randn(*s, dtype=torch.bfloat16) * 0.05)(D, H * Dh)),
            "wk": _w((lambda *s: torch.randn(*s, dtype=torch.bfloat16) * 0.05)(D, Dh)),
            "wv": _w((lambda *s: torch.randn(*s, dtype=torch.bfloat16) * 0.05)(D, Dh)),
            "wo": _w((lambda *s: torch.randn(*s, dtype=torch.bfloat16) * 0.05)(H * Dh, D)),
        }
    _A_in = _A_setup()

    def _B_setup():
        B, S, D, F = 1, 2048, 640, 1536
        return {
            "x": _w((lambda *s: torch.randn(*s, dtype=torch.bfloat16) * 0.05)(B, S, D)),
            "w_gate": _w((lambda *s: torch.randn(*s, dtype=torch.bfloat16) * 0.05)(D, F)),
            "w_up": _w((lambda *s: torch.randn(*s, dtype=torch.bfloat16) * 0.05)(D, F)),
            "w_down": _w((lambda *s: torch.randn(*s, dtype=torch.bfloat16) * 0.05)(F, D)),
        }
    _B_in = _B_setup()

    return {
        "A_x": _A_in["x"],
        "A_wq": _A_in["wq"],
        "A_wk": _A_in["wk"],
        "A_wv": _A_in["wv"],
        "A_wo": _A_in["wo"],
        "B_x": _B_in["x"],
        "B_w_gate": _B_in["w_gate"],
        "B_w_up": _B_in["w_up"],
        "B_w_down": _B_in["w_down"],
    }

def reference(A_x, A_wq, A_wk, A_wv, A_wo, B_x, B_w_gate, B_w_up, B_w_down):
    def _A_ref(x, wq, wk, wv, wo):
        B, S, D = x.shape
        H = 32
        Dh = D // H
        q = (lambda x, *d: x.permute(*d))((x @ wq).reshape(B, S, H, Dh), 0, 2, 1, 3)
        k = x @ wk
        v = x @ wv
        scores = torch.einsum("bhqd,bkd->bhqk", q, k) * (Dh ** -0.5)
        p = _softmax(scores, axis=-1)
        o = torch.einsum("bhqk,bkd->bhqd", p, v)
        return (lambda x, *d: x.permute(*d))(o, 0, 2, 1, 3).reshape(B, S, H * Dh) @ wo

    def _B_ref(x, w_gate, w_up, w_down):
        g = _silu(x @ w_gate)
        u = x @ w_up
        return (g * u) @ w_down

    x = A_x
    h = x + _A_ref(_layernorm(x, axis=-1), A_wq, A_wk, A_wv, A_wo)
    h2 = h + _B_ref(_layernorm(h, axis=-1), B_w_gate, B_w_up, B_w_down)
    return h2
```

```asm
; @launch grid=(256,1,1) block=(256,1,1) lds=163840
.amdgcn_target "amdgcn-amd-amdhsa--gfx950"
.text
.p2align 12
.p2align 8
.globl sequential_preLN__grouped_kv_mqa__swiglu_ffn__prompt_kernel
.type sequential_preLN__grouped_kv_mqa__swiglu_ffn__prompt_kernel,@function
sequential_preLN__grouped_kv_mqa__swiglu_ffn__prompt_kernel:
    s_cmp_ge_u32 s2, 256
    s_cbranch_scc1 L_end
    s_load_dwordx8 s[4:11], s[0:1], 0
    s_load_dwordx4 s[56:59], s[0:1], 80
    s_load_dwordx8 s[44:51], s[0:1], 48
    s_load_dwordx2 s[52:53], s[0:1], 32
    s_getpc_b64 s[20:21]
    v_lshrrev_b32 v1, 6, v0
    s_and_b32 s33, s2, 7
    s_lshr_b32 s35, s2, 3
    v_readfirstlane_b32 s32, v1
    v_and_b32 v1, 63, v0
    s_lshr_b32 s34, s35, 3
    s_lshl_b32 s33, s33, 2
    s_add_u32 s33, s33, s34
    s_and_b32 s34, s35, 7
    s_and_b32 s15, s35, 15
    s_lshr_b32 s14, s33, 1
    v_and_b32 v2, 15, v1
    v_lshrrev_b32 v3, 4, v1
    s_lshl_b32 s55, s35, 2
    s_add_u32 s55, s55, s32
    s_lshl_b32 s39, s55, 9
    v_lshl_add_u32 v20, v1, 7, s39
        v_min_u32 v20, L_code_end-sequential_preLN__grouped_kv_mqa__swiglu_ffn__prompt_kernel-128, v20
    s_mov_b64 exec, 15
    global_load_dword v200, v20, s[20:21]
    s_mov_b64 exec, -1
    v_add_u32 v22, 0, v3
    v_xor_b32 v23, v22, v2
    v_mul_u32_u24 v22, 1280, v22
    v_lshl_add_u32 v220, v23, 4, v22
    v_add_u32 v22, 4, v3
    v_xor_b32 v23, v22, v2
    v_mul_u32_u24 v22, 1280, v22
    v_lshl_add_u32 v221, v23, 4, v22
    v_subrev_u32 v221, 1024, v221
    v_add_u32 v22, 8, v3
    v_xor_b32 v23, v22, v2
    v_mul_u32_u24 v22, 1280, v22
    v_lshl_add_u32 v222, v23, 4, v22
    v_subrev_u32 v222, 2048, v222
    v_add_u32 v22, 12, v3
    v_xor_b32 v23, v22, v2
    v_mul_u32_u24 v22, 1280, v22
    v_lshl_add_u32 v223, v23, 4, v22
    v_subrev_u32 v223, 3072, v223
    s_lshl_b32 s35, s33, 2
    s_add_u32 s35, s35, s32
    s_mul_i32 s54, s35, 20480
    s_mul_i32 s39, s32, 20480
    v_lshlrev_b32 v4, 4, v1
    v_mov_b32 v0, 1
    s_lshl2_add_u32 s61, s2, s32
    s_mul_i32 s38, s61, 800
    v_lshl_add_u32 v19, v1, 7, s38
    s_mul_i32 s38, s34, 2560
    v_lshl_add_u32 v18, v1, 7, s38
    s_mov_b32 s18, 20480
    s_mov_b32 s19, 0x20000
    s_waitcnt lgkmcnt(0)
    s_and_b32 s5, s5, 0xffff
    s_and_b32 s59, s59, 0xffff
    s_add_u32 s16, s4, s54
    s_addc_u32 s17, s5, 0
    s_mov_b64 exec, 0xfffff
    buffer_load_dword v200, v18, s[16:19], 0 offen
    s_mov_b64 exec, -1
    s_mov_b32 s18, 19456
    s_mov_b32 s28, s58
    s_and_b32 s29, s59, 0xffff
    s_mov_b32 s30, 18710528
    s_mov_b32 s31, 0x20000
    s_cmp_lg_u32 s55, 28
    s_cbranch_scc1 L_nz0
    v_mov_b32 v24, 0
    v_mov_b32 v25, 0
    v_mov_b32 v26, 0
    v_mov_b32 v27, 0
    s_and_b32 s38, s2, 7
    s_lshl_b32 s38, s38, 13
    s_add_u32 s38, s38, 262144
    s_add_u32 s40, s38, 4096
    buffer_store_dwordx4 v[24:27], v4, s[28:31], s38 offen offset:0 sc1
    buffer_store_dwordx4 v[24:27], v4, s[28:31], s38 offen offset:1024 sc1
    buffer_store_dwordx4 v[24:27], v4, s[28:31], s38 offen offset:2048 sc1
    buffer_store_dwordx4 v[24:27], v4, s[28:31], s38 offen offset:3072 sc1
    buffer_store_dwordx4 v[24:27], v4, s[28:31], s40 offen offset:0 sc1
    buffer_store_dwordx4 v[24:27], v4, s[28:31], s40 offen offset:1024 sc1
    buffer_store_dwordx4 v[24:27], v4, s[28:31], s40 offen offset:2048 sc1
    buffer_store_dwordx4 v[24:27], v4, s[28:31], s40 offen offset:3072 sc1
L_nz0:
    s_bitcmp1_b32 s34, 1
    s_cselect_b32 s12, s10, s8
    s_cselect_b32 s13, s11, s9
    s_mov_b32 s24, s12
    s_and_b32 s25, s13, 0xffff
    s_mov_b32 s26, 25600
    s_mov_b32 s27, 0x20000
    s_cmp_ge_u32 s34, 4
    s_cselect_b32 s26, 0, s26
    s_mul_i32 s60, s32, 7168
    s_add_u32 m0, s60, 81920
    v_add_u32 v22, s60, v4
    v_add_u32 v23, 4096, v22
    buffer_load_dwordx4 v22, s[24:27], 0 offen offset:0 lds
    buffer_load_dwordx4 v22, s[24:27], 0 offen offset:1024 lds
    buffer_load_dwordx4 v22, s[24:27], 0 offen offset:2048 lds
    buffer_load_dwordx4 v22, s[24:27], 0 offen offset:3072 lds
    s_add_u32 m0, m0, 4096
    s_nop 0
    buffer_load_dwordx4 v23, s[24:27], 0 offen offset:0 lds
    buffer_load_dwordx4 v23, s[24:27], 0 offen offset:1024 lds
    buffer_load_dwordx4 v23, s[24:27], 0 offen offset:2048 lds
    s_mov_b64 exec, 0x7f
    global_load_dword v200, v19, s[6:7]
    s_mov_b64 exec, -1
    s_mov_b32 s8, s56
    s_and_b32 s9, s57, 0xffff
    s_mov_b32 s10, 256
    s_mov_b32 s11, 0x20000
    s_mul_i32 s38, s34, 160
    s_mul_i32 s40, s32, 40960
    s_add_u32 s38, s38, s40
    s_and_b32 s7, s7, 0xffff
    s_add_u32 s20, s6, s38
    s_addc_u32 s21, s7, 0
    s_mov_b32 s22, 39840
    s_mov_b32 s23, 0x20000
    s_mul_i32 s41, s32, 5120
    s_add_u32 s40, s41, 110592
    v_add_u32 v32, 0, v1
    v_mul_u32_u24 v33, 6554, v32
    v_lshrrev_b32 v33, 16, v33
    v_mul_u32_u24 v34, 10, v33
    v_sub_u32 v32, v32, v34
    v_and_b32 v34, 3, v33
    v_bfe_u32 v246, v33, 2, 2
    v_lshl_add_u32 v34, v246, 3, v34
    v_lshrrev_b32 v33, 4, v33
    v_lshl_add_u32 v33, v33, 2, v34
    v_mul_u32_u24 v33, 1280, v33
    v_lshl_add_u32 v246, v32, 4, v33
    v_add_u32 v32, 64, v1
    v_mul_u32_u24 v33, 6554, v32
    v_lshrrev_b32 v33, 16, v33
    v_mul_u32_u24 v34, 10, v33
    v_sub_u32 v32, v32, v34
    v_and_b32 v34, 3, v33
    v_bfe_u32 v247, v33, 2, 2
    v_lshl_add_u32 v34, v247, 3, v34
    v_lshrrev_b32 v33, 4, v33
    v_lshl_add_u32 v33, v33, 2, v34
    v_mul_u32_u24 v33, 1280, v33
    v_lshl_add_u32 v247, v32, 4, v33
    v_subrev_u32 v247, 1024, v247
    v_add_u32 v32, 128, v1
    v_mul_u32_u24 v33, 6554, v32
    v_lshrrev_b32 v33, 16, v33
    v_mul_u32_u24 v34, 10, v33
    v_sub_u32 v32, v32, v34
    v_and_b32 v34, 3, v33
    v_bfe_u32 v248, v33, 2, 2
    v_lshl_add_u32 v34, v248, 3, v34
    v_lshrrev_b32 v33, 4, v33
    v_lshl_add_u32 v33, v33, 2, v34
    v_mul_u32_u24 v33, 1280, v33
    v_lshl_add_u32 v248, v32, 4, v33
    v_subrev_u32 v248, 2048, v248
    v_add_u32 v32, 192, v1
    v_mul_u32_u24 v33, 6554, v32
    v_lshrrev_b32 v33, 16, v33
    v_mul_u32_u24 v34, 10, v33
    v_sub_u32 v32, v32, v34
    v_and_b32 v34, 3, v33
    v_bfe_u32 v249, v33, 2, 2
    v_lshl_add_u32 v34, v249, 3, v34
    v_lshrrev_b32 v33, 4, v33
    v_lshl_add_u32 v33, v33, 2, v34
    v_mul_u32_u24 v33, 1280, v33
    v_lshl_add_u32 v249, v32, 4, v33
    v_subrev_u32 v249, 3072, v249
    v_add_u32 v32, 256, v1
    v_mul_u32_u24 v33, 6554, v32
    v_lshrrev_b32 v33, 16, v33
    v_mul_u32_u24 v34, 10, v33
    v_sub_u32 v32, v32, v34
    v_and_b32 v34, 3, v33
    v_bfe_u32 v250, v33, 2, 2
    v_lshl_add_u32 v34, v250, 3, v34
    v_lshrrev_b32 v33, 4, v33
    v_lshl_add_u32 v33, v33, 2, v34
    v_mul_u32_u24 v33, 1280, v33
    v_lshl_add_u32 v250, v32, 4, v33
    v_lshrrev_b32 v24, 2, v1
    v_mul_u32_u24 v24, 160, v24
    v_and_b32 v27, 3, v1
    v_lshl_add_u32 v24, v27, 3, v24
    v_bfe_u32 v26, v1, 2, 2
    v_lshl_add_u32 v26, v3, 3, v26
    v_mul_u32_u24 v25, 40, v26
    v_lshlrev_b32 v28, 3, v27
    s_bitcmp1_b32 s34, 0
    s_cselect_b32 s38, 0, -1
    s_cselect_b32 s42, 32, 0
    v_and_b32 v28, s38, v28
    s_add_u32 s42, s42, 81920
    v_add3_u32 v25, v25, v28, s42
    v_lshl_add_u32 v29, v2, 8, s39
    s_add_u32 s38, s32, 0
    s_and_b32 s38, s38, 3
    s_lshl_b32 s42, s38, 2
    v_add_u32 v28, s42, v3
    v_xor_b32 v28, v28, v2
    v_lshl_add_u32 v224, v28, 4, v29
    s_mul_i32 s42, s38, 5120
    s_add_u32 s42, s42, 110592
    v_add_u32 v233, s42, v24
    s_mul_i32 s42, s38, 20480
    v_add_u32 v237, s42, v24
    s_mul_i32 s42, s38, 1280
    v_add_u32 v241, s42, v25
    s_add_u32 s38, s32, 1
    s_and_b32 s38, s38, 3
    s_lshl_b32 s42, s38, 2
    v_add_u32 v28, s42, v3
    v_xor_b32 v28, v28, v2
    v_lshl_add_u32 v225, v28, 4, v29
    s_mul_i32 s42, s38, 5120
    s_add_u32 s42, s42, 110592
    v_add_u32 v234, s42, v24
    s_mul_i32 s42, s38, 20480
    v_add_u32 v238, s42, v24
    s_mul_i32 s42, s38, 1280
    v_add_u32 v242, s42, v25
    s_add_u32 s38, s32, 2
    s_and_b32 s38, s38, 3
    s_lshl_b32 s42, s38, 2
    v_add_u32 v28, s42, v3
    v_xor_b32 v28, v28, v2
    v_lshl_add_u32 v226, v28, 4, v29
    s_mul_i32 s42, s38, 5120
    s_add_u32 s42, s42, 110592
    v_add_u32 v235, s42, v24
    s_mul_i32 s42, s38, 20480
    v_add_u32 v239, s42, v24
    s_mul_i32 s42, s38, 1280
    v_add_u32 v243, s42, v25
    s_add_u32 s38, s32, 3
    s_and_b32 s38, s38, 3
    s_lshl_b32 s42, s38, 2
    v_add_u32 v28, s42, v3
    v_xor_b32 v28, v28, v2
    v_lshl_add_u32 v227, v28, 4, v29
    s_mul_i32 s42, s38, 5120
    s_add_u32 s42, s42, 110592
    v_add_u32 v236, s42, v24
    s_mul_i32 s42, s38, 20480
    v_add_u32 v240, s42, v24
    s_mul_i32 s42, s38, 1280
    v_add_u32 v244, s42, v25
    s_mul_i32 s38, s34, 10
    v_lshrrev_b32 v24, 1, v3
    v_add_u32 v24, s38, v24
    v_and_b32 v25, 1, v3
    v_lshl_add_u32 v25, v25, 3, v29
    v_add_u32 v28, 0, v24
    v_lshrrev_b32 v30, 4, v28
    v_and_b32 v28, 15, v28
    v_xor_b32 v28, v28, v2
    v_lshl_add_u32 v28, v28, 4, v25
    v_lshl_add_u32 v228, v30, 12, v28
    v_add_u32 v28, 2, v24
    v_lshrrev_b32 v30, 4, v28
    v_and_b32 v28, 15, v28
    v_xor_b32 v28, v28, v2
    v_lshl_add_u32 v28, v28, 4, v25
    v_lshl_add_u32 v229, v30, 12, v28
    v_add_u32 v28, 4, v24
    v_lshrrev_b32 v30, 4, v28
    v_and_b32 v28, 15, v28
    v_xor_b32 v28, v28, v2
    v_lshl_add_u32 v28, v28, 4, v25
    v_lshl_add_u32 v230, v30, 12, v28
    v_add_u32 v28, 6, v24
    v_lshrrev_b32 v30, 4, v28
    v_and_b32 v28, 15, v28
    v_xor_b32 v28, v28, v2
    v_lshl_add_u32 v28, v28, 4, v25
    v_lshl_add_u32 v231, v30, 12, v28
    v_add_u32 v28, 8, v24
    v_lshrrev_b32 v30, 4, v28
    v_and_b32 v28, 15, v28
    v_xor_b32 v28, v28, v2
    v_lshl_add_u32 v28, v28, 4, v25
    v_lshl_add_u32 v232, v30, 12, v28
    v_cmp_eq_u32 vcc, 0, v27
    v_mov_b32 v72, 0x3f803f80
    s_nop 0
    v_cndmask_b32 v72, 0, v72, vcc
    v_mov_b32 v73, v72
    v_mov_b32 v74, v72
    v_mov_b32 v75, v72
    s_and_b32 s36, s32, 1
    v_and_b32 v7, 31, v1
    v_lshrrev_b32 v8, 5, v1
    s_lshr_b32 s37, s32, 1
    v_bfe_u32 v10, v1, 2, 1
    v_bfe_u32 v11, v1, 3, 1
    v_lshl_add_u32 v6, v10, 3, v27
    v_lshl_add_u32 v6, v11, 2, v6
    v_min_u32 v10, 21, v7
    v_cmp_gt_u32 vcc, 16, v7
    v_mov_b32 v15, 0xdddddddd
    v_mul_u32_u24 v11, 384, v8
    v_cndmask_b32 v6, v10, v6, vcc
    v_lshl_add_u32 v6, v6, 4, v11
    v_add_u32 v6, 2560, v6
    s_mul_i32 s35, s32, 2688
    s_add_u32 s35, s35, 98304
    v_mul_u32_u24 v28, 168, v2
    v_lshl_add_u32 v28, v3, 3, v28
    v_add_u32 v204, s35, v28
    s_mul_i32 s35, s37, 5376
    s_add_u32 s35, s35, 98304
    v_mul_u32_u24 v28, 168, v7
    v_add_u32 v28, s35, v28
    s_mul_i32 s38, s36, 80
    v_add_u32 v207, s38, v28
    v_lshl_add_u32 v208, v8, 4, v207
    s_sub_u32 s38, 80, s38
    v_add_u32 v205, s38, v28
    v_lshl_add_u32 v206, v8, 4, v205
    v_lshlrev_b32 v28, 2, v2
    v_add_u32 v28, 159744, v28
    v_mul_u32_u24 v30, 320, v3
    s_mul_i32 s35, s32, 320
    v_add_u32 v210, v28, v30
    v_add_u32 v209, s35, v28
    s_lshl_b32 s56, s33, 8
    s_lshr_b32 s35, s34, 1
    s_lshl_b32 s35, s35, 7
    s_add_u32 s56, s56, s35
    s_and_b32 s35, s34, 1
    s_lshl_b32 s35, s35, 2
    s_add_u32 s56, s56, s35
    s_add_u32 s56, s56, 270336
    s_mov_b32 s57, 270336
    s_cmp_ge_u32 s34, 4
    s_cselect_b32 s56, 18710528, s56
    s_cmp_lg_u32 s32, 0
    s_cselect_b32 s56, 18710528, s56
    s_cselect_b32 s57, 18710528, s57
    s_cselect_b32 s43, 256, 0
    v_lshlrev_b32 v211, 7, v1
    v_lshlrev_b32 v5, 3, v1
    s_cmp_lg_u32 s55, 28
    s_cbranch_scc1 L_nz1
    s_waitcnt vmcnt(8)
    s_mov_b64 exec, 1
    buffer_atomic_add v0, off, s[8:11], 0 sc1
    s_mov_b64 exec, -1
L_nz1:
    v_lshrrev_b32 v22, 1, v3
    v_and_b32 v23, 1, v3
    s_lshl_b32 s35, s32, 4
    v_add_u32 v24, s35, v2
    v_lshrrev_b32 v25, 5, v24
    v_and_b32 v26, 31, v24
    v_lshl_add_u32 v26, v22, 5, v26
    v_lshl_add_u32 v26, v25, 6, v26
    v_lshlrev_b32 v26, 4, v26
    v_lshl_add_u32 v26, v23, 3, v26
    v_lshlrev_b32 v24, 3, v24
    v_add_u32 v24, 2048, v24
    s_bitcmp1_b32 s34, 0
    s_cselect_b64 vcc, -1, 0
    s_cselect_b32 s42, 256, 0
    v_cndmask_b32 v24, v26, v24, vcc
    v_mul_u32_u24 v26, 384, v22
    v_lshl_add_u32 v26, v23, 3, v26
    s_mul_i32 s35, s32, 768
    v_lshl_add_u32 v26, v2, 4, v26
    s_add_u32 s35, s35, s42
    s_add_u32 s35, s35, 2560
    v_add_u32 v26, s35, v26
    s_bitcmp1_b32 s34, 1
    s_cselect_b64 vcc, -1, 0
    v_cndmask_b32 v212, v24, v26, vcc
    v_cmp_eq_u32 vcc, 4, v2
    s_lshl_b32 s35, s32, 9
    s_add_u32 s35, s35, 161024
    v_add_u32 v215, s35, v5
    v_cndmask_b32 v213, 0, v72, vcc
    v_lshlrev_b32 v24, 5, v2
    v_lshl_add_u32 v24, v3, 3, v24
    v_add_u32 v214, s35, v24
    s_cmp_ge_u32 s61, 480
    s_cselect_b32 s4, s46, s44
    s_cselect_b32 s5, s47, s45
    s_cselect_b32 s0, 480, 0
    s_sub_u32 s0, s61, s0
    s_mul_i32 s1, s0, 2731
    s_lshr_b32 s1, s1, 16
    s_mul_i32 s6, s1, 24
    s_sub_u32 s0, s0, s6
    s_mul_i32 s1, s1, 98304
    s_lshl_b32 s0, s0, 7
    s_add_u32 s0, s0, s1
    s_and_b32 s5, s5, 0xffff
    s_cmp_lt_u32 s61, 960
    s_cselect_b32 s6, 24704, 0
    s_cselect_b32 s0, s0, 0
    s_add_u32 s4, s4, s0
    s_addc_u32 s5, s5, 0
    s_mov_b32 s7, 0x20000
    v_lshrrev_b32 v194, 3, v1
    v_and_b32 v195, 7, v1
    v_lshlrev_b32 v195, 4, v195
    v_mul_u32_u24 v254, 3072, v194
    v_add_u32 v254, v254, v195
    v_mul_u32_u24 v253, 1280, v194
    v_add_u32 v253, v253, v195
    s_mul_i32 s3, s14, 3072
    s_add_u32 s3, s3, 278528
    v_and_b32 v195, 3, v1
    v_bfe_u32 v194, v1, 2, 2
    v_lshl_add_u32 v194, v3, 3, v194
    v_lshlrev_b32 v255, 7, v194
    v_lshl_add_u32 v255, v195, 3, v255
    s_lshl_b32 s42, s32, 12
    s_add_u32 s42, s42, 81920
    v_add_u32 v255, s42, v255
    s_lshl2_add_u32 s42, s15, s32
    s_mul_i32 s42, s42, 24
    v_add_u32 v194, s42, v2
    v_lshrrev_b32 v195, 4, v194
    v_and_b32 v194, 15, v194
    v_lshlrev_b32 v194, 4, v194
    v_lshl_add_u32 v194, v195, 10, v194
    v_lshl_add_u32 v251, v3, 8, v194
    v_add_u32 v252, 1966080, v251
    s_add_u32 s42, s42, 16
    v_and_b32 v194, 7, v2
    v_add_u32 v194, s42, v194
    v_lshrrev_b32 v195, 4, v194
    v_and_b32 v194, 15, v194
    v_lshlrev_b32 v194, 4, v194
    v_lshl_add_u32 v194, v195, 10, v194
    v_lshl_add_u32 v194, v3, 8, v194
    v_lshrrev_b32 v195, 3, v2
    v_mul_u32_u24 v195, 1966080, v195
    v_add_u32 v13, v194, v195
    v_add_u32 v9, 4096, v4
    s_add_u32 m0, s39, 0
    s_nop 0
    buffer_load_dwordx4 v220, s[16:19], 0 offen offset:0 lds
    buffer_load_dwordx4 v221, s[16:19], 0 offen offset:1024 lds
    buffer_load_dwordx4 v222, s[16:19], 0 offen offset:2048 lds
    buffer_load_dwordx4 v223, s[16:19], 0 offen offset:3072 lds
    s_add_u32 m0, s39, 4096
    s_add_u32 s16, s16, 256
    s_addc_u32 s17, s17, 0
    buffer_load_dwordx4 v220, s[16:19], 0 offen offset:0 lds
    buffer_load_dwordx4 v221, s[16:19], 0 offen offset:1024 lds
    buffer_load_dwordx4 v222, s[16:19], 0 offen offset:2048 lds
    buffer_load_dwordx4 v223, s[16:19], 0 offen offset:3072 lds
    s_add_u32 m0, s39, 8192
    s_add_u32 s16, s16, 256
    s_addc_u32 s17, s17, 0
    buffer_load_dwordx4 v220, s[16:19], 0 offen offset:0 lds
    buffer_load_dwordx4 v221, s[16:19], 0 offen offset:1024 lds
    buffer_load_dwordx4 v222, s[16:19], 0 offen offset:2048 lds
    buffer_load_dwordx4 v223, s[16:19], 0 offen offset:3072 lds
    s_mov_b64 exec, 0
    s_cmp_eq_u32 s32, 0
    s_cbranch_scc1 L_warm0_0
    s_cmp_eq_u32 s32, 1
    s_cbranch_scc1 L_warm0_1
    s_cmp_eq_u32 s32, 2
    s_cbranch_scc1 L_warm0_2
    s_branch L_warm0_3
L_warm0_ret:
    s_mov_b64 exec, -1
    s_waitcnt vmcnt(13)
    s_barrier
    s_waitcnt vmcnt(8)
    ds_read_b128 a[0:3], v224 offset:0
    ds_read_b64_tr_b16 a[140:141], v241 offset:0
    ds_read_b64_tr_b16 a[142:143], v241 offset:160
    ds_read_b128 a[4:7], v225 offset:0
    ds_read_b64_tr_b16 a[144:145], v242 offset:0
    ds_read_b64_tr_b16 a[146:147], v242 offset:160
    ds_read_b128 a[8:11], v226 offset:0
    ds_read_b64_tr_b16 a[148:149], v243 offset:0
    ds_read_b64_tr_b16 a[150:151], v243 offset:160
    ds_read_b128 a[12:15], v227 offset:0
    ds_read_b64_tr_b16 a[152:153], v244 offset:0
    ds_read_b64_tr_b16 a[154:155], v244 offset:160
    s_waitcnt lgkmcnt(9)
    v_mfma_f32_16x16x32_bf16 v[56:59], v[72:75], a[0:3], 0
    s_add_u32 m0, s39, 12288
    s_add_u32 s16, s16, 256
    s_addc_u32 s17, s17, 0
    buffer_load_dwordx4 v220, s[16:19], 0 offen offset:0 lds
    v_mfma_f32_16x16x32_bf16 v[64:67], a[140:143], a[0:3], 0
    s_waitcnt vmcnt(5)
    ds_read_b128 a[16:19], v224 offset:4096
    v_mov_b32 v80, 0
    v_mfma_f32_16x16x32_bf16 v[60:63], a[0:3], a[0:3], 0
    ds_read_b64_tr_b16 a[156:157], v241 offset:5120
    v_mov_b32 v81, 0
    v_mfma_f32_16x16x32_bf16 v[68:71], v[72:75], a[140:143], 0
    s_waitcnt lgkmcnt(8)
    ds_read_b64_tr_b16 a[158:159], v241 offset:5280
    v_mov_b32 v82, 0
    v_mfma_f32_16x16x32_bf16 v[56:59], v[72:75], a[4:7], v[56:59]
    buffer_load_dwordx4 v221, s[16:19], 0 offen offset:1024 lds
    v_mfma_f32_16x16x32_bf16 v[64:67], a[144:147], a[4:7], v[64:67]
    ds_read_b128 a[20:23], v225 offset:4096
    v_mov_b32 v83, 0
    v_mfma_f32_16x16x32_bf16 v[60:63], a[4:7], a[4:7], v[60:63]
    ds_read_b64_tr_b16 a[160:161], v242 offset:5120
    v_mov_b32 v84, 0
    v_mfma_f32_16x16x32_bf16 v[68:71], v[72:75], a[144:147], v[68:71]
    s_waitcnt lgkmcnt(8)
    ds_read_b64_tr_b16 a[162:163], v242 offset:5280
    v_mov_b32 v85, 0
    v_mfma_f32_16x16x32_bf16 v[56:59], v[72:75], a[8:11], v[56:59]
    buffer_load_dwordx4 v222, s[16:19], 0 offen offset:2048 lds
    v_mfma_f32_16x16x32_bf16 v[64:67], a[148:151], a[8:11], v[64:67]
    ds_read_b128 a[24:27], v226 offset:4096
    v_mov_b32 v86, 0
    v_mfma_f32_16x16x32_bf16 v[60:63], a[8:11], a[8:11], v[60:63]
    ds_read_b64_tr_b16 a[164:165], v243 offset:5120
    v_mov_b32 v87, 0
    v_mfma_f32_16x16x32_bf16 v[68:71], v[72:75], a[148:151], v[68:71]
    s_waitcnt lgkmcnt(8)
    ds_read_b64_tr_b16 a[166:167], v243 offset:5280
    v_mov_b32 v88, 0
    v_mfma_f32_16x16x32_bf16 v[56:59], v[72:75], a[12:15], v[56:59]
    buffer_load_dwordx4 v223, s[16:19], 0 offen offset:3072 lds
    v_mfma_f32_16x16x32_bf16 v[64:67], a[152:155], a[12:15], v[64:67]
    ds_read_b128 a[28:31], v227 offset:4096
    v_mov_b32 v89, 0
    v_mfma_f32_16x16x32_bf16 v[60:63], a[12:15], a[12:15], v[60:63]
    ds_read_b64_tr_b16 a[168:169], v244 offset:5120
    v_mov_b32 v90, 0
    v_mfma_f32_16x16x32_bf16 v[68:71], v[72:75], a[152:155], v[68:71]
    s_waitcnt lgkmcnt(8)
    ds_read_b64_tr_b16 a[170:171], v244 offset:5280
    v_mov_b32 v91, 0
    v_mfma_f32_16x16x32_bf16 v[56:59], v[72:75], a[16:19], v[56:59]
    s_add_u32 m0, s39, 16384
    s_add_u32 s16, s16, 256
    s_addc_u32 s17, s17, 0
    buffer_load_dwordx4 v220, s[16:19], 0 offen offset:0 lds
    v_mfma_f32_16x16x32_bf16 v[64:67], a[156:159], a[16:19], v[64:67]
L_warm0_0:
L_warm0_2:
    s_cbranch_execz L_warm0_ret
    s_waitcnt vmcnt(5)
    ds_read_b128 a[32:35], v224 offset:8192
    v_mov_b32 v92, 0
    v_mfma_f32_16x16x32_bf16 v[60:63], a[16:19], a[16:19], v[60:63]
    ds_read_b64_tr_b16 a[172:173], v241 offset:10240
    v_mov_b32 v93, 0
    v_mfma_f32_16x16x32_bf16 v[68:71], v[72:75], a[156:159], v[68:71]
    s_waitcnt lgkmcnt(8)
    ds_read_b64_tr_b16 a[174:175], v241 offset:10400
    v_mov_b32 v94, 0
    v_mfma_f32_16x16x32_bf16 v[56:59], v[72:75], a[20:23], v[56:59]
    buffer_load_dwordx4 v221, s[16:19], 0 offen offset:1024 lds
    v_mfma_f32_16x16x32_bf16 v[64:67], a[160:163], a[20:23], v[64:67]
    ds_read_b128 a[36:39], v225 offset:8192
    v_mov_b32 v95, 0
    v_mfma_f32_16x16x32_bf16 v[60:63], a[20:23], a[20:23], v[60:63]
    ds_read_b64_tr_b16 a[176:177], v242 offset:10240
    v_mov_b32 v96, 0
    v_mfma_f32_16x16x32_bf16 v[68:71], v[72:75], a[160:163], v[68:71]
    s_waitcnt lgkmcnt(8)
    ds_read_b64_tr_b16 a[178:179], v242 offset:10400
    v_mov_b32 v97, 0
    v_mfma_f32_16x16x32_bf16 v[56:59], v[72:75], a[24:27], v[56:59]
    buffer_load_dwordx4 v222, s[16:19], 0 offen offset:2048 lds
    v_mfma_f32_16x16x32_bf16 v[64:67], a[164:167], a[24:27], v[64:67]
    ds_read_b128 a[40:43], v226 offset:8192
    v_mov_b32 v98, 0
    v_mfma_f32_16x16x32_bf16 v[60:63], a[24:27], a[24:27], v[60:63]
    ds_read_b64_tr_b16 a[180:181], v243 offset:10240
    v_mov_b32 v99, 0
    v_mfma_f32_16x16x32_bf16 v[68:71], v[72:75], a[164:167], v[68:71]
    s_waitcnt lgkmcnt(8)
    ds_read_b64_tr_b16 a[182:183], v243 offset:10400
    v_mov_b32 v100, 0
    v_mfma_f32_16x16x32_bf16 v[56:59], v[72:75], a[28:31], v[56:59]
    buffer_load_dwordx4 v223, s[16:19], 0 offen offset:3072 lds
    v_mfma_f32_16x16x32_bf16 v[64:67], a[168:171], a[28:31], v[64:67]
    ds_read_b128 a[44:47], v227 offset:8192
    v_mov_b32 v101, 0
    v_mfma_f32_16x16x32_bf16 v[60:63], a[28:31], a[28:31], v[60:63]
    ds_read_b64_tr_b16 a[184:185], v244 offset:10240
    v_mov_b32 v102, 0
    v_mfma_f32_16x16x32_bf16 v[68:71], v[72:75], a[168:171], v[68:71]
    s_waitcnt lgkmcnt(8)
    ds_read_b64_tr_b16 a[186:187], v244 offset:10400
    v_mov_b32 v103, 0
    v_mfma_f32_16x16x32_bf16 v[56:59], v[72:75], a[32:35], v[56:59]
    s_add_u32 m0, s40, 0
    s_nop 0
    buffer_load_dwordx4 v246, s[20:23], 0 offen offset:0 lds
    v_mfma_f32_16x16x32_bf16 v[64:67], a[172:175], a[32:35], v[64:67]
    s_waitcnt vmcnt(5)
    ds_read_b128 a[48:51], v224 offset:12288
    v_mov_b32 v104, 0
    v_mfma_f32_16x16x32_bf16 v[60:63], a[32:35], a[32:35], v[60:63]
    ds_read_b64_tr_b16 a[188:189], v241 offset:15360
    v_mov_b32 v105, 0
    v_mfma_f32_16x16x32_bf16 v[68:71], v[72:75], a[172:175], v[68:71]
    s_waitcnt lgkmcnt(8)
    ds_read_b64_tr_b16 a[190:191], v241 offset:15520
    v_mov_b32 v106, 0
    v_mfma_f32_16x16x32_bf16 v[56:59], v[72:75], a[36:39], v[56:59]
    buffer_load_dwordx4 v247, s[20:23], 0 offen offset:1024 lds
    v_mfma_f32_16x16x32_bf16 v[64:67], a[176:179], a[36:39], v[64:67]
    ds_read_b128 a[52:55], v225 offset:12288
    v_mov_b32 v107, 0
    v_mfma_f32_16x16x32_bf16 v[60:63], a[36:39], a[36:39], v[60:63]
    ds_read_b64_tr_b16 a[192:193], v242 offset:15360
    v_mov_b32 v108, 0
    v_mfma_f32_16x16x32_bf16 v[68:71], v[72:75], a[176:179], v[68:71]
    s_waitcnt lgkmcnt(8)
    ds_read_b64_tr_b16 a[194:195], v242 offset:15520
    v_mov_b32 v109, 0
    v_mfma_f32_16x16x32_bf16 v[56:59], v[72:75], a[40:43], v[56:59]
    buffer_load_dwordx4 v248, s[20:23], 0 offen offset:2048 lds
    v_mfma_f32_16x16x32_bf16 v[64:67], a[180:183], a[40:43], v[64:67]
    ds_read_b128 a[56:59], v226 offset:12288
    v_mov_b32 v110, 0
    v_mfma_f32_16x16x32_bf16 v[60:63], a[40:43], a[40:43], v[60:63]
    ds_read_b64_tr_b16 a[196:197], v243 offset:15360
    v_mov_b32 v111, 0
    v_mfma_f32_16x16x32_bf16 v[68:71], v[72:75], a[180:183], v[68:71]
    s_waitcnt lgkmcnt(8)
    ds_read_b64_tr_b16 a[198:199], v243 offset:15520
    v_mov_b32 v112, 0
    v_mfma_f32_16x16x32_bf16 v[56:59], v[72:75], a[44:47], v[56:59]
    buffer_load_dwordx4 v249, s[20:23], 0 offen offset:3072 lds
    v_mfma_f32_16x16x32_bf16 v[64:67], a[184:187], a[44:47], v[64:67]
    ds_read_b128 a[60:63], v227 offset:12288
    v_mov_b32 v113, 0
    v_mfma_f32_16x16x32_bf16 v[60:63], a[44:47], a[44:47], v[60:63]
    ds_read_b64_tr_b16 a[200:201], v244 offset:15360
    v_mov_b32 v114, 0
    v_mfma_f32_16x16x32_bf16 v[68:71], v[72:75], a[184:187], v[68:71]
    s_waitcnt lgkmcnt(8)
    ds_read_b64_tr_b16 a[202:203], v244 offset:15520
    v_mov_b32 v115, 0
    v_mfma_f32_16x16x32_bf16 v[56:59], v[72:75], a[48:51], v[56:59]
    s_add_u32 m0, m0, 4096
    s_nop 0
    buffer_load_dwordx4 v250, s[20:23], 0 offen lds
    v_mfma_f32_16x16x32_bf16 v[64:67], a[188:191], a[48:51], v[64:67]
    s_waitcnt vmcnt(5)
    ds_read_b64 a[240:241], v228
    ds_read_b64 a[242:243], v229
    v_mfma_f32_16x16x32_bf16 v[60:63], a[48:51], a[48:51], v[60:63]
    ds_read_b64 a[244:245], v230
    ds_read_b64 a[246:247], v231
    v_mfma_f32_16x16x32_bf16 v[68:71], v[72:75], a[188:191], v[68:71]
    s_waitcnt lgkmcnt(10)
    ds_read_b64 a[248:249], v232
    ds_read_b128 a[64:67], v224 offset:16384
    v_mfma_f32_16x16x32_bf16 v[56:59], v[72:75], a[52:55], v[56:59]
    s_add_u32 m0, s40, 20480
    s_add_u32 s20, s20, 163840
    s_addc_u32 s21, s21, 0
    buffer_load_dwordx4 v246, s[20:23], 0 offen offset:0 lds
    v_mfma_f32_16x16x32_bf16 v[64:67], a[192:195], a[52:55], v[64:67]
    ds_read_b64_tr_b16 a[204:205], v241 offset:20480
    ds_read_b64_tr_b16 a[206:207], v241 offset:20640
    v_mfma_f32_16x16x32_bf16 v[60:63], a[52:55], a[52:55], v[60:63]
    ds_read_b128 a[68:71], v225 offset:16384
    ds_read_b64_tr_b16 a[208:209], v242 offset:20480
    v_mfma_f32_16x16x32_bf16 v[68:71], v[72:75], a[192:195], v[68:71]
    s_waitcnt lgkmcnt(13)
    ds_read_b64_tr_b16 a[210:211], v242 offset:20640
    v_mov_b32 v116, 0
    v_mfma_f32_16x16x32_bf16 v[56:59], v[72:75], a[56:59], v[56:59]
    buffer_load_dwordx4 v247, s[20:23], 0 offen offset:1024 lds
    v_mfma_f32_16x16x32_bf16 v[64:67], a[196:199], a[56:59], v[64:67]
    ds_read_b128 a[72:75], v226 offset:16384
    v_mov_b32 v117, 0
    v_mfma_f32_16x16x32_bf16 v[60:63], a[56:59], a[56:59], v[60:63]
    ds_read_b64_tr_b16 a[212:213], v243 offset:20480
    v_mov_b32 v118, 0
    v_mfma_f32_16x16x32_bf16 v[68:71], v[72:75], a[196:199], v[68:71]
    s_waitcnt lgkmcnt(13)
    ds_read_b64_tr_b16 a[214:215], v243 offset:20640
    v_mov_b32 v119, 0
    v_mfma_f32_16x16x32_bf16 v[56:59], v[72:75], a[60:63], v[56:59]
    buffer_load_dwordx4 v248, s[20:23], 0 offen offset:2048 lds
    v_mfma_f32_16x16x32_bf16 v[64:67], a[200:203], a[60:63], v[64:67]
    ds_read_b128 a[76:79], v227 offset:16384
    v_mov_b32 v120, 0
    v_mfma_f32_16x16x32_bf16 v[60:63], a[60:63], a[60:63], v[60:63]
    ds_read_b64_tr_b16 a[216:217], v244 offset:20480
    v_mov_b32 v121, 0
    v_mfma_f32_16x16x32_bf16 v[68:71], v[72:75], a[200:203], v[68:71]
    ds_read_b64_tr_b16 a[218:219], v244 offset:20640
    v_mov_b32 v122, 0
    s_waitcnt lgkmcnt(0)
    s_waitcnt lgkmcnt(9)
    v_mfma_f32_16x16x32_bf16 v[56:59], v[72:75], a[64:67], v[56:59]
    buffer_load_dwordx4 v249, s[20:23], 0 offen offset:3072 lds
    v_mfma_f32_16x16x32_bf16 v[64:67], a[204:207], a[64:67], v[64:67]
    v_mov_b32 v123, 0
    v_mov_b32 v124, 0
    v_mfma_f32_16x16x32_bf16 v[60:63], a[64:67], a[64:67], v[60:63]
    v_mov_b32 v125, 0
    v_mov_b32 v126, 0
    v_mfma_f32_16x16x32_bf16 v[68:71], v[72:75], a[204:207], v[68:71]
    v_mov_b32 v127, 0
    v_mov_b32 v128, 0
    v_mfma_f32_16x16x32_bf16 v[56:59], v[72:75], a[68:71], v[56:59]
    s_add_u32 m0, m0, 4096
    s_nop 0
    buffer_load_dwordx4 v250, s[20:23], 0 offen lds
    v_mfma_f32_16x16x32_bf16 v[64:67], a[208:211], a[68:71], v[64:67]
    v_mov_b32 v129, 0
    v_mov_b32 v130, 0
    v_mfma_f32_16x16x32_bf16 v[60:63], a[68:71], a[68:71], v[60:63]
    v_mov_b32 v131, 0
    v_mov_b32 v132, 0
    v_mfma_f32_16x16x32_bf16 v[68:71], v[72:75], a[208:211], v[68:71]
    v_mov_b32 v133, 0
    v_mov_b32 v134, 0
    v_mfma_f32_16x16x32_bf16 v[56:59], v[72:75], a[72:75], v[56:59]
    s_add_u32 m0, s39, 0
    s_add_u32 s20, s20, 163840
    s_addc_u32 s21, s21, 0
    buffer_load_dwordx4 v246, s[20:23], 0 offen offset:0 lds
    v_mfma_f32_16x16x32_bf16 v[64:67], a[212:215], a[72:75], v[64:67]
    v_mov_b32 v135, 0
    v_mov_b32 v136, 0
    v_mfma_f32_16x16x32_bf16 v[60:63], a[72:75], a[72:75], v[60:63]
    v_mov_b32 v137, 0
    v_mov_b32 v138, 0
    v_mfma_f32_16x16x32_bf16 v[68:71], v[72:75], a[212:215], v[68:71]
    v_mov_b32 v139, 0
    v_mov_b32 v140, 0
    v_mfma_f32_16x16x32_bf16 v[56:59], v[72:75], a[76:79], v[56:59]
    buffer_load_dwordx4 v247, s[20:23], 0 offen offset:1024 lds
    v_mfma_f32_16x16x32_bf16 v[64:67], a[216:219], a[76:79], v[64:67]
    v_mov_b32 v141, 0
    v_mov_b32 v142, 0
    v_mfma_f32_16x16x32_bf16 v[60:63], a[76:79], a[76:79], v[60:63]
    v_mov_b32 v143, 0
    v_mfma_f32_16x16x32_bf16 v[68:71], v[72:75], a[216:219], v[68:71]
    s_mov_b32 s12, 0x22222222
    s_mov_b32 s13, s12
    v_mov_b32 v79, 1.0
    s_mul_i32 s38, s33, 5632
    s_add_u32 s38, s38, 0
    s_cmp_ge_u32 s34, 4
    s_cselect_b32 s38, 18710528, s38
    v_mul_f32 v76, 0xb9cccccd, v56
    v_cndmask_b32 v60, v60, v61, s[12:13]
    s_lshl_b64 s[12:13], s[12:13], 1
    v_cndmask_b32 v60, v60, v62, s[12:13]
    s_lshl_b64 s[12:13], s[12:13], 1
    v_cndmask_b32 v60, v60, v63, s[12:13]
    s_mov_b32 s12, 0x00f0000f
    s_mov_b32 s13, 0xf0000f00
    v_cndmask_b32 v77, 0, v60, s[12:13]
    v_mul_f32 v78, 4.0, v76
    v_mfma_f32_16x16x4_f32 v[64:67], v68, v76, v[64:67]
    v_mfma_f32_16x16x4_f32 v[60:63], v79, v77, 0
    s_cmp_eq_u32 s34, 1
    s_cselect_b64 s[12:13], 0xffff, -1
    s_cmp_eq_u32 s34, 3
    s_cselect_b32 s12, 0x00ff00ff, s12
    s_cselect_b32 s13, s12, s13
    s_cselect_b32 s26, 0x00f000f0, 0
    s_mov_b32 s27, s26
    s_bitcmp1_b32 s34, 1
    s_cselect_b64 vcc, -1, 0
    buffer_load_dwordx4 v248, s[20:23], 0 offen offset:2048 lds
    buffer_load_dwordx4 v249, s[20:23], 0 offen offset:3072 lds
    s_nop 0
    v_mul_f32 v77, 0x3acccccd, v60
    v_fma_f32 v77, -v78, v78, v77
    v_max_f32 v77, 0, v77
    v_add_f32 v77, 0x3727c5ac, v77
    v_rsq_f32 v77, v77
    v_mov_b32 v76, v78
    v_mul_f32 v64, v64, v77
    v_mul_f32 v65, v65, v77
    v_mul_f32 v66, v66, v77
    v_mul_f32 v67, v67, v77
    v_cvt_pk_bf16_f32 v64, v64, v65
    v_cvt_pk_bf16_f32 v65, v66, v67
    ds_write_b64 v214, v[64:65]
    ds_read_b64_tr_b16 v[66:67], v215
    v_mul_f32 v78, 0x3ea52b5c, v77
    s_waitcnt lgkmcnt(0)
    v_cndmask_b32 v64, v64, v66, vcc
    v_cndmask_b32 v65, v65, v67, vcc
    v_cndmask_b32 v64, v64, v213, s[26:27]
    v_cndmask_b32 v65, v65, v213, s[26:27]
    s_mov_b64 exec, s[12:13]
    buffer_store_dwordx2 v[64:65], v212, s[28:31], s38 offen sc1
    s_mov_b64 exec, -1
    buffer_load_dword v14, off, s[8:11], s43 sc1
    s_waitcnt vmcnt(11)
    s_barrier
    ds_read_b64_tr_b16 a[80:81], v233 offset:0
    ds_read_b64_tr_b16 a[82:83], v233 offset:2560
    ds_read_b64_tr_b16 a[84:85], v234 offset:0
    ds_read_b64_tr_b16 a[86:87], v234 offset:2560
    ds_read_b64_tr_b16 a[88:89], v233 offset:32
    ds_read_b64_tr_b16 a[90:91], v233 offset:2592
    ds_read_b64_tr_b16 a[92:93], v234 offset:32
    ds_read_b64_tr_b16 a[94:95], v234 offset:2592
    ds_read_b64_tr_b16 a[96:97], v233 offset:64
    ds_read_b64_tr_b16 a[98:99], v233 offset:2624
    ds_read_b64_tr_b16 a[100:101], v234 offset:64
    ds_read_b64_tr_b16 a[102:103], v234 offset:2624
    s_waitcnt lgkmcnt(10)
    v_mfma_f32_16x16x32_bf16 v[36:39], v[72:75], a[80:83], 0
    ds_read_b64_tr_b16 a[104:105], v233 offset:96
    ds_read_b64_tr_b16 a[106:107], v233 offset:2656
    v_mfma_f32_16x16x32_bf16 v[16:19], a[80:83], a[0:3], 0
    s_waitcnt lgkmcnt(10)
    ds_read_b64_tr_b16 a[108:109], v234 offset:96
    ds_read_b64_tr_b16 a[110:111], v234 offset:2656
    v_mfma_f32_16x16x32_bf16 v[16:19], a[84:87], a[4:7], v[16:19]
    s_waitcnt lgkmcnt(10)
    ds_read_b64_tr_b16 a[112:113], v233 offset:128
    ds_read_b64_tr_b16 a[114:115], v233 offset:2688
    v_mfma_f32_16x16x32_bf16 v[40:43], v[72:75], a[88:91], 0
    s_add_u32 m0, m0, 4096
    s_nop 0
    buffer_load_dwordx4 v250, s[20:23], 0 offen lds
    v_mfma_f32_16x16x32_bf16 v[20:23], a[88:91], a[0:3], 0
    s_waitcnt lgkmcnt(10)
    ds_read_b64_tr_b16 a[116:117], v234 offset:128
    ds_read_b64_tr_b16 a[118:119], v234 offset:2688
    v_mfma_f32_16x16x32_bf16 v[20:23], a[92:95], a[4:7], v[20:23]
    s_waitcnt lgkmcnt(10)
    ds_read_b64_tr_b16 a[120:121], v235 offset:0
    ds_read_b64_tr_b16 a[122:123], v235 offset:2560
    v_mfma_f32_16x16x32_bf16 v[44:47], v[72:75], a[96:99], 0
    ds_read_b64_tr_b16 a[124:125], v236 offset:0
    ds_read_b64_tr_b16 a[126:127], v236 offset:2560
    v_mfma_f32_16x16x32_bf16 v[24:27], a[96:99], a[0:3], 0
    s_waitcnt lgkmcnt(12)
    ds_read_b64_tr_b16 a[128:129], v235 offset:32
    ds_read_b64_tr_b16 a[130:131], v235 offset:2592
    v_mfma_f32_16x16x32_bf16 v[24:27], a[100:103], a[4:7], v[24:27]
    s_waitcnt lgkmcnt(12)
    s_add_u32 m0, s39, 5120
    s_add_u32 s20, s20, 163840
    s_addc_u32 s21, s21, 0
    buffer_load_dwordx4 v246, s[20:23], 0 offen offset:0 lds
    v_mfma_f32_16x16x32_bf16 v[48:51], v[72:75], a[104:107], 0
    ds_read_b64_tr_b16 a[132:133], v236 offset:32
    ds_read_b64_tr_b16 a[134:135], v236 offset:2592
    v_mfma_f32_16x16x32_bf16 v[28:31], a[104:107], a[0:3], 0
    s_waitcnt lgkmcnt(12)
    ds_read_b64_tr_b16 a[136:137], v235 offset:64
    ds_read_b64_tr_b16 a[138:139], v235 offset:2624
    v_mfma_f32_16x16x32_bf16 v[28:31], a[108:111], a[4:7], v[28:31]
    s_waitcnt lgkmcnt(12)
    buffer_load_dwordx4 v247, s[20:23], 0 offen offset:1024 lds
    v_mfma_f32_16x16x32_bf16 v[52:55], v[72:75], a[112:115], 0
    ds_read_b64_tr_b16 a[80:81], v236 offset:64
    ds_read_b64_tr_b16 a[82:83], v236 offset:2624
    v_mfma_f32_16x16x32_bf16 v[32:35], a[112:115], a[0:3], 0
    s_waitcnt lgkmcnt(12)
    ds_read_b64_tr_b16 a[84:85], v235 offset:96
    ds_read_b64_tr_b16 a[86:87], v235 offset:2656
    v_mfma_f32_16x16x32_bf16 v[32:35], a[116:119], a[4:7], v[32:35]
    s_waitcnt lgkmcnt(12)
    ds_read_b64_tr_b16 a[88:89], v236 offset:96
    ds_read_b64_tr_b16 a[90:91], v236 offset:2656
    v_mfma_f32_16x16x32_bf16 v[16:19], a[120:123], a[8:11], v[16:19]
    s_waitcnt lgkmcnt(12)
    ds_read_b64_tr_b16 a[92:93], v235 offset:128
    ds_read_b64_tr_b16 a[94:95], v235 offset:2688
    v_mfma_f32_16x16x32_bf16 v[16:19], a[124:127], a[12:15], v[16:19]
    s_waitcnt lgkmcnt(12)
    buffer_load_dwordx4 v248, s[20:23], 0 offen offset:2048 lds
    v_mfma_f32_16x16x32_bf16 v[20:23], a[128:131], a[8:11], v[20:23]
    s_waitcnt lgkmcnt(10)
    ds_read_b64_tr_b16 a[96:97], v236 offset:128
    ds_read_b64_tr_b16 a[98:99], v236 offset:2688
    v_mfma_f32_16x16x32_bf16 v[20:23], a[132:135], a[12:15], v[20:23]
    s_waitcnt lgkmcnt(10)
    s_waitcnt vmcnt(10)
    s_barrier
    ds_read_b64_tr_b16 a[100:101], v233 offset:20480
    ds_read_b64_tr_b16 a[102:103], v233 offset:23040
    v_mfma_f32_16x16x32_bf16 v[24:27], a[136:139], a[8:11], v[24:27]
    s_waitcnt lgkmcnt(10)
    ds_read_b64_tr_b16 a[104:105], v234 offset:20480
    ds_read_b64_tr_b16 a[106:107], v234 offset:23040
    v_mfma_f32_16x16x32_bf16 v[24:27], a[80:83], a[12:15], v[24:27]
    s_waitcnt lgkmcnt(10)
    buffer_load_dwordx4 v249, s[20:23], 0 offen offset:3072 lds
    v_mfma_f32_16x16x32_bf16 v[28:31], a[84:87], a[8:11], v[28:31]
    s_waitcnt lgkmcnt(8)
    ds_read_b64_tr_b16 a[108:109], v233 offset:20512
    ds_read_b64_tr_b16 a[110:111], v233 offset:23072
    v_mfma_f32_16x16x32_bf16 v[28:31], a[88:91], a[12:15], v[28:31]
    s_waitcnt lgkmcnt(8)
    ds_read_b64_tr_b16 a[112:113], v234 offset:20512
    ds_read_b64_tr_b16 a[114:115], v234 offset:23072
    v_mfma_f32_16x16x32_bf16 v[32:35], a[92:95], a[8:11], v[32:35]
    s_waitcnt lgkmcnt(8)
    ds_read_b64_tr_b16 a[116:117], v233 offset:20544
    ds_read_b64_tr_b16 a[118:119], v233 offset:23104
    v_mfma_f32_16x16x32_bf16 v[32:35], a[96:99], a[12:15], v[32:35]
    s_waitcnt lgkmcnt(8)
    s_add_u32 m0, m0, 4096
    s_nop 0
    buffer_load_dwordx4 v250, s[20:23], 0 offen lds
    v_mfma_f32_16x16x32_bf16 v[36:39], v[72:75], a[100:103], v[36:39]
    ds_read_b64_tr_b16 a[120:121], v234 offset:20544
    ds_read_b64_tr_b16 a[122:123], v234 offset:23104
    v_mfma_f32_16x16x32_bf16 v[16:19], a[100:103], a[16:19], v[16:19]
    s_waitcnt lgkmcnt(8)
    ds_read_b64_tr_b16 a[124:125], v233 offset:20576
    ds_read_b64_tr_b16 a[126:127], v233 offset:23136
    v_mfma_f32_16x16x32_bf16 v[16:19], a[104:107], a[20:23], v[16:19]
    s_waitcnt lgkmcnt(8)
    s_add_u32 m0, s39, 10240
    s_add_u32 s20, s20, 163840
    s_addc_u32 s21, s21, 0
    buffer_load_dwordx4 v246, s[20:23], 0 offen offset:0 lds
    v_mfma_f32_16x16x32_bf16 v[40:43], v[72:75], a[108:111], v[40:43]
    ds_read_b64_tr_b16 a[128:129], v234 offset:20576
    ds_read_b64_tr_b16 a[130:131], v234 offset:23136
    v_mfma_f32_16x16x32_bf16 v[20:23], a[108:111], a[16:19], v[20:23]
    s_waitcnt lgkmcnt(8)
    s_cmp_lg_u32 s32, 0
    s_cbranch_scc1 L_s0_ok
    s_waitcnt vmcnt(7)
    v_cmp_gt_u32 vcc, 8, v14
    s_nop 0
    s_cmp_eq_u64 vcc, 0
    s_cbranch_scc0 L_s0_slow
L_s0_ok:
    s_waitcnt vmcnt(8)
    s_barrier
    s_mov_b64 exec, 1
    buffer_store_dword v0, off, s[28:31], s56 sc1
    s_mov_b64 exec, -1
    ds_read_b64_tr_b16 a[132:133], v233 offset:20608
    ds_read_b64_tr_b16 a[134:135], v233 offset:23168
    v_mfma_f32_16x16x32_bf16 v[20:23], a[112:115], a[20:23], v[20:23]
    s_waitcnt lgkmcnt(8)
    ds_read_b64_tr_b16 a[136:137], v234 offset:20608
    ds_read_b64_tr_b16 a[138:139], v234 offset:23168
    v_mfma_f32_16x16x32_bf16 v[44:47], v[72:75], a[116:119], v[44:47]
    buffer_load_dwordx4 v247, s[20:23], 0 offen offset:1024 lds
    v_mfma_f32_16x16x32_bf16 v[24:27], a[116:119], a[16:19], v[24:27]
    s_waitcnt lgkmcnt(8)
    ds_read_b64_tr_b16 a[80:81], v235 offset:20480
    ds_read_b64_tr_b16 a[82:83], v235 offset:23040
    v_mfma_f32_16x16x32_bf16 v[24:27], a[120:123], a[20:23], v[24:27]
    s_waitcnt lgkmcnt(8)
    ds_read_b64_tr_b16 a[84:85], v236 offset:20480
    ds_read_b64_tr_b16 a[86:87], v236 offset:23040
    v_mfma_f32_16x16x32_bf16 v[48:51], v[72:75], a[124:127], v[48:51]
    ds_read_b64_tr_b16 a[88:89], v235 offset:20512
    ds_read_b64_tr_b16 a[90:91], v235 offset:23072
    v_mfma_f32_16x16x32_bf16 v[28:31], a[124:127], a[16:19], v[28:31]
    s_waitcnt lgkmcnt(10)
    ds_read_b64_tr_b16 a[92:93], v236 offset:20512
    ds_read_b64_tr_b16 a[94:95], v236 offset:23072
    v_mfma_f32_16x16x32_bf16 v[28:31], a[128:131], a[20:23], v[28:31]
    s_waitcnt lgkmcnt(10)
    buffer_load_dwordx4 v248, s[20:23], 0 offen offset:2048 lds
    v_mfma_f32_16x16x32_bf16 v[52:55], v[72:75], a[132:135], v[52:55]
    ds_read_b64_tr_b16 a[96:97], v235 offset:20544
    ds_read_b64_tr_b16 a[98:99], v235 offset:23104
    v_mfma_f32_16x16x32_bf16 v[32:35], a[132:135], a[16:19], v[32:35]
    s_waitcnt lgkmcnt(10)
    ds_read_b64_tr_b16 a[100:101], v236 offset:20544
    ds_read_b64_tr_b16 a[102:103], v236 offset:23104
    v_mfma_f32_16x16x32_bf16 v[32:35], a[136:139], a[20:23], v[32:35]
    s_waitcnt lgkmcnt(10)
    buffer_load_dwordx4 v249, s[20:23], 0 offen offset:3072 lds
    v_mfma_f32_16x16x32_bf16 v[16:19], a[80:83], a[24:27], v[16:19]
    s_waitcnt lgkmcnt(8)
    ds_read_b64_tr_b16 a[104:105], v235 offset:20576
    ds_read_b64_tr_b16 a[106:107], v235 offset:23136
    v_mfma_f32_16x16x32_bf16 v[16:19], a[84:87], a[28:31], v[16:19]
    s_waitcnt lgkmcnt(8)
    ds_read_b64_tr_b16 a[108:109], v236 offset:20576
    ds_read_b64_tr_b16 a[110:111], v236 offset:23136
    v_mfma_f32_16x16x32_bf16 v[20:23], a[88:91], a[24:27], v[20:23]
    s_waitcnt lgkmcnt(8)
    ds_read_b64_tr_b16 a[112:113], v235 offset:20608
    ds_read_b64_tr_b16 a[114:115], v235 offset:23168
    v_mfma_f32_16x16x32_bf16 v[20:23], a[92:95], a[28:31], v[20:23]
    s_waitcnt lgkmcnt(8)
    s_add_u32 m0, m0, 4096
    s_nop 0
    buffer_load_dwordx4 v250, s[20:23], 0 offen lds
    v_mfma_f32_16x16x32_bf16 v[24:27], a[96:99], a[24:27], v[24:27]
    s_waitcnt lgkmcnt(6)
    ds_read_b64_tr_b16 a[116:117], v236 offset:20608
    ds_read_b64_tr_b16 a[118:119], v236 offset:23168
    v_mfma_f32_16x16x32_bf16 v[24:27], a[100:103], a[28:31], v[24:27]
    s_waitcnt lgkmcnt(6)
    s_waitcnt vmcnt(11)
    s_barrier
    ds_read_b64_tr_b16 a[120:121], v237 offset:0
    ds_read_b64_tr_b16 a[122:123], v237 offset:2560
    v_mfma_f32_16x16x32_bf16 v[28:31], a[104:107], a[24:27], v[28:31]
    s_waitcnt lgkmcnt(6)
    ds_read_b64_tr_b16 a[124:125], v238 offset:0
    ds_read_b64_tr_b16 a[126:127], v238 offset:2560
    v_mfma_f32_16x16x32_bf16 v[28:31], a[108:111], a[28:31], v[28:31]
    s_waitcnt lgkmcnt(6)
    s_lshl_b32 s0, s32, 12
    s_add_u32 m0, s0, 81920
    s_nop 0
    buffer_load_dwordx4 v254, s[4:7], 0 offen offset:0 lds
    v_mfma_f32_16x16x32_bf16 v[32:35], a[112:115], a[24:27], v[32:35]
    s_waitcnt lgkmcnt(4)
    ds_read_b64_tr_b16 a[128:129], v237 offset:32
    ds_read_b64_tr_b16 a[130:131], v237 offset:2592
    v_mfma_f32_16x16x32_bf16 v[32:35], a[116:119], a[28:31], v[32:35]
    s_waitcnt lgkmcnt(4)
    ds_read_b64_tr_b16 a[132:133], v238 offset:32
    ds_read_b64_tr_b16 a[134:135], v238 offset:2592
    v_mfma_f32_16x16x32_bf16 v[36:39], v[72:75], a[120:123], v[36:39]
    ds_read_b64_tr_b16 a[136:137], v237 offset:64
    ds_read_b64_tr_b16 a[138:139], v237 offset:2624
    v_mfma_f32_16x16x32_bf16 v[16:19], a[120:123], a[32:35], v[16:19]
    s_waitcnt lgkmcnt(6)
    ds_read_b64_tr_b16 a[80:81], v238 offset:64
    ds_read_b64_tr_b16 a[82:83], v238 offset:2624
    v_mfma_f32_16x16x32_bf16 v[16:19], a[124:127], a[36:39], v[16:19]
    s_waitcnt lgkmcnt(6)
    s_add_u32 s4, s4, 23552
    s_addc_u32 s5, s5, 0
    buffer_load_dwordx4 v254, s[4:7], 0 offen offset:1024 lds
    v_mfma_f32_16x16x32_bf16 v[40:43], v[72:75], a[128:131], v[40:43]
    ds_read_b64_tr_b16 a[84:85], v237 offset:96
    ds_read_b64_tr_b16 a[86:87], v237 offset:2656
    v_mfma_f32_16x16x32_bf16 v[20:23], a[128:131], a[32:35], v[20:23]
    s_waitcnt lgkmcnt(6)
    ds_read_b64_tr_b16 a[88:89], v238 offset:96
    ds_read_b64_tr_b16 a[90:91], v238 offset:2656
    v_mfma_f32_16x16x32_bf16 v[20:23], a[132:135], a[36:39], v[20:23]
    s_waitcnt lgkmcnt(6)
    s_add_u32 s4, s4, 23552
    s_addc_u32 s5, s5, 0
    buffer_load_dwordx4 v254, s[4:7], 0 offen offset:2048 lds
    v_mfma_f32_16x16x32_bf16 v[44:47], v[72:75], a[136:139], v[44:47]
    ds_read_b64_tr_b16 a[92:93], v237 offset:128
    ds_read_b64_tr_b16 a[94:95], v237 offset:2688
    v_mfma_f32_16x16x32_bf16 v[24:27], a[136:139], a[32:35], v[24:27]
    s_waitcnt lgkmcnt(6)
    ds_read_b64_tr_b16 a[96:97], v238 offset:128
    ds_read_b64_tr_b16 a[98:99], v238 offset:2688
    v_mfma_f32_16x16x32_bf16 v[24:27], a[80:83], a[36:39], v[24:27]
    s_waitcnt lgkmcnt(6)
    ds_read_b64_tr_b16 a[100:101], v239 offset:0
    ds_read_b64_tr_b16 a[102:103], v239 offset:2560
    v_mfma_f32_16x16x32_bf16 v[48:51], v[72:75], a[84:87], v[48:51]
    s_add_u32 s4, s4, 23552
    s_addc_u32 s5, s5, 0
    buffer_load_dwordx4 v254, s[4:7], 0 offen offset:3072 lds
    v_mfma_f32_16x16x32_bf16 v[28:31], a[84:87], a[32:35], v[28:31]
    s_waitcnt lgkmcnt(6)
    ds_read_b64_tr_b16 a[104:105], v240 offset:0
    ds_read_b64_tr_b16 a[106:107], v240 offset:2560
    v_mfma_f32_16x16x32_bf16 v[28:31], a[88:91], a[36:39], v[28:31]
    s_waitcnt lgkmcnt(6)
    ds_read_b64_tr_b16 a[108:109], v239 offset:32
    ds_read_b64_tr_b16 a[110:111], v239 offset:2592
    v_mfma_f32_16x16x32_bf16 v[52:55], v[72:75], a[92:95], v[52:55]
    ds_read_b64_tr_b16 a[112:113], v240 offset:32
    ds_read_b64_tr_b16 a[114:115], v240 offset:2592
    v_mfma_f32_16x16x32_bf16 v[32:35], a[92:95], a[32:35], v[32:35]
    s_waitcnt lgkmcnt(8)
    ds_read_b64_tr_b16 a[116:117], v239 offset:64
    ds_read_b64_tr_b16 a[118:119], v239 offset:2624
    v_mfma_f32_16x16x32_bf16 v[32:35], a[96:99], a[36:39], v[32:35]
    s_waitcnt lgkmcnt(8)
    ds_read_b64_tr_b16 a[120:121], v240 offset:64
    ds_read_b64_tr_b16 a[122:123], v240 offset:2624
    v_mfma_f32_16x16x32_bf16 v[16:19], a[100:103], a[40:43], v[16:19]
    s_waitcnt lgkmcnt(8)
    ds_read_b64_tr_b16 a[124:125], v239 offset:96
    ds_read_b64_tr_b16 a[126:127], v239 offset:2656
    v_mfma_f32_16x16x32_bf16 v[16:19], a[104:107], a[44:47], v[16:19]
    s_waitcnt lgkmcnt(8)
    ds_read_b64_tr_b16 a[128:129], v240 offset:96
    ds_read_b64_tr_b16 a[130:131], v240 offset:2656
    v_mfma_f32_16x16x32_bf16 v[20:23], a[108:111], a[40:43], v[20:23]
    s_waitcnt lgkmcnt(8)
    ds_read_b64_tr_b16 a[132:133], v239 offset:128
    ds_read_b64_tr_b16 a[134:135], v239 offset:2688
    v_mfma_f32_16x16x32_bf16 v[20:23], a[112:115], a[44:47], v[20:23]
    s_waitcnt lgkmcnt(8)
    ds_read_b64_tr_b16 a[136:137], v240 offset:128
    ds_read_b64_tr_b16 a[138:139], v240 offset:2688
    v_mfma_f32_16x16x32_bf16 v[24:27], a[116:119], a[40:43], v[24:27]
    s_waitcnt lgkmcnt(8)
    s_waitcnt vmcnt(10)
    s_barrier
    ds_read_b64_tr_b16 a[80:81], v237 offset:5120
    ds_read_b64_tr_b16 a[82:83], v237 offset:7680
    v_mfma_f32_16x16x32_bf16 v[24:27], a[120:123], a[44:47], v[24:27]
    s_waitcnt lgkmcnt(8)
    ds_read_b64_tr_b16 a[84:85], v238 offset:5120
    ds_read_b64_tr_b16 a[86:87], v238 offset:7680
    v_mfma_f32_16x16x32_bf16 v[28:31], a[124:127], a[40:43], v[28:31]
    s_waitcnt lgkmcnt(8)
    ds_read_b64_tr_b16 a[88:89], v237 offset:5152
    ds_read_b64_tr_b16 a[90:91], v237 offset:7712
    v_mfma_f32_16x16x32_bf16 v[28:31], a[128:131], a[44:47], v[28:31]
    s_waitcnt lgkmcnt(8)
    ds_read_b64_tr_b16 a[92:93], v238 offset:5152
    ds_read_b64_tr_b16 a[94:95], v238 offset:7712
    v_mfma_f32_16x16x32_bf16 v[32:35], a[132:135], a[40:43], v[32:35]
    s_waitcnt lgkmcnt(8)
    ds_read_b64_tr_b16 a[96:97], v237 offset:5184
    ds_read_b64_tr_b16 a[98:99], v237 offset:7744
    v_mfma_f32_16x16x32_bf16 v[32:35], a[136:139], a[44:47], v[32:35]
    s_waitcnt lgkmcnt(8)
    ds_read_b64_tr_b16 a[100:101], v238 offset:5184
    ds_read_b64_tr_b16 a[102:103], v238 offset:7744
    v_mfma_f32_16x16x32_bf16 v[36:39], v[72:75], a[80:83], v[36:39]
    ds_read_b64_tr_b16 a[104:105], v237 offset:5216
    ds_read_b64_tr_b16 a[106:107], v237 offset:7776
    v_mfma_f32_16x16x32_bf16 v[16:19], a[80:83], a[48:51], v[16:19]
    s_waitcnt lgkmcnt(10)
    ds_read_b64_tr_b16 a[108:109], v238 offset:5216
    ds_read_b64_tr_b16 a[110:111], v238 offset:7776
    v_mfma_f32_16x16x32_bf16 v[16:19], a[84:87], a[52:55], v[16:19]
    s_waitcnt lgkmcnt(10)
    ds_read_b64_tr_b16 a[112:113], v237 offset:5248
    ds_read_b64_tr_b16 a[114:115], v237 offset:7808
    v_mfma_f32_16x16x32_bf16 v[40:43], v[72:75], a[88:91], v[40:43]
    ds_read_b64_tr_b16 a[116:117], v238 offset:5248
    ds_read_b64_tr_b16 a[118:119], v238 offset:7808
    v_mfma_f32_16x16x32_bf16 v[20:23], a[88:91], a[48:51], v[20:23]
    s_waitcnt lgkmcnt(12)
    ds_read_b64_tr_b16 a[120:121], v239 offset:5120
    ds_read_b64_tr_b16 a[122:123], v239 offset:7680
    v_mfma_f32_16x16x32_bf16 v[20:23], a[92:95], a[52:55], v[20:23]
    s_waitcnt lgkmcnt(12)
    ds_read_b64_tr_b16 a[124:125], v240 offset:5120
    ds_read_b64_tr_b16 a[126:127], v240 offset:7680
    v_mfma_f32_16x16x32_bf16 v[44:47], v[72:75], a[96:99], v[44:47]
    ds_read_b64_tr_b16 a[128:129], v239 offset:5152
    ds_read_b64_tr_b16 a[130:131], v239 offset:7712
    v_mfma_f32_16x16x32_bf16 v[24:27], a[96:99], a[48:51], v[24:27]
    s_waitcnt lgkmcnt(14)
    ds_read_b64_tr_b16 a[132:133], v240 offset:5152
    ds_read_b64_tr_b16 a[134:135], v240 offset:7712
    v_mfma_f32_16x16x32_bf16 v[24:27], a[100:103], a[52:55], v[24:27]
    s_waitcnt lgkmcnt(14)
    ds_read_b64_tr_b16 a[136:137], v239 offset:5184
    ds_read_b64_tr_b16 a[138:139], v239 offset:7744
L_warm0_1:
L_warm0_3:
    s_cbranch_execz L_warm0_ret
    v_mfma_f32_16x16x32_bf16 v[48:51], v[72:75], a[104:107], v[48:51]
    ds_read_b64_tr_b16 a[80:81], v240 offset:5184
    ds_read_b64_tr_b16 a[82:83], v240 offset:7744
    v_mfma_f32_16x16x32_bf16 v[28:31], a[104:107], a[48:51], v[28:31]
    s_waitcnt lgkmcnt(15)
    ds_read_b64_tr_b16 a[84:85], v239 offset:5216
    ds_read_b64_tr_b16 a[86:87], v239 offset:7776
    v_mfma_f32_16x16x32_bf16 v[28:31], a[108:111], a[52:55], v[28:31]
    s_waitcnt lgkmcnt(15)
    ds_read_b64_tr_b16 a[88:89], v240 offset:5216
    ds_read_b64_tr_b16 a[90:91], v240 offset:7776
    v_mfma_f32_16x16x32_bf16 v[52:55], v[72:75], a[112:115], v[52:55]
    ds_read_b64_tr_b16 a[92:93], v239 offset:5248
    ds_read_b64_tr_b16 a[94:95], v239 offset:7808
    v_mfma_f32_16x16x32_bf16 v[32:35], a[112:115], a[48:51], v[32:35]
    s_waitcnt lgkmcnt(15)
    ds_read_b64_tr_b16 a[96:97], v240 offset:5248
    ds_read_b64_tr_b16 a[98:99], v240 offset:7808
    v_mfma_f32_16x16x32_bf16 v[32:35], a[116:119], a[52:55], v[32:35]
    s_waitcnt lgkmcnt(15)
    s_waitcnt vmcnt(4)
    s_barrier
    ds_read_b64_tr_b16 a[100:101], v237 offset:10240
    ds_read_b64_tr_b16 a[102:103], v237 offset:12800
    v_mfma_f32_16x16x32_bf16 v[16:19], a[120:123], a[56:59], v[16:19]
    s_waitcnt lgkmcnt(15)
    ds_read_b64_tr_b16 a[104:105], v238 offset:10240
    ds_read_b64_tr_b16 a[106:107], v238 offset:12800
    v_mfma_f32_16x16x32_bf16 v[16:19], a[124:127], a[60:63], v[16:19]
    s_waitcnt lgkmcnt(15)
    ds_read_b64_tr_b16 a[108:109], v237 offset:10272
    ds_read_b64_tr_b16 a[110:111], v237 offset:12832
    v_mfma_f32_16x16x32_bf16 v[20:23], a[128:131], a[56:59], v[20:23]
    s_waitcnt lgkmcnt(15)
    ds_read_b64_tr_b16 a[112:113], v238 offset:10272
    ds_read_b64_tr_b16 a[114:115], v238 offset:12832
    v_mfma_f32_16x16x32_bf16 v[20:23], a[132:135], a[60:63], v[20:23]
    s_waitcnt lgkmcnt(15)
    ds_read_b64_tr_b16 a[116:117], v237 offset:10304
    ds_read_b64_tr_b16 a[118:119], v237 offset:12864
    v_mfma_f32_16x16x32_bf16 v[24:27], a[136:139], a[56:59], v[24:27]
    s_waitcnt lgkmcnt(15)
    ds_read_b64_tr_b16 a[120:121], v238 offset:10304
    ds_read_b64_tr_b16 a[122:123], v238 offset:12864
    v_mfma_f32_16x16x32_bf16 v[24:27], a[80:83], a[60:63], v[24:27]
    s_waitcnt lgkmcnt(15)
    ds_read_b64_tr_b16 a[124:125], v237 offset:10336
    ds_read_b64_tr_b16 a[126:127], v237 offset:12896
    v_mfma_f32_16x16x32_bf16 v[28:31], a[84:87], a[56:59], v[28:31]
    s_waitcnt lgkmcnt(15)
    ds_read_b64_tr_b16 a[128:129], v238 offset:10336
    ds_read_b64_tr_b16 a[130:131], v238 offset:12896
    v_mfma_f32_16x16x32_bf16 v[28:31], a[88:91], a[60:63], v[28:31]
    s_waitcnt lgkmcnt(15)
    ds_read_b64_tr_b16 a[132:133], v237 offset:10368
    ds_read_b64_tr_b16 a[134:135], v237 offset:12928
    v_mfma_f32_16x16x32_bf16 v[32:35], a[92:95], a[56:59], v[32:35]
    s_waitcnt lgkmcnt(15)
    ds_read_b64_tr_b16 a[136:137], v238 offset:10368
    ds_read_b64_tr_b16 a[138:139], v238 offset:12928
    v_mfma_f32_16x16x32_bf16 v[32:35], a[96:99], a[60:63], v[32:35]
    s_waitcnt lgkmcnt(15)
    ds_read_b64_tr_b16 a[80:81], v239 offset:10240
    ds_read_b64_tr_b16 a[82:83], v239 offset:12800
    v_mfma_f32_16x16x32_bf16 v[36:39], v[72:75], a[100:103], v[36:39]
    ds_read_b64_tr_b16 a[84:85], v240 offset:10240
    ds_read_b64_tr_b16 a[86:87], v240 offset:12800
    v_mfma_f32_16x16x32_bf16 v[16:19], a[100:103], a[64:67], v[16:19]
    s_waitcnt lgkmcnt(15)
    s_mul_i32 s35, s36, 90112
    s_add_u32 s35, s35, 0
    s_add_u32 s24, s58, s35
    s_addc_u32 s25, s59, 0
    v_mfma_f32_16x16x32_bf16 v[16:19], a[104:107], a[68:71], v[16:19]
    s_waitcnt lgkmcnt(15)
    ds_read_b64_tr_b16 a[88:89], v239 offset:10272
    ds_read_b64_tr_b16 a[90:91], v239 offset:12832
    v_mfma_f32_16x16x32_bf16 v[40:43], v[72:75], a[108:111], v[40:43]
    ds_read_b64_tr_b16 a[92:93], v240 offset:10272
    ds_read_b64_tr_b16 a[94:95], v240 offset:12832
    v_mfma_f32_16x16x32_bf16 v[20:23], a[108:111], a[64:67], v[20:23]
    s_waitcnt lgkmcnt(15)
    s_mov_b32 s26, 5632
    s_mov_b32 s27, 0x20000
    v_mfma_f32_16x16x32_bf16 v[20:23], a[112:115], a[68:71], v[20:23]
    s_waitcnt lgkmcnt(15)
    ds_read_b64_tr_b16 a[96:97], v239 offset:10304
    ds_read_b64_tr_b16 a[98:99], v239 offset:12864
    v_mfma_f32_16x16x32_bf16 v[44:47], v[72:75], a[116:119], v[44:47]
    ds_read_b64_tr_b16 a[100:101], v240 offset:10304
    ds_read_b64_tr_b16 a[102:103], v240 offset:12864
    v_mfma_f32_16x16x32_bf16 v[24:27], a[116:119], a[64:67], v[24:27]
    s_waitcnt lgkmcnt(15)
    v_mfma_f32_16x16x32_bf16 v[24:27], a[120:123], a[68:71], v[24:27]
    s_waitcnt lgkmcnt(15)
    ds_read_b64_tr_b16 a[104:105], v239 offset:10336
    ds_read_b64_tr_b16 a[106:107], v239 offset:12896
    v_mfma_f32_16x16x32_bf16 v[48:51], v[72:75], a[124:127], v[48:51]
    ds_read_b64_tr_b16 a[108:109], v240 offset:10336
    ds_read_b64_tr_b16 a[110:111], v240 offset:12896
    v_mfma_f32_16x16x32_bf16 v[28:31], a[124:127], a[64:67], v[28:31]
    s_waitcnt lgkmcnt(15)
    v_mfma_f32_16x16x32_bf16 v[28:31], a[128:131], a[68:71], v[28:31]
    s_waitcnt lgkmcnt(15)
    ds_read_b64_tr_b16 a[112:113], v239 offset:10368
    ds_read_b64_tr_b16 a[114:115], v239 offset:12928
    v_mfma_f32_16x16x32_bf16 v[52:55], v[72:75], a[132:135], v[52:55]
    ds_read_b64_tr_b16 a[116:117], v240 offset:10368
    ds_read_b64_tr_b16 a[118:119], v240 offset:12928
    v_mfma_f32_16x16x32_bf16 v[32:35], a[132:135], a[64:67], v[32:35]
    s_waitcnt lgkmcnt(15)
    v_mfma_f32_16x16x32_bf16 v[32:35], a[136:139], a[68:71], v[32:35]
    s_waitcnt lgkmcnt(15)
    v_mfma_f32_16x16x32_bf16 v[16:19], a[80:83], a[72:75], v[16:19]
    s_waitcnt lgkmcnt(15)
    ds_write_b32 v209, v36 offset:0
    v_mfma_f32_16x16x32_bf16 v[16:19], a[84:87], a[76:79], v[16:19]
    s_waitcnt lgkmcnt(15)
    ds_write_b32 v209, v40 offset:64
    v_mfma_f32_16x16x32_bf16 v[20:23], a[88:91], a[72:75], v[20:23]
    s_waitcnt lgkmcnt(14)
    ds_write_b32 v209, v44 offset:128
    v_mfma_f32_16x16x32_bf16 v[20:23], a[92:95], a[76:79], v[20:23]
    s_waitcnt lgkmcnt(13)
    ds_write_b32 v209, v48 offset:192
    v_mfma_f32_16x16x32_bf16 v[24:27], a[96:99], a[72:75], v[24:27]
    s_waitcnt lgkmcnt(12)
    ds_write_b32 v209, v52 offset:256
    v_mfma_f32_16x16x32_bf16 v[24:27], a[100:103], a[76:79], v[24:27]
    s_waitcnt lgkmcnt(11)
    v_mfma_f32_16x16x32_bf16 v[28:31], a[104:107], a[72:75], v[28:31]
    s_waitcnt lgkmcnt(9)
    v_mfma_f32_16x16x32_bf16 v[28:31], a[108:111], a[76:79], v[28:31]
    s_waitcnt lgkmcnt(7)
    v_mfma_f32_16x16x32_bf16 v[32:35], a[112:115], a[72:75], v[32:35]
    s_waitcnt lgkmcnt(5)
    s_waitcnt lgkmcnt(0)
    s_barrier
    ds_read_b32 v36, v210 offset:0
    ds_read_b32 v40, v210 offset:64
    v_mfma_f32_16x16x32_bf16 v[32:35], a[116:119], a[76:79], v[32:35]
    ds_read_b32 v44, v210 offset:128
    ds_read_b32 v48, v210 offset:192
    ds_read_b32 v52, v210 offset:256
    buffer_load_dwordx2 v[200:201], v211, s[28:31], s57 offen sc1
    s_waitcnt lgkmcnt(0)
    v_mfma_f32_16x16x4_f32 v[16:19], v36, v76, v[16:19]
    v_mfma_f32_16x16x4_f32 v[20:23], v40, v76, v[20:23]
    v_mfma_f32_16x16x4_f32 v[24:27], v44, v76, v[24:27]
    v_mfma_f32_16x16x4_f32 v[28:31], v48, v76, v[28:31]
    v_mfma_f32_16x16x4_f32 v[32:35], v52, v76, v[32:35]
    s_add_u32 s16, s58, 11993088
    s_addc_u32 s17, s59, 0
    s_mov_b32 s18, 2064384
    s_lshl_b32 s40, s61, 12
    s_add_u32 s39, s40, 11993088
    s_cmp_ge_u32 s61, 960
    s_cselect_b32 s39, 18710528, s39
    s_add_u32 s40, s40, 15925248
    v_mul_f32 v16, v78, v16
    v_mul_f32 v17, v78, v17
    v_mul_f32 v18, v78, v18
    v_mul_f32 v19, v78, v19
    v_cvt_pk_bf16_f32 v16, v16, v17
    v_cvt_pk_bf16_f32 v17, v18, v19
    ds_write_b64 v204, v[16:17] offset:0
    v_mul_f32 v20, v78, v20
    v_mul_f32 v21, v78, v21
    v_mul_f32 v22, v78, v22
    v_mul_f32 v23, v78, v23
    v_cvt_pk_bf16_f32 v20, v20, v21
    v_cvt_pk_bf16_f32 v21, v22, v23
    ds_write_b64 v204, v[20:21] offset:32
    v_mul_f32 v24, v78, v24
    v_mul_f32 v25, v78, v25
    v_mul_f32 v26, v78, v26
    v_mul_f32 v27, v78, v27
    v_cvt_pk_bf16_f32 v24, v24, v25
    v_cvt_pk_bf16_f32 v25, v26, v27
    ds_write_b64 v204, v[24:25] offset:64
    v_mul_f32 v28, v78, v28
    v_mul_f32 v29, v78, v29
    v_mul_f32 v30, v78, v30
    v_mul_f32 v31, v78, v31
    v_cvt_pk_bf16_f32 v28, v28, v29
    v_cvt_pk_bf16_f32 v29, v30, v31
    ds_write_b64 v204, v[28:29] offset:96
    v_mul_f32 v32, v78, v32
    v_mul_f32 v33, v78, v33
    v_mul_f32 v34, v78, v34
    v_mul_f32 v35, v78, v35
    v_cvt_pk_bf16_f32 v32, v32, v33
    v_cvt_pk_bf16_f32 v33, v34, v35
    ds_write_b64 v204, v[32:33] offset:128
    s_cmp_lg_u32 s32, 0
    s_cbranch_scc1 L_s1_ok
    s_waitcnt vmcnt(0)
    v_and_b32 v200, v200, v201
    v_cmp_eq_u32 vcc, 0, v200
    s_nop 0
    s_cmp_eq_u64 vcc, 0
    s_cbranch_scc1 L_s1_ok
    s_mov_b32 s60, 200000
L_s1_spin:
    buffer_load_dwordx2 v[200:201], v211, s[28:31], s57 offen sc1
    s_sub_u32 s60, s60, 1
    s_waitcnt vmcnt(0)
    v_and_b32 v200, v200, v201
    v_cmp_eq_u32 vcc, 0, v200
    s_nop 0
    s_cmp_eq_u64 vcc, 0
    s_cbranch_scc1 L_s1_ok
    s_cmp_lg_u32 s60, 0
    s_cbranch_scc1 L_s1_spin
L_s1_ok:
    s_waitcnt lgkmcnt(0)
    s_barrier
    buffer_load_dwordx4 v[168:171], v4, s[24:27], 0 offen
    buffer_load_dwordx4 v[172:175], v4, s[24:27], 0 offen offset:1024
    buffer_load_dwordx2 v[176:177], v5, s[24:27], 0 offen offset:2048
    ds_read2_b64 v[144:147], v206 offset0:0 offset1:1
    ds_read2_b64 v[148:151], v206 offset0:5 offset1:6
    ds_read2_b64 v[152:155], v205 offset0:4 offset1:9
    ds_read2_b64 v[156:159], v208 offset0:0 offset1:1
    ds_read2_b64 v[160:163], v208 offset0:5 offset1:6
    ds_read2_b64 v[164:167], v207 offset0:4 offset1:9
    buffer_load_dwordx4 v[178:181], v6, s[24:27], 0 offen offset:0
    buffer_load_dwordx4 v[182:185], v6, s[24:27], 0 offen offset:768
    buffer_load_dwordx4 v[186:189], v6, s[24:27], 0 offen offset:1536
    buffer_load_dwordx4 v[190:193], v6, s[24:27], 0 offen offset:2304
    s_add_u32 s24, s24, 5632
    s_addc_u32 s25, s25, 0
    s_getreg_b32 s10, hwreg(HW_REG_XCC_ID, 0, 4)
    s_add_u32 s10, s10, 1
    s_lshl2_add_u32 s35, s15, s3
    s_cmp_lg_u32 s32, 0
    s_cselect_b32 s35, 18710528, s35
    v_mov_b32 v14, s10
    s_waitcnt lgkmcnt(0)
    s_mov_b64 exec, 0
    s_cmp_eq_u32 s32, 0
    s_cbranch_scc1 L_warm1_0
    s_cmp_eq_u32 s32, 1
    s_cbranch_scc1 L_warm1_1
    s_cmp_eq_u32 s32, 2
    s_cbranch_scc1 L_warm1_2
    s_branch L_warm1_3
L_warm1_ret:
    s_mov_b64 exec, -1
    s_waitcnt vmcnt(4)
    v_mfma_f32_32x32x4bf16_1k v[16:47], v[176:177], v[152:153], 0
    buffer_load_dwordx4 v[194:197], v4, s[24:27], 0 offen
    buffer_load_dwordx4 v[198:201], v4, s[24:27], 0 offen offset:1024
    buffer_load_dwordx2 v[202:203], v5, s[24:27], 0 offen offset:2048
    buffer_load_dwordx4 v[204:207], v6, s[24:27], 0 offen offset:0
    buffer_load_dwordx4 v[208:211], v6, s[24:27], 0 offen offset:768
    buffer_load_dwordx4 v[212:215], v6, s[24:27], 0 offen offset:1536
    buffer_load_dwordx4 v[216:219], v6, s[24:27], 0 offen offset:2304
    s_add_u32 s24, s24, 5632
    s_addc_u32 s25, s25, 0
    s_nop 8
    v_mfma_f32_32x32x16_bf16 v[16:31], v[168:171], v[144:147], v[16:31]
    v_mfma_f32_32x32x16_bf16 v[32:47], v[172:175], v[144:147], v[32:47]
    s_waitcnt vmcnt(7)
    s_nop 9
    v_exp_f32 v16, v16
    v_exp_f32 v17, v17
    v_exp_f32 v18, v18
    v_exp_f32 v19, v19
    v_exp_f32 v20, v20
    v_mfma_f32_32x32x4bf16_1k v[48:79], v[176:177], v[154:155], 0
    v_exp_f32 v21, v21
    v_exp_f32 v22, v22
    v_exp_f32 v23, v23
    v_exp_f32 v24, v24
    v_exp_f32 v25, v25
    v_exp_f32 v26, v26
    v_exp_f32 v27, v27
    v_exp_f32 v28, v28
    v_exp_f32 v29, v29
    v_exp_f32 v30, v30
    v_smfmac_f32_32x32x32_bf16 v[80:95], v[178:181], v[16:23], v15
    s_waitcnt vmcnt(15)
    ds_read_b64_tr_b16 a[224:225], v255 offset:0
    v_exp_f32 v31, v31
    v_exp_f32 v32, v32
    v_exp_f32 v33, v33
    v_smfmac_f32_32x32x32_bf16 v[80:95], v[182:185], v[24:31], v15
    buffer_load_dwordx4 v[220:223], v4, s[24:27], 0 offen
    buffer_load_dwordx4 v[224:227], v4, s[24:27], 0 offen offset:1024
    buffer_load_dwordx2 v[228:229], v5, s[24:27], 0 offen offset:2048
    v_exp_f32 v34, v34
    v_exp_f32 v35, v35
    v_exp_f32 v36, v36
    v_mfma_f32_32x32x16_bf16 v[48:63], v[168:171], v[148:151], v[48:63]
    ds_read_b64_tr_b16 a[226:227], v255 offset:512
    v_exp_f32 v37, v37
    v_exp_f32 v38, v38
    v_exp_f32 v39, v39
    v_mfma_f32_32x32x16_bf16 v[64:79], v[172:175], v[148:151], v[64:79]
    ds_read_b64_tr_b16 a[228:229], v255 offset:32
    v_exp_f32 v40, v40
    v_exp_f32 v41, v41
    v_exp_f32 v42, v42
    v_exp_f32 v43, v43
    v_exp_f32 v44, v44
    v_exp_f32 v45, v45
    v_exp_f32 v46, v46
    v_smfmac_f32_32x32x32_bf16 v[80:95], v[186:189], v[32:39], v15
    ds_read_b64_tr_b16 a[230:231], v255 offset:544
    v_exp_f32 v47, v47
    v_exp_f32 v48, v48
    v_exp_f32 v49, v49
    v_smfmac_f32_32x32x32_bf16 v[80:95], v[190:193], v[40:47], v15
    ds_read_b64_tr_b16 a[232:233], v255 offset:64
    v_exp_f32 v50, v50
    v_exp_f32 v51, v51
    v_exp_f32 v52, v52
    v_mfma_f32_32x32x4bf16_1k v[16:47], v[176:177], v[164:165], 0
    v_exp_f32 v53, v53
    v_exp_f32 v54, v54
    v_exp_f32 v55, v55
    v_exp_f32 v56, v56
    v_exp_f32 v57, v57
    v_exp_f32 v58, v58
    v_exp_f32 v59, v59
    v_exp_f32 v60, v60
    v_exp_f32 v61, v61
    v_exp_f32 v62, v62
    v_smfmac_f32_32x32x32_bf16 v[96:111], v[178:181], v[48:55], v15
    ds_read_b64_tr_b16 a[234:235], v255 offset:576
    v_exp_f32 v63, v63
    v_exp_f32 v64, v64
    v_exp_f32 v65, v65
    v_smfmac_f32_32x32x32_bf16 v[96:111], v[182:185], v[56:63], v15
    ds_read_b64_tr_b16 a[236:237], v255 offset:96
    v_exp_f32 v66, v66
    v_exp_f32 v67, v67
    v_exp_f32 v68, v68
    v_mfma_f32_32x32x16_bf16 v[16:31], v[168:171], v[156:159], v[16:31]
    ds_read_b64_tr_b16 a[238:239], v255 offset:608
    v_exp_f32 v69, v69
    v_exp_f32 v70, v70
    v_exp_f32 v71, v71
    v_mfma_f32_32x32x16_bf16 v[32:47], v[172:175], v[156:159], v[32:47]
    s_cmp_ge_u32 s61, 200
    s_cselect_b32 s4, s48, s52
    s_cselect_b32 s5, s49, s53
    s_cselect_b32 s0, 200, 0
    s_sub_u32 s0, s61, s0
    s_mul_i32 s1, s0, 6554
    v_exp_f32 v72, v72
    v_exp_f32 v73, v73
    v_exp_f32 v74, v74
    v_exp_f32 v75, v75
    v_exp_f32 v76, v76
    v_exp_f32 v77, v77
    v_exp_f32 v78, v78
    v_smfmac_f32_32x32x32_bf16 v[96:111], v[186:189], v[64:71], v15
    buffer_load_dwordx4 v[230:233], v6, s[24:27], 0 offen offset:0
    buffer_load_dwordx4 v[234:237], v6, s[24:27], 0 offen offset:768
    v_exp_f32 v79, v79
    v_exp_f32 v16, v16
    v_exp_f32 v17, v17
    v_smfmac_f32_32x32x32_bf16 v[96:111], v[190:193], v[72:79], v15
    s_waitcnt lgkmcnt(0)
    v_exp_f32 v18, v18
    v_exp_f32 v19, v19
    v_exp_f32 v20, v20
    v_mfma_f32_32x32x4bf16_1k v[48:79], v[176:177], v[166:167], 0
    v_exp_f32 v21, v21
    v_exp_f32 v22, v22
    v_exp_f32 v23, v23
    v_exp_f32 v24, v24
    v_exp_f32 v25, v25
    v_exp_f32 v26, v26
    v_exp_f32 v27, v27
    v_exp_f32 v28, v28
    v_exp_f32 v29, v29
    v_exp_f32 v30, v30
    v_smfmac_f32_32x32x32_bf16 v[112:127], v[178:181], v[16:23], v15
    buffer_store_dwordx4 a[224:227], v4, s[28:31], s39 offen offset:0 sc1
    buffer_store_dwordx4 a[228:231], v4, s[28:31], s39 offen offset:1024 sc1
    v_exp_f32 v31, v31
    v_exp_f32 v32, v32
    v_exp_f32 v33, v33
    v_smfmac_f32_32x32x32_bf16 v[112:127], v[182:185], v[24:31], v15
    s_lshr_b32 s1, s1, 16
    s_mul_i32 s6, s1, 10
    s_sub_u32 s0, s0, s6
    v_exp_f32 v34, v34
    v_exp_f32 v35, v35
    v_exp_f32 v36, v36
    v_mfma_f32_32x32x16_bf16 v[48:63], v[168:171], v[160:163], v[48:63]
    s_mul_i32 s1, s1, 40960
    s_lshl_b32 s0, s0, 7
    s_add_u32 s0, s0, s1
    v_exp_f32 v37, v37
    v_exp_f32 v38, v38
    v_exp_f32 v39, v39
    v_mfma_f32_32x32x16_bf16 v[64:79], v[172:175], v[160:163], v[64:79]
    s_and_b32 s5, s5, 0xffff
    s_cmp_lt_u32 s61, 680
    s_cselect_b32 s6, 12160, 0
    s_cselect_b32 s0, s0, 0
    s_add_u32 s4, s4, s0
    s_addc_u32 s5, s5, 0
    v_exp_f32 v40, v40
    v_exp_f32 v41, v41
    v_exp_f32 v42, v42
    v_exp_f32 v43, v43
    v_exp_f32 v44, v44
    v_exp_f32 v45, v45
    v_exp_f32 v46, v46
    v_smfmac_f32_32x32x32_bf16 v[112:127], v[186:189], v[32:39], v15
    buffer_load_dwordx4 v[238:241], v6, s[24:27], 0 offen offset:1536
    buffer_load_dwordx4 v[242:245], v6, s[24:27], 0 offen offset:2304
    v_exp_f32 v47, v47
    v_exp_f32 v48, v48
    v_exp_f32 v49, v49
    v_smfmac_f32_32x32x32_bf16 v[112:127], v[190:193], v[40:47], v15
    s_add_u32 s24, s24, 5632
    s_addc_u32 s25, s25, 0
    s_waitcnt vmcnt(13)
    v_exp_f32 v50, v50
    v_exp_f32 v51, v51
    v_exp_f32 v52, v52
    v_mfma_f32_32x32x4bf16_1k v[16:47], v[202:203], v[152:153], 0
    v_exp_f32 v53, v53
    v_exp_f32 v54, v54
    v_exp_f32 v55, v55
    v_exp_f32 v56, v56
    v_exp_f32 v57, v57
    v_exp_f32 v58, v58
    v_exp_f32 v59, v59
    v_exp_f32 v60, v60
    v_exp_f32 v61, v61
    v_exp_f32 v62, v62
    v_smfmac_f32_32x32x32_bf16 v[128:143], v[178:181], v[48:55], v15
    buffer_load_dwordx4 v[168:171], v4, s[24:27], 0 offen
    buffer_load_dwordx4 v[172:175], v4, s[24:27], 0 offen offset:1024
    buffer_load_dwordx2 v[176:177], v5, s[24:27], 0 offen offset:2048
    v_exp_f32 v63, v63
    v_exp_f32 v64, v64
    v_exp_f32 v65, v65
    v_smfmac_f32_32x32x32_bf16 v[128:143], v[182:185], v[56:63], v15
    buffer_store_dwordx4 a[232:235], v4, s[28:31], s39 offen offset:2048 sc1
    buffer_store_dwordx4 a[236:239], v4, s[28:31], s39 offen offset:3072 sc1
    v_exp_f32 v66, v66
    v_exp_f32 v67, v67
    v_exp_f32 v68, v68
    v_mfma_f32_32x32x16_bf16 v[16:31], v[194:197], v[144:147], v[16:31]
    s_mov_b32 s7, 0x20000
    v_exp_f32 v69, v69
    v_exp_f32 v70, v70
    v_exp_f32 v71, v71
    v_mfma_f32_32x32x16_bf16 v[32:47], v[198:201], v[144:147], v[32:47]
    v_exp_f32 v72, v72
    v_exp_f32 v73, v73
    v_exp_f32 v74, v74
    v_exp_f32 v75, v75
    v_exp_f32 v76, v76
    v_exp_f32 v77, v77
    v_exp_f32 v78, v78
    v_smfmac_f32_32x32x32_bf16 v[128:143], v[186:189], v[64:71], v15
    s_waitcnt vmcnt(14)
    v_exp_f32 v79, v79
    v_exp_f32 v16, v16
    v_exp_f32 v17, v17
    v_smfmac_f32_32x32x32_bf16 v[128:143], v[190:193], v[72:79], v15
    buffer_load_dwordx4 v[178:181], v6, s[24:27], 0 offen offset:0
    buffer_load_dwordx4 v[182:185], v6, s[24:27], 0 offen offset:768
    v_exp_f32 v18, v18
    v_exp_f32 v19, v19
    v_exp_f32 v20, v20
    v_mfma_f32_32x32x4bf16_1k v[48:79], v[202:203], v[154:155], 0
    v_exp_f32 v21, v21
    v_exp_f32 v22, v22
    v_exp_f32 v23, v23
    v_exp_f32 v24, v24
    v_exp_f32 v25, v25
    v_exp_f32 v26, v26
    v_exp_f32 v27, v27
    v_exp_f32 v28, v28
    v_exp_f32 v29, v29
    v_exp_f32 v30, v30
    v_smfmac_f32_32x32x32_bf16 v[80:95], v[204:207], v[16:23], v15
    s_and_b32 s9, s61, 31
    s_lshl_b32 s9, s9, 8
    v_exp_f32 v31, v31
    v_exp_f32 v32, v32
    v_exp_f32 v33, v33
    v_smfmac_f32_32x32x32_bf16 v[80:95], v[208:211], v[24:31], v15
    buffer_load_dwordx4 v[186:189], v6, s[24:27], 0 offen offset:1536
    buffer_load_dwordx4 v[190:193], v6, s[24:27], 0 offen offset:2304
    v_exp_f32 v34, v34
    v_exp_f32 v35, v35
    v_exp_f32 v36, v36
    v_mfma_f32_32x32x16_bf16 v[48:63], v[194:197], v[148:151], v[48:63]
    s_add_u32 s9, s9, 262144
    v_exp_f32 v37, v37
    v_exp_f32 v38, v38
    v_exp_f32 v39, v39
    v_mfma_f32_32x32x16_bf16 v[64:79], v[198:201], v[148:151], v[64:79]
    v_lshlrev_b32 v10, 2, v2
    v_exp_f32 v40, v40
    v_exp_f32 v41, v41
    v_exp_f32 v42, v42
    v_exp_f32 v43, v43
    v_exp_f32 v44, v44
    v_exp_f32 v45, v45
    v_exp_f32 v46, v46
    v_smfmac_f32_32x32x32_bf16 v[80:95], v[212:215], v[32:39], v15
    s_add_u32 s24, s24, 5632
    s_addc_u32 s25, s25, 0
    v_exp_f32 v47, v47
    v_exp_f32 v48, v48
    v_exp_f32 v49, v49
    v_smfmac_f32_32x32x32_bf16 v[80:95], v[216:219], v[40:47], v15
    s_lshl_b32 s0, s32, 12
    s_add_u32 m0, s0, 81920
    v_exp_f32 v50, v50
    v_exp_f32 v51, v51
    v_exp_f32 v52, v52
    v_mfma_f32_32x32x4bf16_1k v[16:47], v[202:203], v[164:165], 0
    v_exp_f32 v53, v53
    v_exp_f32 v54, v54
    v_exp_f32 v55, v55
    v_exp_f32 v56, v56
    v_exp_f32 v57, v57
    v_exp_f32 v58, v58
    v_exp_f32 v59, v59
    v_exp_f32 v60, v60
    v_exp_f32 v61, v61
    v_exp_f32 v62, v62
    v_smfmac_f32_32x32x32_bf16 v[96:111], v[204:207], v[48:55], v15
    buffer_load_dwordx4 v253, s[4:7], 0 offen offset:0 lds
    s_add_u32 s4, s4, 9216
    s_addc_u32 s5, s5, 0
    buffer_load_dwordx4 v253, s[4:7], 0 offen offset:1024 lds
    v_exp_f32 v63, v63
    v_exp_f32 v64, v64
    v_exp_f32 v65, v65
    v_smfmac_f32_32x32x32_bf16 v[96:111], v[208:211], v[56:63], v15
    v_lshrrev_b32 v11, 1, v1
    v_exp_f32 v66, v66
    v_exp_f32 v67, v67
    v_exp_f32 v68, v68
    v_mfma_f32_32x32x16_bf16 v[16:31], v[194:197], v[156:159], v[16:31]
    v_lshlrev_b32 v11, 8, v11
    v_exp_f32 v69, v69
    v_exp_f32 v70, v70
    v_exp_f32 v71, v71
    v_mfma_f32_32x32x16_bf16 v[32:47], v[198:201], v[156:159], v[32:47]
    s_mov_b32 s8, 262144
    v_exp_f32 v72, v72
    v_exp_f32 v73, v73
    v_exp_f32 v74, v74
    v_exp_f32 v75, v75
    v_exp_f32 v76, v76
    v_exp_f32 v77, v77
    v_exp_f32 v78, v78
    v_smfmac_f32_32x32x32_bf16 v[96:111], v[212:215], v[64:71], v15
    s_mov_b64 exec, 1
    buffer_store_dword v14, off, s[28:31], s35 sc1
    s_mov_b64 exec, -1
    v_exp_f32 v79, v79
    v_exp_f32 v16, v16
    v_exp_f32 v17, v17
    v_smfmac_f32_32x32x32_bf16 v[96:111], v[216:219], v[72:79], v15
    s_add_u32 s4, s4, 9216
    s_addc_u32 s5, s5, 0
    v_exp_f32 v18, v18
    v_exp_f32 v19, v19
    v_exp_f32 v20, v20
    v_mfma_f32_32x32x4bf16_1k v[48:79], v[202:203], v[166:167], 0
    v_exp_f32 v21, v21
    v_exp_f32 v22, v22
    v_exp_f32 v23, v23
    v_exp_f32 v24, v24
    v_exp_f32 v25, v25
    v_exp_f32 v26, v26
    v_exp_f32 v27, v27
    v_exp_f32 v28, v28
    v_exp_f32 v29, v29
    v_exp_f32 v30, v30
    v_smfmac_f32_32x32x32_bf16 v[112:127], v[204:207], v[16:23], v15
    buffer_load_dwordx4 v253, s[4:7], 0 offen offset:2048 lds
    s_add_u32 s4, s4, 9216
    s_addc_u32 s5, s5, 0
    buffer_load_dwordx4 v253, s[4:7], 0 offen offset:3072 lds
    v_exp_f32 v31, v31
    v_exp_f32 v32, v32
    v_exp_f32 v33, v33
    v_smfmac_f32_32x32x32_bf16 v[112:127], v[208:211], v[24:31], v15
    v_exp_f32 v34, v34
    v_exp_f32 v35, v35
    v_exp_f32 v36, v36
    v_mfma_f32_32x32x16_bf16 v[48:63], v[194:197], v[160:163], v[48:63]
    v_exp_f32 v37, v37
    v_exp_f32 v38, v38
    v_exp_f32 v39, v39
    v_mfma_f32_32x32x16_bf16 v[64:79], v[198:201], v[160:163], v[64:79]
    v_exp_f32 v40, v40
    v_exp_f32 v41, v41
    v_exp_f32 v42, v42
    v_exp_f32 v43, v43
    v_exp_f32 v44, v44
    v_exp_f32 v45, v45
    v_exp_f32 v46, v46
    v_smfmac_f32_32x32x32_bf16 v[112:127], v[212:215], v[32:39], v15
    v_exp_f32 v47, v47
    v_exp_f32 v48, v48
    v_exp_f32 v49, v49
    v_smfmac_f32_32x32x32_bf16 v[112:127], v[216:219], v[40:47], v15
    s_waitcnt vmcnt(20)
    v_exp_f32 v50, v50
    v_exp_f32 v51, v51
    v_exp_f32 v52, v52
    v_mfma_f32_32x32x4bf16_1k v[16:47], v[228:229], v[152:153], 0
    v_exp_f32 v53, v53
    v_exp_f32 v54, v54
    v_exp_f32 v55, v55
    v_exp_f32 v56, v56
    v_exp_f32 v57, v57
    v_exp_f32 v58, v58
    v_exp_f32 v59, v59
    v_exp_f32 v60, v60
    v_exp_f32 v61, v61
    v_exp_f32 v62, v62
    v_smfmac_f32_32x32x32_bf16 v[128:143], v[204:207], v[48:55], v15
    buffer_load_dwordx4 v[194:197], v4, s[24:27], 0 offen
    buffer_load_dwordx4 v[198:201], v4, s[24:27], 0 offen offset:1024
    buffer_load_dwordx2 v[202:203], v5, s[24:27], 0 offen offset:2048
    v_exp_f32 v63, v63
    v_exp_f32 v64, v64
    v_exp_f32 v65, v65
    v_smfmac_f32_32x32x32_bf16 v[128:143], v[208:211], v[56:63], v15
    v_exp_f32 v66, v66
    v_exp_f32 v67, v67
    v_exp_f32 v68, v68
    v_mfma_f32_32x32x16_bf16 v[16:31], v[220:223], v[144:147], v[16:31]
    v_exp_f32 v69, v69
    v_exp_f32 v70, v70
    v_exp_f32 v71, v71
    v_mfma_f32_32x32x16_bf16 v[32:47], v[224:227], v[144:147], v[32:47]
    v_exp_f32 v72, v72
    v_exp_f32 v73, v73
    v_exp_f32 v74, v74
    v_exp_f32 v75, v75
    v_exp_f32 v76, v76
    v_exp_f32 v77, v77
    v_exp_f32 v78, v78
    v_smfmac_f32_32x32x32_bf16 v[128:143], v[212:215], v[64:71], v15
    s_waitcnt vmcnt(17)
    v_exp_f32 v79, v79
    v_exp_f32 v16, v16
    v_exp_f32 v17, v17
    v_smfmac_f32_32x32x32_bf16 v[128:143], v[216:219], v[72:79], v15
    buffer_load_dwordx4 v[204:207], v6, s[24:27], 0 offen offset:0
    buffer_load_dwordx4 v[208:211], v6, s[24:27], 0 offen offset:768
    v_exp_f32 v18, v18
    v_exp_f32 v19, v19
    v_exp_f32 v20, v20
    v_mfma_f32_32x32x4bf16_1k v[48:79], v[228:229], v[154:155], 0
    v_exp_f32 v21, v21
    v_exp_f32 v22, v22
    v_exp_f32 v23, v23
    v_exp_f32 v24, v24
    v_exp_f32 v25, v25
    v_exp_f32 v26, v26
    v_exp_f32 v27, v27
    v_exp_f32 v28, v28
    v_exp_f32 v29, v29
    v_exp_f32 v30, v30
    v_smfmac_f32_32x32x32_bf16 v[80:95], v[230:233], v[16:23], v15
    s_waitcnt vmcnt(14)
    v_exp_f32 v31, v31
    v_exp_f32 v32, v32
    v_exp_f32 v33, v33
    v_smfmac_f32_32x32x32_bf16 v[80:95], v[234:237], v[24:31], v15
    buffer_load_dwordx4 v[212:215], v6, s[24:27], 0 offen offset:1536
    buffer_load_dwordx4 v[216:219], v6, s[24:27], 0 offen offset:2304
    s_mov_b64 exec, 1
    buffer_atomic_add v0, off, s[28:31], s9 offset:0 sc1
    s_mov_b64 exec, -1
    v_exp_f32 v34, v34
    v_exp_f32 v35, v35
    v_exp_f32 v36, v36
    v_mfma_f32_32x32x16_bf16 v[48:63], v[220:223], v[148:151], v[48:63]
    s_lshl_b32 s44, s33, 2
    v_exp_f32 v37, v37
    v_exp_f32 v38, v38
    v_exp_f32 v39, v39
    v_mfma_f32_32x32x16_bf16 v[64:79], v[224:227], v[148:151], v[64:79]
    s_lshl1_add_u32 s44, s37, s44
    v_exp_f32 v40, v40
    v_exp_f32 v41, v41
    v_exp_f32 v42, v42
    v_exp_f32 v43, v43
    v_exp_f32 v44, v44
    v_exp_f32 v45, v45
    v_exp_f32 v46, v46
    v_smfmac_f32_32x32x32_bf16 v[80:95], v[238:241], v[32:39], v15
    s_add_u32 s24, s24, 5632
    s_addc_u32 s25, s25, 0
    v_exp_f32 v47, v47
    v_exp_f32 v48, v48
    v_exp_f32 v49, v49
    v_smfmac_f32_32x32x32_bf16 v[80:95], v[242:245], v[40:47], v15
    s_mul_i32 s44, s44, 20480
    s_mul_i32 s45, s34, 2560
    v_exp_f32 v50, v50
    v_exp_f32 v51, v51
    v_exp_f32 v52, v52
    v_mfma_f32_32x32x4bf16_1k v[16:47], v[228:229], v[164:165], 0
    v_exp_f32 v53, v53
    v_exp_f32 v54, v54
    v_exp_f32 v55, v55
    v_exp_f32 v56, v56
    v_exp_f32 v57, v57
    v_exp_f32 v58, v58
    v_exp_f32 v59, v59
    v_exp_f32 v60, v60
    v_exp_f32 v61, v61
    v_exp_f32 v62, v62
    v_smfmac_f32_32x32x32_bf16 v[96:111], v[230:233], v[48:55], v15
    s_add_u32 s44, s44, s45
    s_mul_i32 s12, s36, 1280
    v_exp_f32 v63, v63
    v_exp_f32 v64, v64
    v_exp_f32 v65, v65
    v_smfmac_f32_32x32x32_bf16 v[96:111], v[234:237], v[56:63], v15
    s_add_u32 s44, s44, s12
    s_add_u32 s44, s44, 327680
    v_exp_f32 v66, v66
    v_exp_f32 v67, v67
    v_exp_f32 v68, v68
    v_mfma_f32_32x32x16_bf16 v[16:31], v[220:223], v[156:159], v[16:31]
    s_add_u32 s45, s45, s54
L_warm1_0:
    s_cbranch_execz L_warm1_0_1
    v_exp_f32 v69, v69
    v_exp_f32 v70, v70
    v_exp_f32 v71, v71
    v_mfma_f32_32x32x16_bf16 v[32:47], v[224:227], v[156:159], v[32:47]
    s_add_u32 s45, s45, 2949120
    v_exp_f32 v72, v72
    v_exp_f32 v73, v73
    v_exp_f32 v74, v74
    v_exp_f32 v75, v75
    v_exp_f32 v76, v76
    v_exp_f32 v77, v77
    v_exp_f32 v78, v78
    v_smfmac_f32_32x32x32_bf16 v[96:111], v[238:241], v[64:71], v15
    s_lshl2_add_u32 s46, s15, s32
    s_mul_i32 s46, s46, 768
    v_exp_f32 v79, v79
    v_exp_f32 v16, v16
    v_exp_f32 v17, v17
    v_smfmac_f32_32x32x32_bf16 v[96:111], v[242:245], v[72:79], v15
    s_mul_i32 s12, s14, 393216
    s_add_u32 s46, s46, s12
    v_exp_f32 v18, v18
    v_exp_f32 v19, v19
    v_exp_f32 v20, v20
    v_mfma_f32_32x32x4bf16_1k v[48:79], v[228:229], v[166:167], 0
    v_exp_f32 v21, v21
    v_exp_f32 v22, v22
    v_exp_f32 v23, v23
    v_exp_f32 v24, v24
    v_exp_f32 v25, v25
    v_exp_f32 v26, v26
    v_exp_f32 v27, v27
    v_exp_f32 v28, v28
    v_exp_f32 v29, v29
    v_exp_f32 v30, v30
    v_smfmac_f32_32x32x32_bf16 v[112:127], v[230:233], v[16:23], v15
    s_add_u32 s46, s46, 5701632
    s_lshr_b32 s47, s55, 5
    v_exp_f32 v31, v31
    v_exp_f32 v32, v32
    v_exp_f32 v33, v33
    v_smfmac_f32_32x32x32_bf16 v[112:127], v[234:237], v[24:31], v15
    s_mul_i32 s47, s47, 491520
    s_and_b32 s12, s55, 31
    v_exp_f32 v34, v34
    v_exp_f32 v35, v35
    v_exp_f32 v36, v36
    v_mfma_f32_32x32x16_bf16 v[48:63], v[220:223], v[160:163], v[48:63]
    s_mul_i32 s12, s12, 5120
    v_exp_f32 v37, v37
    v_exp_f32 v38, v38
    v_exp_f32 v39, v39
    v_mfma_f32_32x32x16_bf16 v[64:79], v[224:227], v[160:163], v[64:79]
    s_add_u32 s47, s47, s12
    v_exp_f32 v40, v40
    v_exp_f32 v41, v41
    v_exp_f32 v42, v42
    v_exp_f32 v43, v43
    v_exp_f32 v44, v44
    v_exp_f32 v45, v45
    v_exp_f32 v46, v46
    v_smfmac_f32_32x32x32_bf16 v[112:127], v[238:241], v[32:39], v15
    s_add_u32 s47, s47, 16908288
    s_mul_i32 s42, s32, 6144
    v_exp_f32 v47, v47
    v_exp_f32 v48, v48
    v_exp_f32 v49, v49
    v_smfmac_f32_32x32x32_bf16 v[112:127], v[242:245], v[40:47], v15
    s_waitcnt vmcnt(19)
    v_exp_f32 v50, v50
    v_exp_f32 v51, v51
    v_exp_f32 v52, v52
    v_mfma_f32_32x32x4bf16_1k v[16:47], v[176:177], v[152:153], 0
    v_exp_f32 v53, v53
    v_exp_f32 v54, v54
    v_exp_f32 v55, v55
    v_exp_f32 v56, v56
    v_exp_f32 v57, v57
    v_exp_f32 v58, v58
    v_exp_f32 v59, v59
    v_exp_f32 v60, v60
    v_exp_f32 v61, v61
    v_exp_f32 v62, v62
    v_smfmac_f32_32x32x32_bf16 v[128:143], v[230:233], v[48:55], v15
    buffer_load_dwordx4 v[220:223], v4, s[24:27], 0 offen
    buffer_load_dwordx4 v[224:227], v4, s[24:27], 0 offen offset:1024
    buffer_load_dwordx2 v[228:229], v5, s[24:27], 0 offen offset:2048
    v_exp_f32 v63, v63
    v_exp_f32 v64, v64
    v_exp_f32 v65, v65
    v_smfmac_f32_32x32x32_bf16 v[128:143], v[234:237], v[56:63], v15
    s_mul_i32 s43, s32, 9216
    s_mul_i32 s12, s32, 204800
    v_exp_f32 v66, v66
    v_exp_f32 v67, v67
    v_exp_f32 v68, v68
    v_mfma_f32_32x32x16_bf16 v[16:31], v[168:171], v[144:147], v[16:31]
    s_mul_i32 s13, s34, 5120
    v_exp_f32 v69, v69
    v_exp_f32 v70, v70
    v_exp_f32 v71, v71
    v_mfma_f32_32x32x16_bf16 v[32:47], v[172:175], v[144:147], v[32:47]
    s_add_u32 s12, s12, s13
    v_exp_f32 v72, v72
    v_exp_f32 v73, v73
    v_exp_f32 v74, v74
    v_exp_f32 v75, v75
    v_exp_f32 v76, v76
    v_exp_f32 v77, v77
    v_exp_f32 v78, v78
    v_smfmac_f32_32x32x32_bf16 v[128:143], v[238:241], v[64:71], v15
    s_waitcnt vmcnt(16)
    v_exp_f32 v79, v79
    v_exp_f32 v16, v16
    v_exp_f32 v17, v17
    v_smfmac_f32_32x32x32_bf16 v[128:143], v[242:245], v[72:79], v15
    buffer_load_dwordx4 v[230:233], v6, s[24:27], 0 offen offset:0
    buffer_load_dwordx4 v[234:237], v6, s[24:27], 0 offen offset:768
    v_exp_f32 v18, v18
    v_exp_f32 v19, v19
    v_exp_f32 v20, v20
    v_mfma_f32_32x32x4bf16_1k v[48:79], v[176:177], v[154:155], 0
    v_exp_f32 v21, v21
    v_exp_f32 v22, v22
    v_exp_f32 v23, v23
    v_exp_f32 v24, v24
    v_exp_f32 v25, v25
    v_exp_f32 v26, v26
    v_exp_f32 v27, v27
    v_exp_f32 v28, v28
    v_exp_f32 v29, v29
    v_exp_f32 v30, v30
    v_smfmac_f32_32x32x32_bf16 v[80:95], v[178:181], v[16:23], v15
    s_add_u32 s12, s12, 15925248
    s_mov_b32 s22, 5120
    v_exp_f32 v31, v31
    v_exp_f32 v32, v32
    v_exp_f32 v33, v33
    v_smfmac_f32_32x32x32_bf16 v[80:95], v[182:185], v[24:31], v15
    buffer_load_dwordx4 v[238:241], v6, s[24:27], 0 offen offset:1536
    buffer_load_dwordx4 v[242:245], v6, s[24:27], 0 offen offset:2304
    v_exp_f32 v34, v34
    v_exp_f32 v35, v35
    v_exp_f32 v36, v36
    v_mfma_f32_32x32x16_bf16 v[48:63], v[168:171], v[148:151], v[48:63]
    s_add_u32 s48, s58, s12
    s_addc_u32 s49, s59, 0
    s_mul_i32 s12, s32, 491520
    v_exp_f32 v37, v37
    v_exp_f32 v38, v38
    v_exp_f32 v39, v39
    v_mfma_f32_32x32x16_bf16 v[64:79], v[172:175], v[148:151], v[64:79]
    s_add_u32 s12, s12, s13
    s_add_u32 s12, s12, 16744448
    v_exp_f32 v40, v40
    v_exp_f32 v41, v41
    v_exp_f32 v42, v42
    v_exp_f32 v43, v43
    v_exp_f32 v44, v44
    v_exp_f32 v45, v45
    v_exp_f32 v46, v46
    v_smfmac_f32_32x32x32_bf16 v[80:95], v[186:189], v[32:39], v15
    s_add_u32 s24, s24, 5632
    s_addc_u32 s25, s25, 0
    v_exp_f32 v47, v47
    v_exp_f32 v48, v48
    v_exp_f32 v49, v49
    v_smfmac_f32_32x32x32_bf16 v[80:95], v[190:193], v[40:47], v15
    s_mul_i32 s11, s32, 25600
    s_add_u32 s52, s58, s12
    s_addc_u32 s53, s59, 0
    v_exp_f32 v50, v50
    v_exp_f32 v51, v51
    v_exp_f32 v52, v52
    v_mfma_f32_32x32x4bf16_1k v[16:47], v[176:177], v[164:165], 0
    v_exp_f32 v53, v53
    v_exp_f32 v54, v54
    v_exp_f32 v55, v55
    v_exp_f32 v56, v56
    v_exp_f32 v57, v57
    v_exp_f32 v58, v58
    v_exp_f32 v59, v59
    v_exp_f32 v60, v60
    v_exp_f32 v61, v61
    v_exp_f32 v62, v62
    v_smfmac_f32_32x32x32_bf16 v[96:111], v[178:181], v[48:55], v15
    v_exp_f32 v63, v63
    v_exp_f32 v64, v64
    v_exp_f32 v65, v65
    v_smfmac_f32_32x32x32_bf16 v[96:111], v[182:185], v[56:63], v15
    v_exp_f32 v66, v66
    v_exp_f32 v67, v67
    v_exp_f32 v68, v68
    v_mfma_f32_32x32x16_bf16 v[16:31], v[168:171], v[156:159], v[16:31]
    v_exp_f32 v69, v69
    v_exp_f32 v70, v70
    v_exp_f32 v71, v71
    v_mfma_f32_32x32x16_bf16 v[32:47], v[172:175], v[156:159], v[32:47]
    v_exp_f32 v72, v72
    v_exp_f32 v73, v73
    v_exp_f32 v74, v74
    v_exp_f32 v75, v75
    v_exp_f32 v76, v76
    v_exp_f32 v77, v77
    v_exp_f32 v78, v78
    v_smfmac_f32_32x32x32_bf16 v[96:111], v[186:189], v[64:71], v15
    v_exp_f32 v79, v79
    v_exp_f32 v16, v16
    v_exp_f32 v17, v17
    v_smfmac_f32_32x32x32_bf16 v[96:111], v[190:193], v[72:79], v15
    v_exp_f32 v18, v18
    v_exp_f32 v19, v19
    v_exp_f32 v20, v20
    v_mfma_f32_32x32x4bf16_1k v[48:79], v[176:177], v[166:167], 0
    v_exp_f32 v21, v21
    v_exp_f32 v22, v22
    v_exp_f32 v23, v23
    v_exp_f32 v24, v24
    v_exp_f32 v25, v25
    v_exp_f32 v26, v26
    v_exp_f32 v27, v27
    v_exp_f32 v28, v28
    v_exp_f32 v29, v29
    v_exp_f32 v30, v30
    v_smfmac_f32_32x32x32_bf16 v[112:127], v[178:181], v[16:23], v15
    v_exp_f32 v31, v31
    v_exp_f32 v32, v32
    v_exp_f32 v33, v33
    v_smfmac_f32_32x32x32_bf16 v[112:127], v[182:185], v[24:31], v15
    v_exp_f32 v34, v34
    v_exp_f32 v35, v35
    v_exp_f32 v36, v36
    v_mfma_f32_32x32x16_bf16 v[48:63], v[168:171], v[160:163], v[48:63]
    v_exp_f32 v37, v37
    v_exp_f32 v38, v38
    v_exp_f32 v39, v39
    v_mfma_f32_32x32x16_bf16 v[64:79], v[172:175], v[160:163], v[64:79]
    v_exp_f32 v40, v40
    v_exp_f32 v41, v41
    v_exp_f32 v42, v42
    v_exp_f32 v43, v43
    v_exp_f32 v44, v44
    v_exp_f32 v45, v45
    v_exp_f32 v46, v46
    v_smfmac_f32_32x32x32_bf16 v[112:127], v[186:189], v[32:39], v15
    v_exp_f32 v47, v47
    v_exp_f32 v48, v48
    v_exp_f32 v49, v49
    v_smfmac_f32_32x32x32_bf16 v[112:127], v[190:193], v[40:47], v15
    s_waitcnt vmcnt(12)
    v_exp_f32 v50, v50
    v_exp_f32 v51, v51
    v_exp_f32 v52, v52
    v_mfma_f32_32x32x4bf16_1k v[16:47], v[202:203], v[152:153], 0
    v_exp_f32 v53, v53
    v_exp_f32 v54, v54
    v_exp_f32 v55, v55
    v_exp_f32 v56, v56
    v_exp_f32 v57, v57
    v_exp_f32 v58, v58
    v_exp_f32 v59, v59
    v_exp_f32 v60, v60
    v_exp_f32 v61, v61
    v_exp_f32 v62, v62
    v_smfmac_f32_32x32x32_bf16 v[128:143], v[178:181], v[48:55], v15
    buffer_load_dwordx4 v[168:171], v4, s[24:27], 0 offen
    buffer_load_dwordx4 v[172:175], v4, s[24:27], 0 offen offset:1024
    buffer_load_dwordx2 v[176:177], v5, s[24:27], 0 offen offset:2048
    v_exp_f32 v63, v63
    v_exp_f32 v64, v64
    v_exp_f32 v65, v65
    v_smfmac_f32_32x32x32_bf16 v[128:143], v[182:185], v[56:63], v15
    v_exp_f32 v66, v66
    v_exp_f32 v67, v67
    v_exp_f32 v68, v68
    v_mfma_f32_32x32x16_bf16 v[16:31], v[194:197], v[144:147], v[16:31]
    v_exp_f32 v69, v69
    v_exp_f32 v70, v70
    v_exp_f32 v71, v71
    v_mfma_f32_32x32x16_bf16 v[32:47], v[198:201], v[144:147], v[32:47]
    v_exp_f32 v72, v72
    v_exp_f32 v73, v73
    v_exp_f32 v74, v74
    v_exp_f32 v75, v75
    v_exp_f32 v76, v76
    v_exp_f32 v77, v77
    v_exp_f32 v78, v78
    v_smfmac_f32_32x32x32_bf16 v[128:143], v[186:189], v[64:71], v15
    s_waitcnt vmcnt(11)
    v_exp_f32 v79, v79
    v_exp_f32 v16, v16
    v_exp_f32 v17, v17
    v_smfmac_f32_32x32x32_bf16 v[128:143], v[190:193], v[72:79], v15
    buffer_load_dwordx4 v[178:181], v6, s[24:27], 0 offen offset:0
    buffer_load_dwordx4 v[182:185], v6, s[24:27], 0 offen offset:768
    v_exp_f32 v18, v18
    v_exp_f32 v19, v19
    v_exp_f32 v20, v20
    v_mfma_f32_32x32x4bf16_1k v[48:79], v[202:203], v[154:155], 0
    v_exp_f32 v21, v21
    v_exp_f32 v22, v22
    v_exp_f32 v23, v23
    v_exp_f32 v24, v24
    v_exp_f32 v25, v25
    v_exp_f32 v26, v26
    v_exp_f32 v27, v27
    v_exp_f32 v28, v28
    v_exp_f32 v29, v29
    v_exp_f32 v30, v30
    v_smfmac_f32_32x32x32_bf16 v[80:95], v[204:207], v[16:23], v15
    s_waitcnt vmcnt(20)
    ds_read_b64_tr_b16 a[208:209], v255 offset:0
    v_exp_f32 v31, v31
    v_exp_f32 v32, v32
    v_exp_f32 v33, v33
    v_smfmac_f32_32x32x32_bf16 v[80:95], v[208:211], v[24:31], v15
    buffer_load_dwordx4 v[186:189], v6, s[24:27], 0 offen offset:1536
    buffer_load_dwordx4 v[190:193], v6, s[24:27], 0 offen offset:2304
    v_exp_f32 v34, v34
    v_exp_f32 v35, v35
    v_exp_f32 v36, v36
    v_mfma_f32_32x32x16_bf16 v[48:63], v[194:197], v[148:151], v[48:63]
    ds_read_b64_tr_b16 a[210:211], v255 offset:512
    v_exp_f32 v37, v37
    v_exp_f32 v38, v38
    v_exp_f32 v39, v39
    v_mfma_f32_32x32x16_bf16 v[64:79], v[198:201], v[148:151], v[64:79]
    ds_read_b64_tr_b16 a[212:213], v255 offset:32
    v_exp_f32 v40, v40
    v_exp_f32 v41, v41
    v_exp_f32 v42, v42
    v_exp_f32 v43, v43
    v_exp_f32 v44, v44
    v_exp_f32 v45, v45
    v_exp_f32 v46, v46
    v_smfmac_f32_32x32x32_bf16 v[80:95], v[212:215], v[32:39], v15
    s_add_u32 s24, s24, 5632
    s_addc_u32 s25, s25, 0
    v_exp_f32 v47, v47
    v_exp_f32 v48, v48
    v_exp_f32 v49, v49
    v_smfmac_f32_32x32x32_bf16 v[80:95], v[216:219], v[40:47], v15
    ds_read_b64_tr_b16 a[214:215], v255 offset:544
    v_exp_f32 v50, v50
    v_exp_f32 v51, v51
    v_exp_f32 v52, v52
    v_mfma_f32_32x32x4bf16_1k v[16:47], v[202:203], v[164:165], 0
    v_exp_f32 v53, v53
    v_exp_f32 v54, v54
    v_exp_f32 v55, v55
    v_exp_f32 v56, v56
    v_exp_f32 v57, v57
    v_exp_f32 v58, v58
    v_exp_f32 v59, v59
    v_exp_f32 v60, v60
    v_exp_f32 v61, v61
    v_exp_f32 v62, v62
    v_smfmac_f32_32x32x32_bf16 v[96:111], v[204:207], v[48:55], v15
    ds_read_b64_tr_b16 a[216:217], v255 offset:64
    v_exp_f32 v63, v63
    v_exp_f32 v64, v64
    v_exp_f32 v65, v65
    v_smfmac_f32_32x32x32_bf16 v[96:111], v[208:211], v[56:63], v15
    ds_read_b64_tr_b16 a[218:219], v255 offset:576
    v_exp_f32 v66, v66
    v_exp_f32 v67, v67
    v_exp_f32 v68, v68
    v_mfma_f32_32x32x16_bf16 v[16:31], v[194:197], v[156:159], v[16:31]
    ds_read_b64_tr_b16 a[220:221], v255 offset:96
    v_exp_f32 v69, v69
    v_exp_f32 v70, v70
    v_exp_f32 v71, v71
    v_mfma_f32_32x32x16_bf16 v[32:47], v[198:201], v[156:159], v[32:47]
    ds_read_b64_tr_b16 a[222:223], v255 offset:608
    v_exp_f32 v72, v72
    v_exp_f32 v73, v73
    v_exp_f32 v74, v74
    v_exp_f32 v75, v75
    v_exp_f32 v76, v76
    v_exp_f32 v77, v77
    v_exp_f32 v78, v78
    v_smfmac_f32_32x32x32_bf16 v[96:111], v[212:215], v[64:71], v15
    buffer_load_dword v12, v11, s[28:31], s8 offen sc1
    v_exp_f32 v79, v79
    v_exp_f32 v16, v16
    v_exp_f32 v17, v17
    v_smfmac_f32_32x32x32_bf16 v[96:111], v[216:219], v[72:79], v15
    s_waitcnt lgkmcnt(0)
    v_exp_f32 v18, v18
    v_exp_f32 v19, v19
    v_exp_f32 v20, v20
    v_mfma_f32_32x32x4bf16_1k v[48:79], v[202:203], v[166:167], 0
    v_exp_f32 v21, v21
    v_exp_f32 v22, v22
    v_exp_f32 v23, v23
    v_exp_f32 v24, v24
    v_exp_f32 v25, v25
    v_exp_f32 v26, v26
    v_exp_f32 v27, v27
    v_exp_f32 v28, v28
    v_exp_f32 v29, v29
    v_exp_f32 v30, v30
    v_smfmac_f32_32x32x32_bf16 v[112:127], v[204:207], v[16:23], v15
    buffer_store_dwordx4 a[208:211], v4, s[28:31], s40 offen offset:0 sc1
    buffer_store_dwordx4 a[212:215], v4, s[28:31], s40 offen offset:1024 sc1
    v_exp_f32 v31, v31
    v_exp_f32 v32, v32
    v_exp_f32 v33, v33
    v_smfmac_f32_32x32x32_bf16 v[112:127], v[208:211], v[24:31], v15
    v_exp_f32 v34, v34
    v_exp_f32 v35, v35
    v_exp_f32 v36, v36
    v_mfma_f32_32x32x16_bf16 v[48:63], v[194:197], v[160:163], v[48:63]
    v_exp_f32 v37, v37
    v_exp_f32 v38, v38
    v_exp_f32 v39, v39
    v_mfma_f32_32x32x16_bf16 v[64:79], v[198:201], v[160:163], v[64:79]
    v_exp_f32 v40, v40
    v_exp_f32 v41, v41
    v_exp_f32 v42, v42
    v_exp_f32 v43, v43
    v_exp_f32 v44, v44
    v_exp_f32 v45, v45
    v_exp_f32 v46, v46
    v_smfmac_f32_32x32x32_bf16 v[112:127], v[212:215], v[32:39], v15
    v_exp_f32 v47, v47
    v_exp_f32 v48, v48
    v_exp_f32 v49, v49
    v_smfmac_f32_32x32x32_bf16 v[112:127], v[216:219], v[40:47], v15
    s_waitcnt vmcnt(14)
    v_exp_f32 v50, v50
    v_exp_f32 v51, v51
    v_exp_f32 v52, v52
    v_mfma_f32_32x32x4bf16_1k v[16:47], v[228:229], v[152:153], 0
    v_exp_f32 v53, v53
    v_exp_f32 v54, v54
    v_exp_f32 v55, v55
    v_exp_f32 v56, v56
    v_exp_f32 v57, v57
    v_exp_f32 v58, v58
    v_exp_f32 v59, v59
    v_exp_f32 v60, v60
    v_exp_f32 v61, v61
    v_exp_f32 v62, v62
    v_smfmac_f32_32x32x32_bf16 v[128:143], v[204:207], v[48:55], v15
    buffer_load_dwordx4 v[194:197], v4, s[24:27], 0 offen
    buffer_load_dwordx4 v[198:201], v4, s[24:27], 0 offen offset:1024
    buffer_load_dwordx2 v[202:203], v5, s[24:27], 0 offen offset:2048
    v_exp_f32 v63, v63
    v_exp_f32 v64, v64
    v_exp_f32 v65, v65
    v_smfmac_f32_32x32x32_bf16 v[128:143], v[208:211], v[56:63], v15
    buffer_store_dwordx4 a[216:219], v4, s[28:31], s40 offen offset:2048 sc1
    buffer_store_dwordx4 a[220:223], v4, s[28:31], s40 offen offset:3072 sc1
    v_exp_f32 v66, v66
    v_exp_f32 v67, v67
    v_exp_f32 v68, v68
    v_mfma_f32_32x32x16_bf16 v[16:31], v[220:223], v[144:147], v[16:31]
    s_waitcnt vmcnt(7)
    v_cmp_gt_u32 vcc, 32, v12
    v_exp_f32 v69, v69
    v_exp_f32 v70, v70
    v_exp_f32 v71, v71
    v_mfma_f32_32x32x16_bf16 v[32:47], v[224:227], v[144:147], v[32:47]
    v_exp_f32 v72, v72
    v_exp_f32 v73, v73
    v_exp_f32 v74, v74
    v_exp_f32 v75, v75
    v_exp_f32 v76, v76
    v_exp_f32 v77, v77
    v_exp_f32 v78, v78
    v_smfmac_f32_32x32x32_bf16 v[128:143], v[212:215], v[64:71], v15
    s_waitcnt vmcnt(15)
    s_cbranch_vccnz L_g_slow
L_g_ok:
    v_exp_f32 v79, v79
    v_exp_f32 v16, v16
    v_exp_f32 v17, v17
    v_smfmac_f32_32x32x32_bf16 v[128:143], v[216:219], v[72:79], v15
    buffer_load_dwordx4 v[204:207], v6, s[24:27], 0 offen offset:0
    buffer_load_dwordx4 v[208:211], v6, s[24:27], 0 offen offset:768
    v_exp_f32 v18, v18
    v_exp_f32 v19, v19
    v_exp_f32 v20, v20
    v_mfma_f32_32x32x4bf16_1k v[48:79], v[228:229], v[154:155], 0
    v_exp_f32 v21, v21
    v_exp_f32 v22, v22
    v_exp_f32 v23, v23
    v_exp_f32 v24, v24
    v_exp_f32 v25, v25
    v_exp_f32 v26, v26
    v_exp_f32 v27, v27
    v_exp_f32 v28, v28
    v_exp_f32 v29, v29
    v_exp_f32 v30, v30
    v_smfmac_f32_32x32x32_bf16 v[80:95], v[230:233], v[16:23], v15
    v_exp_f32 v31, v31
    v_exp_f32 v32, v32
    v_exp_f32 v33, v33
    v_smfmac_f32_32x32x32_bf16 v[80:95], v[234:237], v[24:31], v15
    buffer_load_dwordx4 v[212:215], v6, s[24:27], 0 offen offset:1536
    buffer_load_dwordx4 v[216:219], v6, s[24:27], 0 offen offset:2304
    v_exp_f32 v34, v34
    v_exp_f32 v35, v35
    v_exp_f32 v36, v36
    v_mfma_f32_32x32x16_bf16 v[48:63], v[220:223], v[148:151], v[48:63]
    v_exp_f32 v37, v37
    v_exp_f32 v38, v38
    v_exp_f32 v39, v39
    v_mfma_f32_32x32x16_bf16 v[64:79], v[224:227], v[148:151], v[64:79]
    v_exp_f32 v40, v40
    v_exp_f32 v41, v41
    v_exp_f32 v42, v42
    v_exp_f32 v43, v43
    v_exp_f32 v44, v44
    v_exp_f32 v45, v45
    v_exp_f32 v46, v46
    v_smfmac_f32_32x32x32_bf16 v[80:95], v[238:241], v[32:39], v15
    s_add_u32 s24, s24, 5632
    s_addc_u32 s25, s25, 0
    v_exp_f32 v47, v47
    v_exp_f32 v48, v48
    v_exp_f32 v49, v49
    v_smfmac_f32_32x32x32_bf16 v[80:95], v[242:245], v[40:47], v15
    v_exp_f32 v50, v50
    v_exp_f32 v51, v51
    v_exp_f32 v52, v52
    v_mfma_f32_32x32x4bf16_1k v[16:47], v[228:229], v[164:165], 0
    v_exp_f32 v53, v53
    v_exp_f32 v54, v54
    v_exp_f32 v55, v55
    v_exp_f32 v56, v56
    v_exp_f32 v57, v57
    v_exp_f32 v58, v58
    v_exp_f32 v59, v59
    v_exp_f32 v60, v60
    v_exp_f32 v61, v61
    v_exp_f32 v62, v62
    v_smfmac_f32_32x32x32_bf16 v[96:111], v[230:233], v[48:55], v15
    buffer_load_dwordx4 a[0:3], v251, s[16:19], 0 offen sc1
    buffer_load_dwordx4 a[4:7], v252, s[16:19], 0 offen sc1
    buffer_load_dwordx4 a[8:11], v13, s[16:19], 0 offen sc1
    v_exp_f32 v63, v63
    v_exp_f32 v64, v64
    v_exp_f32 v65, v65
    v_smfmac_f32_32x32x32_bf16 v[96:111], v[234:237], v[56:63], v15
    v_exp_f32 v66, v66
    v_exp_f32 v67, v67
    v_exp_f32 v68, v68
    v_mfma_f32_32x32x16_bf16 v[16:31], v[220:223], v[156:159], v[16:31]
    v_exp_f32 v69, v69
    v_exp_f32 v70, v70
    v_exp_f32 v71, v71
    v_mfma_f32_32x32x16_bf16 v[32:47], v[224:227], v[156:159], v[32:47]
    s_add_u32 s16, s16, 98304
    s_addc_u32 s17, s17, 0
    v_exp_f32 v72, v72
    v_exp_f32 v73, v73
    v_exp_f32 v74, v74
    v_exp_f32 v75, v75
    v_exp_f32 v76, v76
    v_exp_f32 v77, v77
    v_exp_f32 v78, v78
    v_smfmac_f32_32x32x32_bf16 v[96:111], v[238:241], v[64:71], v15
    buffer_load_dwordx4 a[12:15], v251, s[16:19], 0 offen sc1
    buffer_load_dwordx4 a[16:19], v252, s[16:19], 0 offen sc1
    buffer_load_dwordx4 a[20:23], v13, s[16:19], 0 offen sc1
    v_exp_f32 v79, v79
    v_exp_f32 v16, v16
    v_exp_f32 v17, v17
    v_smfmac_f32_32x32x32_bf16 v[96:111], v[242:245], v[72:79], v15
    v_exp_f32 v18, v18
    v_exp_f32 v19, v19
    v_exp_f32 v20, v20
    v_mfma_f32_32x32x4bf16_1k v[48:79], v[228:229], v[166:167], 0
    v_exp_f32 v21, v21
    v_exp_f32 v22, v22
    v_exp_f32 v23, v23
    v_exp_f32 v24, v24
    v_exp_f32 v25, v25
    v_exp_f32 v26, v26
    v_exp_f32 v27, v27
    v_exp_f32 v28, v28
    v_exp_f32 v29, v29
    v_exp_f32 v30, v30
    v_smfmac_f32_32x32x32_bf16 v[112:127], v[230:233], v[16:23], v15
    s_add_u32 s16, s16, 98304
    s_addc_u32 s17, s17, 0
    v_exp_f32 v31, v31
    v_exp_f32 v32, v32
    v_exp_f32 v33, v33
    v_smfmac_f32_32x32x32_bf16 v[112:127], v[234:237], v[24:31], v15
    buffer_load_dwordx4 a[24:27], v251, s[16:19], 0 offen sc1
    buffer_load_dwordx4 a[28:31], v252, s[16:19], 0 offen sc1
    buffer_load_dwordx4 a[32:35], v13, s[16:19], 0 offen sc1
    v_exp_f32 v34, v34
    v_exp_f32 v35, v35
    v_exp_f32 v36, v36
    v_mfma_f32_32x32x16_bf16 v[48:63], v[220:223], v[160:163], v[48:63]
    v_exp_f32 v37, v37
    v_exp_f32 v38, v38
    v_exp_f32 v39, v39
    v_mfma_f32_32x32x16_bf16 v[64:79], v[224:227], v[160:163], v[64:79]
    v_exp_f32 v40, v40
    v_exp_f32 v41, v41
    v_exp_f32 v42, v42
    v_exp_f32 v43, v43
    v_exp_f32 v44, v44
    v_exp_f32 v45, v45
    v_exp_f32 v46, v46
    v_smfmac_f32_32x32x32_bf16 v[112:127], v[238:241], v[32:39], v15
    v_exp_f32 v47, v47
    v_exp_f32 v48, v48
    v_exp_f32 v49, v49
    v_smfmac_f32_32x32x32_bf16 v[112:127], v[242:245], v[40:47], v15
    s_waitcnt vmcnt(25)
    v_exp_f32 v50, v50
    v_exp_f32 v51, v51
    v_exp_f32 v52, v52
    v_mfma_f32_32x32x4bf16_1k v[16:47], v[176:177], v[152:153], 0
    v_exp_f32 v53, v53
    v_exp_f32 v54, v54
    v_exp_f32 v55, v55
    v_exp_f32 v56, v56
    v_exp_f32 v57, v57
    v_exp_f32 v58, v58
    v_exp_f32 v59, v59
    v_exp_f32 v60, v60
    v_exp_f32 v61, v61
    v_exp_f32 v62, v62
    v_smfmac_f32_32x32x32_bf16 v[128:143], v[230:233], v[48:55], v15
    buffer_load_dwordx4 v[220:223], v4, s[24:27], 0 offen
    buffer_load_dwordx4 v[224:227], v4, s[24:27], 0 offen offset:1024
    buffer_load_dwordx2 v[228:229], v5, s[24:27], 0 offen offset:2048
    buffer_load_dword v14, v10, s[28:31], s3 offen sc1
    v_exp_f32 v63, v63
    v_exp_f32 v64, v64
    v_exp_f32 v65, v65
    v_smfmac_f32_32x32x32_bf16 v[128:143], v[234:237], v[56:63], v15
    v_exp_f32 v66, v66
    v_exp_f32 v67, v67
    v_exp_f32 v68, v68
    v_mfma_f32_32x32x16_bf16 v[16:31], v[168:171], v[144:147], v[16:31]
    v_exp_f32 v69, v69
    v_exp_f32 v70, v70
    v_exp_f32 v71, v71
    v_mfma_f32_32x32x16_bf16 v[32:47], v[172:175], v[144:147], v[32:47]
    v_exp_f32 v72, v72
    v_exp_f32 v73, v73
    v_exp_f32 v74, v74
    v_exp_f32 v75, v75
    v_exp_f32 v76, v76
    v_exp_f32 v77, v77
    v_exp_f32 v78, v78
    v_smfmac_f32_32x32x32_bf16 v[128:143], v[238:241], v[64:71], v15
    s_waitcnt vmcnt(25)
    v_exp_f32 v79, v79
    v_exp_f32 v16, v16
    v_exp_f32 v17, v17
    v_smfmac_f32_32x32x32_bf16 v[128:143], v[242:245], v[72:79], v15
    buffer_load_dwordx4 v[230:233], v6, s[24:27], 0 offen offset:0
    buffer_load_dwordx4 v[234:237], v6, s[24:27], 0 offen offset:768
    v_exp_f32 v18, v18
    v_exp_f32 v19, v19
    v_exp_f32 v20, v20
    v_mfma_f32_32x32x4bf16_1k v[48:79], v[176:177], v[154:155], 0
    v_exp_f32 v21, v21
    v_exp_f32 v22, v22
    v_exp_f32 v23, v23
    v_exp_f32 v24, v24
    v_exp_f32 v25, v25
    v_exp_f32 v26, v26
    v_exp_f32 v27, v27
    v_exp_f32 v28, v28
    v_exp_f32 v29, v29
    v_exp_f32 v30, v30
    v_smfmac_f32_32x32x32_bf16 v[80:95], v[178:181], v[16:23], v15
    s_waitcnt vmcnt(19)
    v_exp_f32 v31, v31
    v_exp_f32 v32, v32
    v_exp_f32 v33, v33
    v_smfmac_f32_32x32x32_bf16 v[80:95], v[182:185], v[24:31], v15
    buffer_load_dwordx4 v[238:241], v6, s[24:27], 0 offen offset:1536
    buffer_load_dwordx4 v[242:245], v6, s[24:27], 0 offen offset:2304
    s_mov_b64 exec, 1
    buffer_atomic_add v0, off, s[28:31], s9 offset:128 sc1
    s_mov_b64 exec, -1
    v_exp_f32 v34, v34
    v_exp_f32 v35, v35
    v_exp_f32 v36, v36
    v_mfma_f32_32x32x16_bf16 v[48:63], v[168:171], v[148:151], v[48:63]
    v_exp_f32 v37, v37
    v_exp_f32 v38, v38
    v_exp_f32 v39, v39
    v_mfma_f32_32x32x16_bf16 v[64:79], v[172:175], v[148:151], v[64:79]
    v_exp_f32 v40, v40
    v_exp_f32 v41, v41
    v_exp_f32 v42, v42
    v_exp_f32 v43, v43
    v_exp_f32 v44, v44
    v_exp_f32 v45, v45
    v_exp_f32 v46, v46
    v_smfmac_f32_32x32x32_bf16 v[80:95], v[186:189], v[32:39], v15
    s_add_u32 s24, s24, 5632
    s_addc_u32 s25, s25, 0
    v_exp_f32 v47, v47
    v_exp_f32 v48, v48
    v_exp_f32 v49, v49
    v_smfmac_f32_32x32x32_bf16 v[80:95], v[190:193], v[40:47], v15
    s_add_u32 s16, s16, 98304
    s_addc_u32 s17, s17, 0
    v_exp_f32 v50, v50
    v_exp_f32 v51, v51
    v_exp_f32 v52, v52
    v_mfma_f32_32x32x4bf16_1k v[16:47], v[176:177], v[164:165], 0
    v_exp_f32 v53, v53
    v_exp_f32 v54, v54
    v_exp_f32 v55, v55
    v_exp_f32 v56, v56
    v_exp_f32 v57, v57
    v_exp_f32 v58, v58
    v_exp_f32 v59, v59
    v_exp_f32 v60, v60
    v_exp_f32 v61, v61
    v_exp_f32 v62, v62
    v_smfmac_f32_32x32x32_bf16 v[96:111], v[178:181], v[48:55], v15
    buffer_load_dwordx4 a[36:39], v251, s[16:19], 0 offen sc1
    buffer_load_dwordx4 a[40:43], v252, s[16:19], 0 offen sc1
    buffer_load_dwordx4 a[44:47], v13, s[16:19], 0 offen sc1
    v_exp_f32 v63, v63
    v_exp_f32 v64, v64
    v_exp_f32 v65, v65
    v_smfmac_f32_32x32x32_bf16 v[96:111], v[182:185], v[56:63], v15
    v_exp_f32 v66, v66
    v_exp_f32 v67, v67
    v_exp_f32 v68, v68
    v_mfma_f32_32x32x16_bf16 v[16:31], v[168:171], v[156:159], v[16:31]
    v_exp_f32 v69, v69
    v_exp_f32 v70, v70
    v_exp_f32 v71, v71
    v_mfma_f32_32x32x16_bf16 v[32:47], v[172:175], v[156:159], v[32:47]
    s_add_u32 s16, s16, 98304
    s_addc_u32 s17, s17, 0
    v_exp_f32 v72, v72
    v_exp_f32 v73, v73
    v_exp_f32 v74, v74
    v_exp_f32 v75, v75
    v_exp_f32 v76, v76
    v_exp_f32 v77, v77
    v_exp_f32 v78, v78
    v_smfmac_f32_32x32x32_bf16 v[96:111], v[186:189], v[64:71], v15
    buffer_load_dwordx4 a[48:51], v251, s[16:19], 0 offen sc1
    buffer_load_dwordx4 a[52:55], v252, s[16:19], 0 offen sc1
    buffer_load_dwordx4 a[56:59], v13, s[16:19], 0 offen sc1
    v_exp_f32 v79, v79
    v_exp_f32 v16, v16
    v_exp_f32 v17, v17
    v_smfmac_f32_32x32x32_bf16 v[96:111], v[190:193], v[72:79], v15
    v_exp_f32 v18, v18
    v_exp_f32 v19, v19
    v_exp_f32 v20, v20
    v_mfma_f32_32x32x4bf16_1k v[48:79], v[176:177], v[166:167], 0
    v_exp_f32 v21, v21
    v_exp_f32 v22, v22
    v_exp_f32 v23, v23
    v_exp_f32 v24, v24
    v_exp_f32 v25, v25
    v_exp_f32 v26, v26
    v_exp_f32 v27, v27
    v_exp_f32 v28, v28
    v_exp_f32 v29, v29
    v_exp_f32 v30, v30
    v_smfmac_f32_32x32x32_bf16 v[112:127], v[178:181], v[16:23], v15
    s_add_u32 s16, s16, 98304
    s_addc_u32 s17, s17, 0
    v_exp_f32 v31, v31
    v_exp_f32 v32, v32
    v_exp_f32 v33, v33
    v_smfmac_f32_32x32x32_bf16 v[112:127], v[182:185], v[24:31], v15
    buffer_load_dwordx4 a[60:63], v251, s[16:19], 0 offen sc1
    buffer_load_dwordx4 a[64:67], v252, s[16:19], 0 offen sc1
    buffer_load_dwordx4 a[68:71], v13, s[16:19], 0 offen sc1
    v_exp_f32 v34, v34
    v_exp_f32 v35, v35
    v_exp_f32 v36, v36
    v_mfma_f32_32x32x16_bf16 v[48:63], v[168:171], v[160:163], v[48:63]
    v_exp_f32 v37, v37
    v_exp_f32 v38, v38
    v_exp_f32 v39, v39
    v_mfma_f32_32x32x16_bf16 v[64:79], v[172:175], v[160:163], v[64:79]
    v_exp_f32 v40, v40
    v_exp_f32 v41, v41
    v_exp_f32 v42, v42
    v_exp_f32 v43, v43
    v_exp_f32 v44, v44
    v_exp_f32 v45, v45
    v_exp_f32 v46, v46
    v_smfmac_f32_32x32x32_bf16 v[112:127], v[186:189], v[32:39], v15
    v_exp_f32 v47, v47
    v_exp_f32 v48, v48
    v_exp_f32 v49, v49
    v_smfmac_f32_32x32x32_bf16 v[112:127], v[190:193], v[40:47], v15
    s_waitcnt vmcnt(33)
    v_exp_f32 v50, v50
    v_exp_f32 v51, v51
    v_exp_f32 v52, v52
    v_mfma_f32_32x32x4bf16_1k v[16:47], v[202:203], v[152:153], 0
    v_exp_f32 v53, v53
    v_exp_f32 v54, v54
    v_exp_f32 v55, v55
    v_exp_f32 v56, v56
    v_exp_f32 v57, v57
    v_exp_f32 v58, v58
    v_exp_f32 v59, v59
    v_exp_f32 v60, v60
L_warm1_1:
    s_cbranch_execz L_warm1_ret
    v_exp_f32 v61, v61
    v_exp_f32 v62, v62
    v_smfmac_f32_32x32x32_bf16 v[128:143], v[178:181], v[48:55], v15
    buffer_load_dwordx4 v[168:171], v4, s[24:27], 0 offen
    buffer_load_dwordx4 v[172:175], v4, s[24:27], 0 offen offset:1024
    buffer_load_dwordx2 v[176:177], v5, s[24:27], 0 offen offset:2048
    v_exp_f32 v63, v63
    v_exp_f32 v64, v64
    v_exp_f32 v65, v65
    v_smfmac_f32_32x32x32_bf16 v[128:143], v[182:185], v[56:63], v15
    v_exp_f32 v66, v66
    v_exp_f32 v67, v67
    v_exp_f32 v68, v68
    v_mfma_f32_32x32x16_bf16 v[16:31], v[194:197], v[144:147], v[16:31]
    v_exp_f32 v69, v69
    v_exp_f32 v70, v70
    v_exp_f32 v71, v71
    v_mfma_f32_32x32x16_bf16 v[32:47], v[198:201], v[144:147], v[32:47]
    v_exp_f32 v72, v72
    v_exp_f32 v73, v73
    v_exp_f32 v74, v74
    v_exp_f32 v75, v75
    v_exp_f32 v76, v76
    v_exp_f32 v77, v77
    v_exp_f32 v78, v78
    v_smfmac_f32_32x32x32_bf16 v[128:143], v[186:189], v[64:71], v15
    s_waitcnt vmcnt(30)
    v_exp_f32 v79, v79
    v_exp_f32 v16, v16
    v_exp_f32 v17, v17
    v_smfmac_f32_32x32x32_bf16 v[128:143], v[190:193], v[72:79], v15
    buffer_load_dwordx4 v[178:181], v6, s[24:27], 0 offen offset:0
    buffer_load_dwordx4 v[182:185], v6, s[24:27], 0 offen offset:768
    v_exp_f32 v18, v18
    v_exp_f32 v19, v19
    v_exp_f32 v20, v20
    v_mfma_f32_32x32x4bf16_1k v[48:79], v[202:203], v[154:155], 0
    v_exp_f32 v21, v21
    v_exp_f32 v22, v22
    v_exp_f32 v23, v23
    v_exp_f32 v24, v24
    v_exp_f32 v25, v25
    v_exp_f32 v26, v26
    v_exp_f32 v27, v27
    v_exp_f32 v28, v28
    v_exp_f32 v29, v29
    v_exp_f32 v30, v30
    v_smfmac_f32_32x32x32_bf16 v[80:95], v[204:207], v[16:23], v15
    v_exp_f32 v31, v31
    v_exp_f32 v32, v32
    v_exp_f32 v33, v33
    v_smfmac_f32_32x32x32_bf16 v[80:95], v[208:211], v[24:31], v15
    buffer_load_dwordx4 v[186:189], v6, s[24:27], 0 offen offset:1536
    buffer_load_dwordx4 v[190:193], v6, s[24:27], 0 offen offset:2304
    v_exp_f32 v34, v34
    v_exp_f32 v35, v35
    v_exp_f32 v36, v36
    v_mfma_f32_32x32x16_bf16 v[48:63], v[194:197], v[148:151], v[48:63]
    v_exp_f32 v37, v37
    v_exp_f32 v38, v38
    v_exp_f32 v39, v39
    v_mfma_f32_32x32x16_bf16 v[64:79], v[198:201], v[148:151], v[64:79]
    v_exp_f32 v40, v40
    v_exp_f32 v41, v41
    v_exp_f32 v42, v42
    v_exp_f32 v43, v43
    v_exp_f32 v44, v44
    v_exp_f32 v45, v45
    v_exp_f32 v46, v46
    v_smfmac_f32_32x32x32_bf16 v[80:95], v[212:215], v[32:39], v15
    s_add_u32 s24, s24, 5632
    s_addc_u32 s25, s25, 0
    v_exp_f32 v47, v47
    v_exp_f32 v48, v48
    v_exp_f32 v49, v49
    v_smfmac_f32_32x32x32_bf16 v[80:95], v[216:219], v[40:47], v15
    s_add_u32 s16, s16, 98304
    s_addc_u32 s17, s17, 0
    v_exp_f32 v50, v50
    v_exp_f32 v51, v51
    v_exp_f32 v52, v52
    v_mfma_f32_32x32x4bf16_1k v[16:47], v[202:203], v[164:165], 0
    v_exp_f32 v53, v53
    v_exp_f32 v54, v54
    v_exp_f32 v55, v55
    v_exp_f32 v56, v56
    v_exp_f32 v57, v57
    v_exp_f32 v58, v58
    v_exp_f32 v59, v59
    v_exp_f32 v60, v60
    v_exp_f32 v61, v61
    v_exp_f32 v62, v62
    v_smfmac_f32_32x32x32_bf16 v[96:111], v[204:207], v[48:55], v15
    buffer_load_dwordx4 a[72:75], v251, s[16:19], 0 offen sc1
    buffer_load_dwordx4 a[76:79], v252, s[16:19], 0 offen sc1
    buffer_load_dwordx4 a[80:83], v13, s[16:19], 0 offen sc1
    v_exp_f32 v63, v63
    v_exp_f32 v64, v64
    v_exp_f32 v65, v65
    v_smfmac_f32_32x32x32_bf16 v[96:111], v[208:211], v[56:63], v15
    v_exp_f32 v66, v66
    v_exp_f32 v67, v67
    v_exp_f32 v68, v68
    v_mfma_f32_32x32x16_bf16 v[16:31], v[194:197], v[156:159], v[16:31]
    v_exp_f32 v69, v69
    v_exp_f32 v70, v70
    v_exp_f32 v71, v71
    v_mfma_f32_32x32x16_bf16 v[32:47], v[198:201], v[156:159], v[32:47]
    s_add_u32 s16, s16, 98304
    s_addc_u32 s17, s17, 0
    v_exp_f32 v72, v72
    v_exp_f32 v73, v73
    v_exp_f32 v74, v74
    v_exp_f32 v75, v75
    v_exp_f32 v76, v76
    v_exp_f32 v77, v77
    v_exp_f32 v78, v78
    v_smfmac_f32_32x32x32_bf16 v[96:111], v[212:215], v[64:71], v15
    buffer_load_dwordx4 a[84:87], v251, s[16:19], 0 offen sc1
    buffer_load_dwordx4 a[88:91], v252, s[16:19], 0 offen sc1
    buffer_load_dwordx4 a[92:95], v13, s[16:19], 0 offen sc1
    v_exp_f32 v79, v79
    v_exp_f32 v16, v16
    v_exp_f32 v17, v17
    v_smfmac_f32_32x32x32_bf16 v[96:111], v[216:219], v[72:79], v15
    v_exp_f32 v18, v18
    v_exp_f32 v19, v19
    v_exp_f32 v20, v20
    v_mfma_f32_32x32x4bf16_1k v[48:79], v[202:203], v[166:167], 0
    v_exp_f32 v21, v21
    v_exp_f32 v22, v22
    v_exp_f32 v23, v23
    v_exp_f32 v24, v24
    v_exp_f32 v25, v25
    v_exp_f32 v26, v26
    v_exp_f32 v27, v27
    v_exp_f32 v28, v28
    v_exp_f32 v29, v29
    v_exp_f32 v30, v30
    v_smfmac_f32_32x32x32_bf16 v[112:127], v[204:207], v[16:23], v15
    s_add_u32 s16, s16, 98304
    s_addc_u32 s17, s17, 0
    v_exp_f32 v31, v31
    v_exp_f32 v32, v32
    v_exp_f32 v33, v33
    v_smfmac_f32_32x32x32_bf16 v[112:127], v[208:211], v[24:31], v15
    buffer_load_dwordx4 a[96:99], v251, s[16:19], 0 offen sc1
    buffer_load_dwordx4 a[100:103], v252, s[16:19], 0 offen sc1
    buffer_load_dwordx4 a[104:107], v13, s[16:19], 0 offen sc1
    v_exp_f32 v34, v34
    v_exp_f32 v35, v35
    v_exp_f32 v36, v36
    v_mfma_f32_32x32x16_bf16 v[48:63], v[194:197], v[160:163], v[48:63]
    v_exp_f32 v37, v37
    v_exp_f32 v38, v38
    v_exp_f32 v39, v39
    v_mfma_f32_32x32x16_bf16 v[64:79], v[198:201], v[160:163], v[64:79]
    v_exp_f32 v40, v40
    v_exp_f32 v41, v41
    v_exp_f32 v42, v42
    v_exp_f32 v43, v43
    v_exp_f32 v44, v44
    v_exp_f32 v45, v45
    v_exp_f32 v46, v46
    v_smfmac_f32_32x32x32_bf16 v[112:127], v[212:215], v[32:39], v15
    v_exp_f32 v47, v47
    v_exp_f32 v48, v48
    v_exp_f32 v49, v49
    v_smfmac_f32_32x32x32_bf16 v[112:127], v[216:219], v[40:47], v15
    s_waitcnt vmcnt(31)
    s_waitcnt vmcnt(30)
    v_cmp_eq_u32 vcc, 0, v14
    s_nop 0
    s_cmp_eq_u64 vcc, 0
    s_cbranch_scc0 L_x_slow
L_x_ok:
    v_cmp_ne_u32 vcc, s10, v14
    v_lshlrev_b32 v10, 7, v1
    s_cmp_eq_u64 vcc, 0
    s_cselect_b32 s61, 1, 0
    v_exp_f32 v50, v50
    v_exp_f32 v51, v51
    v_exp_f32 v52, v52
    v_mfma_f32_32x32x4bf16_1k v[16:47], v[228:229], v[152:153], 0
    v_exp_f32 v53, v53
    v_exp_f32 v54, v54
    v_exp_f32 v55, v55
    v_exp_f32 v56, v56
    v_exp_f32 v57, v57
    v_exp_f32 v58, v58
    v_exp_f32 v59, v59
    v_exp_f32 v60, v60
    v_exp_f32 v61, v61
    v_exp_f32 v62, v62
    v_smfmac_f32_32x32x32_bf16 v[128:143], v[204:207], v[48:55], v15
    buffer_load_dwordx4 v[194:197], v4, s[24:27], 0 offen
    buffer_load_dwordx4 v[198:201], v4, s[24:27], 0 offen offset:1024
    buffer_load_dwordx2 v[202:203], v5, s[24:27], 0 offen offset:2048
    v_exp_f32 v63, v63
    v_exp_f32 v64, v64
    v_exp_f32 v65, v65
    v_smfmac_f32_32x32x32_bf16 v[128:143], v[208:211], v[56:63], v15
    v_exp_f32 v66, v66
    v_exp_f32 v67, v67
    v_exp_f32 v68, v68
    v_mfma_f32_32x32x16_bf16 v[16:31], v[220:223], v[144:147], v[16:31]
    v_exp_f32 v69, v69
    v_exp_f32 v70, v70
    v_exp_f32 v71, v71
    v_mfma_f32_32x32x16_bf16 v[32:47], v[224:227], v[144:147], v[32:47]
    v_exp_f32 v72, v72
    v_exp_f32 v73, v73
    v_exp_f32 v74, v74
    v_exp_f32 v75, v75
    v_exp_f32 v76, v76
    v_exp_f32 v77, v77
    v_exp_f32 v78, v78
    v_smfmac_f32_32x32x32_bf16 v[128:143], v[212:215], v[64:71], v15
    s_waitcnt vmcnt(29)
    v_exp_f32 v79, v79
    v_exp_f32 v16, v16
    v_exp_f32 v17, v17
    v_smfmac_f32_32x32x32_bf16 v[128:143], v[216:219], v[72:79], v15
    buffer_load_dwordx4 v[204:207], v6, s[24:27], 0 offen offset:0
    buffer_load_dwordx4 v[208:211], v6, s[24:27], 0 offen offset:768
    v_exp_f32 v18, v18
    v_exp_f32 v19, v19
    v_exp_f32 v20, v20
    v_mfma_f32_32x32x4bf16_1k v[48:79], v[228:229], v[154:155], 0
    v_exp_f32 v21, v21
    v_exp_f32 v22, v22
    v_exp_f32 v23, v23
    v_exp_f32 v24, v24
    v_exp_f32 v25, v25
    v_exp_f32 v26, v26
    v_exp_f32 v27, v27
    v_exp_f32 v28, v28
    v_exp_f32 v29, v29
    v_exp_f32 v30, v30
    v_smfmac_f32_32x32x32_bf16 v[80:95], v[230:233], v[16:23], v15
    v_exp_f32 v31, v31
    v_exp_f32 v32, v32
    v_exp_f32 v33, v33
    v_smfmac_f32_32x32x32_bf16 v[80:95], v[234:237], v[24:31], v15
    buffer_load_dwordx4 v[212:215], v6, s[24:27], 0 offen offset:1536
    buffer_load_dwordx4 v[216:219], v6, s[24:27], 0 offen offset:2304
    v_exp_f32 v34, v34
    v_exp_f32 v35, v35
    v_exp_f32 v36, v36
    v_mfma_f32_32x32x16_bf16 v[48:63], v[220:223], v[148:151], v[48:63]
    v_exp_f32 v37, v37
    v_exp_f32 v38, v38
    v_exp_f32 v39, v39
    v_mfma_f32_32x32x16_bf16 v[64:79], v[224:227], v[148:151], v[64:79]
    v_exp_f32 v40, v40
    v_exp_f32 v41, v41
    v_exp_f32 v42, v42
    v_exp_f32 v43, v43
    v_exp_f32 v44, v44
    v_exp_f32 v45, v45
    v_exp_f32 v46, v46
    v_smfmac_f32_32x32x32_bf16 v[80:95], v[238:241], v[32:39], v15
    s_add_u32 s24, s24, 5632
    s_addc_u32 s25, s25, 0
    v_exp_f32 v47, v47
    v_exp_f32 v48, v48
    v_exp_f32 v49, v49
    v_smfmac_f32_32x32x32_bf16 v[80:95], v[242:245], v[40:47], v15
    s_add_u32 s16, s16, 98304
    s_addc_u32 s17, s17, 0
    v_exp_f32 v50, v50
    v_exp_f32 v51, v51
    v_exp_f32 v52, v52
    v_mfma_f32_32x32x4bf16_1k v[16:47], v[228:229], v[164:165], 0
    v_exp_f32 v53, v53
    v_exp_f32 v54, v54
    v_exp_f32 v55, v55
    v_exp_f32 v56, v56
    v_exp_f32 v57, v57
    v_exp_f32 v58, v58
    v_exp_f32 v59, v59
    v_exp_f32 v60, v60
    v_exp_f32 v61, v61
    v_exp_f32 v62, v62
    v_smfmac_f32_32x32x32_bf16 v[96:111], v[230:233], v[48:55], v15
    buffer_load_dwordx4 a[108:111], v251, s[16:19], 0 offen sc1
    buffer_load_dwordx4 a[112:115], v252, s[16:19], 0 offen sc1
    buffer_load_dwordx4 a[116:119], v13, s[16:19], 0 offen sc1
    v_exp_f32 v63, v63
    v_exp_f32 v64, v64
    v_exp_f32 v65, v65
    v_smfmac_f32_32x32x32_bf16 v[96:111], v[234:237], v[56:63], v15
    v_exp_f32 v66, v66
    v_exp_f32 v67, v67
    v_exp_f32 v68, v68
    v_mfma_f32_32x32x16_bf16 v[16:31], v[220:223], v[156:159], v[16:31]
    v_exp_f32 v69, v69
    v_exp_f32 v70, v70
    v_exp_f32 v71, v71
    v_mfma_f32_32x32x16_bf16 v[32:47], v[224:227], v[156:159], v[32:47]
    s_add_u32 s16, s16, 98304
    s_addc_u32 s17, s17, 0
    v_exp_f32 v72, v72
    v_exp_f32 v73, v73
    v_exp_f32 v74, v74
    v_exp_f32 v75, v75
    v_exp_f32 v76, v76
    v_exp_f32 v77, v77
    v_exp_f32 v78, v78
    v_smfmac_f32_32x32x32_bf16 v[96:111], v[238:241], v[64:71], v15
    buffer_load_dwordx4 a[120:123], v251, s[16:19], 0 offen sc1
    buffer_load_dwordx4 a[124:127], v252, s[16:19], 0 offen sc1
    buffer_load_dwordx4 a[128:131], v13, s[16:19], 0 offen sc1
    v_exp_f32 v79, v79
    v_exp_f32 v16, v16
    v_exp_f32 v17, v17
    v_smfmac_f32_32x32x32_bf16 v[96:111], v[242:245], v[72:79], v15
    v_exp_f32 v18, v18
    v_exp_f32 v19, v19
    v_exp_f32 v20, v20
    v_mfma_f32_32x32x4bf16_1k v[48:79], v[228:229], v[166:167], 0
    v_exp_f32 v21, v21
    v_exp_f32 v22, v22
    v_exp_f32 v23, v23
    v_exp_f32 v24, v24
    v_exp_f32 v25, v25
    v_exp_f32 v26, v26
    v_exp_f32 v27, v27
    v_exp_f32 v28, v28
    v_exp_f32 v29, v29
    v_exp_f32 v30, v30
    v_smfmac_f32_32x32x32_bf16 v[112:127], v[230:233], v[16:23], v15
    s_add_u32 s16, s16, 98304
    s_addc_u32 s17, s17, 0
    v_exp_f32 v31, v31
    v_exp_f32 v32, v32
    v_exp_f32 v33, v33
    v_smfmac_f32_32x32x32_bf16 v[112:127], v[234:237], v[24:31], v15
    buffer_load_dwordx4 a[132:135], v251, s[16:19], 0 offen sc1
    buffer_load_dwordx4 a[136:139], v252, s[16:19], 0 offen sc1
    buffer_load_dwordx4 a[140:143], v13, s[16:19], 0 offen sc1
    v_exp_f32 v34, v34
    v_exp_f32 v35, v35
    v_exp_f32 v36, v36
    v_mfma_f32_32x32x16_bf16 v[48:63], v[220:223], v[160:163], v[48:63]
    v_exp_f32 v37, v37
    v_exp_f32 v38, v38
    v_exp_f32 v39, v39
    v_mfma_f32_32x32x16_bf16 v[64:79], v[224:227], v[160:163], v[64:79]
    v_exp_f32 v40, v40
    v_exp_f32 v41, v41
    v_exp_f32 v42, v42
    v_exp_f32 v43, v43
    v_exp_f32 v44, v44
    v_exp_f32 v45, v45
    v_exp_f32 v46, v46
    v_smfmac_f32_32x32x32_bf16 v[112:127], v[238:241], v[32:39], v15
    v_exp_f32 v47, v47
    v_exp_f32 v48, v48
    v_exp_f32 v49, v49
    v_smfmac_f32_32x32x32_bf16 v[112:127], v[242:245], v[40:47], v15
    s_waitcnt vmcnt(29)
    v_exp_f32 v50, v50
    v_exp_f32 v51, v51
    v_exp_f32 v52, v52
    v_mfma_f32_32x32x4bf16_1k v[16:47], v[176:177], v[152:153], 0
    v_exp_f32 v53, v53
    v_exp_f32 v54, v54
    v_exp_f32 v55, v55
    v_exp_f32 v56, v56
    v_exp_f32 v57, v57
    v_exp_f32 v58, v58
    v_exp_f32 v59, v59
    v_exp_f32 v60, v60
    v_exp_f32 v61, v61
    v_exp_f32 v62, v62
    v_smfmac_f32_32x32x32_bf16 v[128:143], v[230:233], v[48:55], v15
    buffer_load_dwordx4 v[220:223], v4, s[24:27], 0 offen
    buffer_load_dwordx4 v[224:227], v4, s[24:27], 0 offen offset:1024
    buffer_load_dwordx2 v[228:229], v5, s[24:27], 0 offen offset:2048
    v_exp_f32 v63, v63
    v_exp_f32 v64, v64
    v_exp_f32 v65, v65
    v_smfmac_f32_32x32x32_bf16 v[128:143], v[234:237], v[56:63], v15
    v_exp_f32 v66, v66
    v_exp_f32 v67, v67
    v_exp_f32 v68, v68
    v_mfma_f32_32x32x16_bf16 v[16:31], v[168:171], v[144:147], v[16:31]
    v_exp_f32 v69, v69
    v_exp_f32 v70, v70
    v_exp_f32 v71, v71
    v_mfma_f32_32x32x16_bf16 v[32:47], v[172:175], v[144:147], v[32:47]
    v_exp_f32 v72, v72
    v_exp_f32 v73, v73
    v_exp_f32 v74, v74
    v_exp_f32 v75, v75
    v_exp_f32 v76, v76
    v_exp_f32 v77, v77
    v_exp_f32 v78, v78
    v_smfmac_f32_32x32x32_bf16 v[128:143], v[238:241], v[64:71], v15
    s_waitcnt vmcnt(28)
    v_exp_f32 v79, v79
    v_exp_f32 v16, v16
    v_exp_f32 v17, v17
    v_smfmac_f32_32x32x32_bf16 v[128:143], v[242:245], v[72:79], v15
    buffer_load_dwordx4 v[230:233], v6, s[24:27], 0 offen offset:0
    buffer_load_dwordx4 v[234:237], v6, s[24:27], 0 offen offset:768
    v_exp_f32 v18, v18
    v_exp_f32 v19, v19
    v_exp_f32 v20, v20
    v_mfma_f32_32x32x4bf16_1k v[48:79], v[176:177], v[154:155], 0
    v_exp_f32 v21, v21
    v_exp_f32 v22, v22
    v_exp_f32 v23, v23
    v_exp_f32 v24, v24
    v_exp_f32 v25, v25
    v_exp_f32 v26, v26
    v_exp_f32 v27, v27
    v_exp_f32 v28, v28
    v_exp_f32 v29, v29
    v_exp_f32 v30, v30
    v_smfmac_f32_32x32x32_bf16 v[80:95], v[178:181], v[16:23], v15
    v_exp_f32 v31, v31
    v_exp_f32 v32, v32
    v_exp_f32 v33, v33
    v_smfmac_f32_32x32x32_bf16 v[80:95], v[182:185], v[24:31], v15
    buffer_load_dwordx4 v[238:241], v6, s[24:27], 0 offen offset:1536
    buffer_load_dwordx4 v[242:245], v6, s[24:27], 0 offen offset:2304
    v_exp_f32 v34, v34
    v_exp_f32 v35, v35
    v_exp_f32 v36, v36
    v_mfma_f32_32x32x16_bf16 v[48:63], v[168:171], v[148:151], v[48:63]
    v_exp_f32 v37, v37
    v_exp_f32 v38, v38
    v_exp_f32 v39, v39
    v_mfma_f32_32x32x16_bf16 v[64:79], v[172:175], v[148:151], v[64:79]
    v_exp_f32 v40, v40
    v_exp_f32 v41, v41
    v_exp_f32 v42, v42
    v_exp_f32 v43, v43
    v_exp_f32 v44, v44
    v_exp_f32 v45, v45
    v_exp_f32 v46, v46
    v_smfmac_f32_32x32x32_bf16 v[80:95], v[186:189], v[32:39], v15
    s_add_u32 s24, s24, 5632
    s_addc_u32 s25, s25, 0
    v_exp_f32 v47, v47
    v_exp_f32 v48, v48
    v_exp_f32 v49, v49
    v_smfmac_f32_32x32x32_bf16 v[80:95], v[190:193], v[40:47], v15
    s_add_u32 s16, s16, 98304
    s_addc_u32 s17, s17, 0
    v_exp_f32 v50, v50
    v_exp_f32 v51, v51
    v_exp_f32 v52, v52
    v_mfma_f32_32x32x4bf16_1k v[16:47], v[176:177], v[164:165], 0
    v_exp_f32 v53, v53
    v_exp_f32 v54, v54
    v_exp_f32 v55, v55
    v_exp_f32 v56, v56
    v_exp_f32 v57, v57
    v_exp_f32 v58, v58
    v_exp_f32 v59, v59
    v_exp_f32 v60, v60
    v_exp_f32 v61, v61
    v_exp_f32 v62, v62
    v_smfmac_f32_32x32x32_bf16 v[96:111], v[178:181], v[48:55], v15
    buffer_load_dwordx4 a[144:147], v251, s[16:19], 0 offen sc1
    buffer_load_dwordx4 a[148:151], v252, s[16:19], 0 offen sc1
    buffer_load_dwordx4 a[152:155], v13, s[16:19], 0 offen sc1
    v_exp_f32 v63, v63
    v_exp_f32 v64, v64
    v_exp_f32 v65, v65
    v_smfmac_f32_32x32x32_bf16 v[96:111], v[182:185], v[56:63], v15
    v_exp_f32 v66, v66
    v_exp_f32 v67, v67
    v_exp_f32 v68, v68
    v_mfma_f32_32x32x16_bf16 v[16:31], v[168:171], v[156:159], v[16:31]
    v_exp_f32 v69, v69
    v_exp_f32 v70, v70
    v_exp_f32 v71, v71
    v_mfma_f32_32x32x16_bf16 v[32:47], v[172:175], v[156:159], v[32:47]
    s_add_u32 s16, s16, 98304
    s_addc_u32 s17, s17, 0
    v_exp_f32 v72, v72
    v_exp_f32 v73, v73
    v_exp_f32 v74, v74
    v_exp_f32 v75, v75
    v_exp_f32 v76, v76
    v_exp_f32 v77, v77
    v_exp_f32 v78, v78
    v_smfmac_f32_32x32x32_bf16 v[96:111], v[186:189], v[64:71], v15
    buffer_load_dwordx4 a[156:159], v251, s[16:19], 0 offen sc1
    buffer_load_dwordx4 a[160:163], v252, s[16:19], 0 offen sc1
    buffer_load_dwordx4 a[164:167], v13, s[16:19], 0 offen sc1
    v_exp_f32 v79, v79
    v_exp_f32 v16, v16
    v_exp_f32 v17, v17
    v_smfmac_f32_32x32x32_bf16 v[96:111], v[190:193], v[72:79], v15
    v_exp_f32 v18, v18
    v_exp_f32 v19, v19
    v_exp_f32 v20, v20
    v_mfma_f32_32x32x4bf16_1k v[48:79], v[176:177], v[166:167], 0
    v_exp_f32 v21, v21
    v_exp_f32 v22, v22
    v_exp_f32 v23, v23
    v_exp_f32 v24, v24
    v_exp_f32 v25, v25
    v_exp_f32 v26, v26
    v_exp_f32 v27, v27
    v_exp_f32 v28, v28
    v_exp_f32 v29, v29
    v_exp_f32 v30, v30
    v_smfmac_f32_32x32x32_bf16 v[112:127], v[178:181], v[16:23], v15
    s_add_u32 s16, s16, 98304
    s_addc_u32 s17, s17, 0
    v_exp_f32 v31, v31
    v_exp_f32 v32, v32
    v_exp_f32 v33, v33
    v_smfmac_f32_32x32x32_bf16 v[112:127], v[182:185], v[24:31], v15
    buffer_load_dwordx4 a[168:171], v251, s[16:19], 0 offen sc1
    buffer_load_dwordx4 a[172:175], v252, s[16:19], 0 offen sc1
    buffer_load_dwordx4 a[176:179], v13, s[16:19], 0 offen sc1
    v_exp_f32 v34, v34
    v_exp_f32 v35, v35
    v_exp_f32 v36, v36
    v_mfma_f32_32x32x16_bf16 v[48:63], v[168:171], v[160:163], v[48:63]
    v_exp_f32 v37, v37
    v_exp_f32 v38, v38
    v_exp_f32 v39, v39
    v_mfma_f32_32x32x16_bf16 v[64:79], v[172:175], v[160:163], v[64:79]
    v_exp_f32 v40, v40
    v_exp_f32 v41, v41
    v_exp_f32 v42, v42
    v_exp_f32 v43, v43
    v_exp_f32 v44, v44
    v_exp_f32 v45, v45
    v_exp_f32 v46, v46
    v_smfmac_f32_32x32x32_bf16 v[112:127], v[186:189], v[32:39], v15
    v_exp_f32 v47, v47
    v_exp_f32 v48, v48
    v_exp_f32 v49, v49
    v_smfmac_f32_32x32x32_bf16 v[112:127], v[190:193], v[40:47], v15
    s_waitcnt vmcnt(29)
    v_exp_f32 v50, v50
    v_exp_f32 v51, v51
    v_exp_f32 v52, v52
    v_mfma_f32_32x32x4bf16_1k v[16:47], v[202:203], v[152:153], 0
    v_exp_f32 v53, v53
    v_exp_f32 v54, v54
    v_exp_f32 v55, v55
    v_exp_f32 v56, v56
    v_exp_f32 v57, v57
    v_exp_f32 v58, v58
    v_exp_f32 v59, v59
    v_exp_f32 v60, v60
    v_exp_f32 v61, v61
    v_exp_f32 v62, v62
    v_smfmac_f32_32x32x32_bf16 v[128:143], v[178:181], v[48:55], v15
    buffer_load_dwordx4 v[168:171], v4, s[24:27], 0 offen
    buffer_load_dwordx4 v[172:175], v4, s[24:27], 0 offen offset:1024
    buffer_load_dwordx2 v[176:177], v5, s[24:27], 0 offen offset:2048
    buffer_load_dword v12, v11, s[28:31], s8 offen offset:128 sc1
    v_exp_f32 v63, v63
    v_exp_f32 v64, v64
    v_exp_f32 v65, v65
    v_smfmac_f32_32x32x32_bf16 v[128:143], v[182:185], v[56:63], v15
    v_exp_f32 v66, v66
    v_exp_f32 v67, v67
    v_exp_f32 v68, v68
    v_mfma_f32_32x32x16_bf16 v[16:31], v[194:197], v[144:147], v[16:31]
    v_exp_f32 v69, v69
    v_exp_f32 v70, v70
    v_exp_f32 v71, v71
    v_mfma_f32_32x32x16_bf16 v[32:47], v[198:201], v[144:147], v[32:47]
    v_exp_f32 v72, v72
    v_exp_f32 v73, v73
    v_exp_f32 v74, v74
    v_exp_f32 v75, v75
    v_exp_f32 v76, v76
    v_exp_f32 v77, v77
    v_exp_f32 v78, v78
    v_smfmac_f32_32x32x32_bf16 v[128:143], v[186:189], v[64:71], v15
    s_waitcnt vmcnt(29)
    v_exp_f32 v79, v79
    v_exp_f32 v16, v16
    v_exp_f32 v17, v17
    v_smfmac_f32_32x32x32_bf16 v[128:143], v[190:193], v[72:79], v15
    buffer_load_dwordx4 v[178:181], v6, s[24:27], 0 offen offset:0
    buffer_load_dwordx4 v[182:185], v6, s[24:27], 0 offen offset:768
    v_exp_f32 v18, v18
    v_exp_f32 v19, v19
    v_exp_f32 v20, v20
    v_mfma_f32_32x32x4bf16_1k v[48:79], v[202:203], v[154:155], 0
    v_exp_f32 v21, v21
    v_exp_f32 v22, v22
    v_exp_f32 v23, v23
    v_exp_f32 v24, v24
    v_exp_f32 v25, v25
    v_exp_f32 v26, v26
    v_exp_f32 v27, v27
    v_exp_f32 v28, v28
    v_exp_f32 v29, v29
    v_exp_f32 v30, v30
    v_smfmac_f32_32x32x32_bf16 v[80:95], v[204:207], v[16:23], v15
    v_exp_f32 v31, v31
    v_exp_f32 v32, v32
    v_exp_f32 v33, v33
    v_smfmac_f32_32x32x32_bf16 v[80:95], v[208:211], v[24:31], v15
    buffer_load_dwordx4 v[186:189], v6, s[24:27], 0 offen offset:1536
    buffer_load_dwordx4 v[190:193], v6, s[24:27], 0 offen offset:2304
    v_exp_f32 v34, v34
    v_exp_f32 v35, v35
    v_exp_f32 v36, v36
    v_mfma_f32_32x32x16_bf16 v[48:63], v[194:197], v[148:151], v[48:63]
    v_exp_f32 v37, v37
    v_exp_f32 v38, v38
    v_exp_f32 v39, v39
    v_mfma_f32_32x32x16_bf16 v[64:79], v[198:201], v[148:151], v[64:79]
    v_exp_f32 v40, v40
    v_exp_f32 v41, v41
    v_exp_f32 v42, v42
    v_exp_f32 v43, v43
    v_exp_f32 v44, v44
    v_exp_f32 v45, v45
    v_exp_f32 v46, v46
    v_smfmac_f32_32x32x32_bf16 v[80:95], v[212:215], v[32:39], v15
    s_add_u32 s24, s24, 5632
    s_addc_u32 s25, s25, 0
    v_exp_f32 v47, v47
    v_exp_f32 v48, v48
    v_exp_f32 v49, v49
    v_smfmac_f32_32x32x32_bf16 v[80:95], v[216:219], v[40:47], v15
    s_add_u32 s16, s16, 98304
    s_addc_u32 s17, s17, 0
    v_exp_f32 v50, v50
    v_exp_f32 v51, v51
    v_exp_f32 v52, v52
    v_mfma_f32_32x32x4bf16_1k v[16:47], v[202:203], v[164:165], 0
    v_exp_f32 v53, v53
    v_exp_f32 v54, v54
    v_exp_f32 v55, v55
    v_exp_f32 v56, v56
    v_exp_f32 v57, v57
    v_exp_f32 v58, v58
    v_exp_f32 v59, v59
    v_exp_f32 v60, v60
    v_exp_f32 v61, v61
    v_exp_f32 v62, v62
    v_smfmac_f32_32x32x32_bf16 v[96:111], v[204:207], v[48:55], v15
    buffer_load_dwordx4 a[180:183], v251, s[16:19], 0 offen sc1
    buffer_load_dwordx4 a[184:187], v252, s[16:19], 0 offen sc1
    buffer_load_dwordx4 a[188:191], v13, s[16:19], 0 offen sc1
    v_exp_f32 v63, v63
    v_exp_f32 v64, v64
    v_exp_f32 v65, v65
    v_smfmac_f32_32x32x32_bf16 v[96:111], v[208:211], v[56:63], v15
    v_exp_f32 v66, v66
    v_exp_f32 v67, v67
    v_exp_f32 v68, v68
    v_mfma_f32_32x32x16_bf16 v[16:31], v[194:197], v[156:159], v[16:31]
    v_exp_f32 v69, v69
    v_exp_f32 v70, v70
    v_exp_f32 v71, v71
    v_mfma_f32_32x32x16_bf16 v[32:47], v[198:201], v[156:159], v[32:47]
    s_add_u32 s16, s16, 98304
    s_addc_u32 s17, s17, 0
    v_exp_f32 v72, v72
    v_exp_f32 v73, v73
    v_exp_f32 v74, v74
    v_exp_f32 v75, v75
    v_exp_f32 v76, v76
    v_exp_f32 v77, v77
    v_exp_f32 v78, v78
    v_smfmac_f32_32x32x32_bf16 v[96:111], v[212:215], v[64:71], v15
    buffer_load_dwordx4 a[192:195], v251, s[16:19], 0 offen sc1
    buffer_load_dwordx4 a[196:199], v252, s[16:19], 0 offen sc1
    buffer_load_dwordx4 a[200:203], v13, s[16:19], 0 offen sc1
    v_exp_f32 v79, v79
    v_exp_f32 v16, v16
    v_exp_f32 v17, v17
    v_smfmac_f32_32x32x32_bf16 v[96:111], v[216:219], v[72:79], v15
    v_exp_f32 v18, v18
    v_exp_f32 v19, v19
    v_exp_f32 v20, v20
    v_mfma_f32_32x32x4bf16_1k v[48:79], v[202:203], v[166:167], 0
    v_exp_f32 v21, v21
    v_exp_f32 v22, v22
    v_exp_f32 v23, v23
    v_exp_f32 v24, v24
    v_exp_f32 v25, v25
    v_exp_f32 v26, v26
    v_exp_f32 v27, v27
    v_exp_f32 v28, v28
    v_exp_f32 v29, v29
    v_exp_f32 v30, v30
    v_smfmac_f32_32x32x32_bf16 v[112:127], v[204:207], v[16:23], v15
    s_add_u32 s16, s16, 98304
    s_addc_u32 s17, s17, 0
    v_exp_f32 v31, v31
    v_exp_f32 v32, v32
    v_exp_f32 v33, v33
    v_smfmac_f32_32x32x32_bf16 v[112:127], v[208:211], v[24:31], v15
    buffer_load_dwordx4 a[204:207], v251, s[16:19], 0 offen sc1
    buffer_load_dwordx4 a[208:211], v252, s[16:19], 0 offen sc1
    buffer_load_dwordx4 a[212:215], v13, s[16:19], 0 offen sc1
    v_exp_f32 v34, v34
    v_exp_f32 v35, v35
    v_exp_f32 v36, v36
    v_mfma_f32_32x32x16_bf16 v[48:63], v[194:197], v[160:163], v[48:63]
    v_exp_f32 v37, v37
    v_exp_f32 v38, v38
    v_exp_f32 v39, v39
    v_mfma_f32_32x32x16_bf16 v[64:79], v[198:201], v[160:163], v[64:79]
    v_exp_f32 v40, v40
    v_exp_f32 v41, v41
    v_exp_f32 v42, v42
    v_exp_f32 v43, v43
    v_exp_f32 v44, v44
    v_exp_f32 v45, v45
    v_exp_f32 v46, v46
    v_smfmac_f32_32x32x32_bf16 v[112:127], v[212:215], v[32:39], v15
    v_exp_f32 v47, v47
    v_exp_f32 v48, v48
    v_exp_f32 v49, v49
    v_smfmac_f32_32x32x32_bf16 v[112:127], v[216:219], v[40:47], v15
    s_waitcnt vmcnt(30)
    s_waitcnt vmcnt(13)
    v_cmp_gt_u32 vcc, 32, v12
    v_exp_f32 v50, v50
    v_exp_f32 v51, v51
    v_exp_f32 v52, v52
    v_mfma_f32_32x32x4bf16_1k v[16:47], v[228:229], v[152:153], 0
    v_exp_f32 v53, v53
    v_exp_f32 v54, v54
    v_exp_f32 v55, v55
    v_exp_f32 v56, v56
    v_exp_f32 v57, v57
    v_exp_f32 v58, v58
    v_exp_f32 v59, v59
    v_exp_f32 v60, v60
    v_exp_f32 v61, v61
    v_exp_f32 v62, v62
    v_smfmac_f32_32x32x32_bf16 v[128:143], v[204:207], v[48:55], v15
    buffer_load_dwordx4 v[194:197], v4, s[24:27], 0 offen
    buffer_load_dwordx4 v[198:201], v4, s[24:27], 0 offen offset:1024
    buffer_load_dwordx2 v[202:203], v5, s[24:27], 0 offen offset:2048
    v_exp_f32 v63, v63
    v_exp_f32 v64, v64
    v_exp_f32 v65, v65
    v_smfmac_f32_32x32x32_bf16 v[128:143], v[208:211], v[56:63], v15
    s_cbranch_vccnz L_w_slow
L_w_ok:
    v_exp_f32 v66, v66
    v_exp_f32 v67, v67
    v_exp_f32 v68, v68
    v_mfma_f32_32x32x16_bf16 v[16:31], v[220:223], v[144:147], v[16:31]
    v_exp_f32 v69, v69
    v_exp_f32 v70, v70
    v_exp_f32 v71, v71
    v_mfma_f32_32x32x16_bf16 v[32:47], v[224:227], v[144:147], v[32:47]
    v_exp_f32 v72, v72
    v_exp_f32 v73, v73
    v_exp_f32 v74, v74
    v_exp_f32 v75, v75
    v_exp_f32 v76, v76
    v_exp_f32 v77, v77
    v_exp_f32 v78, v78
    v_smfmac_f32_32x32x32_bf16 v[128:143], v[212:215], v[64:71], v15
    s_waitcnt vmcnt(29)
    s_bfm_b64 exec, 20, 0
    buffer_load_dword v14, v10, s[28:31], s47 offen offset:0 sc1
    s_mov_b64 exec, -1
    v_exp_f32 v79, v79
    v_exp_f32 v16, v16
    v_exp_f32 v17, v17
    v_smfmac_f32_32x32x32_bf16 v[128:143], v[216:219], v[72:79], v15
    buffer_load_dwordx4 v[204:207], v6, s[24:27], 0 offen offset:0
    buffer_load_dwordx4 v[208:211], v6, s[24:27], 0 offen offset:768
    v_exp_f32 v18, v18
    v_exp_f32 v19, v19
    v_exp_f32 v20, v20
    v_mfma_f32_32x32x4bf16_1k v[48:79], v[228:229], v[154:155], 0
    v_exp_f32 v21, v21
    v_exp_f32 v22, v22
    v_exp_f32 v23, v23
    v_exp_f32 v24, v24
    v_exp_f32 v25, v25
    v_exp_f32 v26, v26
    v_exp_f32 v27, v27
    v_exp_f32 v28, v28
    v_exp_f32 v29, v29
    v_exp_f32 v30, v30
    v_smfmac_f32_32x32x32_bf16 v[80:95], v[230:233], v[16:23], v15
    v_exp_f32 v31, v31
    v_exp_f32 v32, v32
    v_exp_f32 v33, v33
    v_smfmac_f32_32x32x32_bf16 v[80:95], v[234:237], v[24:31], v15
    buffer_load_dwordx4 v[212:215], v6, s[24:27], 0 offen offset:1536
    buffer_load_dwordx4 v[216:219], v6, s[24:27], 0 offen offset:2304
    v_exp_f32 v34, v34
    v_exp_f32 v35, v35
    v_exp_f32 v36, v36
    v_mfma_f32_32x32x16_bf16 v[48:63], v[220:223], v[148:151], v[48:63]
    v_exp_f32 v37, v37
    v_exp_f32 v38, v38
    v_exp_f32 v39, v39
    v_mfma_f32_32x32x16_bf16 v[64:79], v[224:227], v[148:151], v[64:79]
    v_exp_f32 v40, v40
    v_exp_f32 v41, v41
    v_exp_f32 v42, v42
    v_exp_f32 v43, v43
    v_exp_f32 v44, v44
L_warm1_2:
    s_cbranch_execz L_warm1_ret
    v_exp_f32 v45, v45
    v_exp_f32 v46, v46
    v_smfmac_f32_32x32x32_bf16 v[80:95], v[238:241], v[32:39], v15
    s_add_u32 s24, s24, 5632
    s_addc_u32 s25, s25, 0
    v_exp_f32 v47, v47
    v_exp_f32 v48, v48
    v_exp_f32 v49, v49
    v_smfmac_f32_32x32x32_bf16 v[80:95], v[242:245], v[40:47], v15
    s_add_u32 s16, s16, 98304
    s_addc_u32 s17, s17, 0
    v_exp_f32 v50, v50
    v_exp_f32 v51, v51
    v_exp_f32 v52, v52
    v_mfma_f32_32x32x4bf16_1k v[16:47], v[228:229], v[164:165], 0
    v_exp_f32 v53, v53
    v_exp_f32 v54, v54
    v_exp_f32 v55, v55
    v_exp_f32 v56, v56
    v_exp_f32 v57, v57
    v_exp_f32 v58, v58
    v_exp_f32 v59, v59
    v_exp_f32 v60, v60
    v_exp_f32 v61, v61
    v_exp_f32 v62, v62
    v_smfmac_f32_32x32x32_bf16 v[96:111], v[230:233], v[48:55], v15
    buffer_load_dwordx4 a[216:219], v251, s[16:19], 0 offen sc1
    buffer_load_dwordx4 a[220:223], v252, s[16:19], 0 offen sc1
    buffer_load_dwordx4 a[224:227], v13, s[16:19], 0 offen sc1
    v_exp_f32 v63, v63
    v_exp_f32 v64, v64
    v_exp_f32 v65, v65
    v_smfmac_f32_32x32x32_bf16 v[96:111], v[234:237], v[56:63], v15
    v_exp_f32 v66, v66
    v_exp_f32 v67, v67
    v_exp_f32 v68, v68
    v_mfma_f32_32x32x16_bf16 v[16:31], v[220:223], v[156:159], v[16:31]
    v_exp_f32 v69, v69
    v_exp_f32 v70, v70
    v_exp_f32 v71, v71
    v_mfma_f32_32x32x16_bf16 v[32:47], v[224:227], v[156:159], v[32:47]
    s_add_u32 s16, s16, 98304
    s_addc_u32 s17, s17, 0
    v_exp_f32 v72, v72
    v_exp_f32 v73, v73
    v_exp_f32 v74, v74
    v_exp_f32 v75, v75
    v_exp_f32 v76, v76
    v_exp_f32 v77, v77
    v_exp_f32 v78, v78
    v_smfmac_f32_32x32x32_bf16 v[96:111], v[238:241], v[64:71], v15
    buffer_load_dwordx4 a[228:231], v251, s[16:19], 0 offen sc1
    buffer_load_dwordx4 a[232:235], v252, s[16:19], 0 offen sc1
    buffer_load_dwordx4 a[236:239], v13, s[16:19], 0 offen sc1
    v_exp_f32 v79, v79
    v_exp_f32 v16, v16
    v_exp_f32 v17, v17
    v_smfmac_f32_32x32x32_bf16 v[96:111], v[242:245], v[72:79], v15
    v_exp_f32 v18, v18
    v_exp_f32 v19, v19
    v_exp_f32 v20, v20
    v_mfma_f32_32x32x4bf16_1k v[48:79], v[228:229], v[166:167], 0
    v_exp_f32 v21, v21
    v_exp_f32 v22, v22
    v_exp_f32 v23, v23
    v_exp_f32 v24, v24
    v_exp_f32 v25, v25
    v_exp_f32 v26, v26
    v_exp_f32 v27, v27
    v_exp_f32 v28, v28
    v_exp_f32 v29, v29
    v_exp_f32 v30, v30
    v_smfmac_f32_32x32x32_bf16 v[112:127], v[230:233], v[16:23], v15
    s_add_u32 m0, s11, 0
    s_add_u32 s20, s48, 0
    s_addc_u32 s21, s49, 0
    v_exp_f32 v31, v31
    v_exp_f32 v32, v32
    v_exp_f32 v33, v33
    v_smfmac_f32_32x32x32_bf16 v[112:127], v[234:237], v[24:31], v15
    buffer_load_dwordx4 v4, s[20:23], 0 offen offset:0 sc1 lds
    buffer_load_dwordx4 v4, s[20:23], 0 offen offset:1024 sc1 lds
    buffer_load_dwordx4 v4, s[20:23], 0 offen offset:2048 sc1 lds
    v_exp_f32 v34, v34
    v_exp_f32 v35, v35
    v_exp_f32 v36, v36
    v_mfma_f32_32x32x16_bf16 v[48:63], v[220:223], v[160:163], v[48:63]
    v_exp_f32 v37, v37
    v_exp_f32 v38, v38
    v_exp_f32 v39, v39
    v_mfma_f32_32x32x16_bf16 v[64:79], v[224:227], v[160:163], v[64:79]
    v_exp_f32 v40, v40
    v_exp_f32 v41, v41
    v_exp_f32 v42, v42
    v_exp_f32 v43, v43
    v_exp_f32 v44, v44
    v_exp_f32 v45, v45
    v_exp_f32 v46, v46
    v_smfmac_f32_32x32x32_bf16 v[112:127], v[238:241], v[32:39], v15
    v_exp_f32 v47, v47
    v_exp_f32 v48, v48
    v_exp_f32 v49, v49
    v_smfmac_f32_32x32x32_bf16 v[112:127], v[242:245], v[40:47], v15
    s_waitcnt vmcnt(31)
    v_exp_f32 v50, v50
    v_exp_f32 v51, v51
    v_exp_f32 v52, v52
    v_mfma_f32_32x32x4bf16_1k v[16:47], v[176:177], v[152:153], 0
    v_exp_f32 v53, v53
    v_exp_f32 v54, v54
    v_exp_f32 v55, v55
    v_exp_f32 v56, v56
    v_exp_f32 v57, v57
    v_exp_f32 v58, v58
    v_exp_f32 v59, v59
    v_exp_f32 v60, v60
    v_exp_f32 v61, v61
    v_exp_f32 v62, v62
    v_smfmac_f32_32x32x32_bf16 v[128:143], v[230:233], v[48:55], v15
    buffer_load_dwordx4 v[220:223], v4, s[24:27], 0 offen
    buffer_load_dwordx4 v[224:227], v4, s[24:27], 0 offen offset:1024
    buffer_load_dwordx2 v[228:229], v5, s[24:27], 0 offen offset:2048
    v_exp_f32 v63, v63
    v_exp_f32 v64, v64
    v_exp_f32 v65, v65
    v_smfmac_f32_32x32x32_bf16 v[128:143], v[234:237], v[56:63], v15
    v_exp_f32 v66, v66
    v_exp_f32 v67, v67
    v_exp_f32 v68, v68
    v_mfma_f32_32x32x16_bf16 v[16:31], v[168:171], v[144:147], v[16:31]
    v_exp_f32 v69, v69
    v_exp_f32 v70, v70
    v_exp_f32 v71, v71
    v_mfma_f32_32x32x16_bf16 v[32:47], v[172:175], v[144:147], v[32:47]
    v_exp_f32 v72, v72
    v_exp_f32 v73, v73
    v_exp_f32 v74, v74
    v_exp_f32 v75, v75
    v_exp_f32 v76, v76
    v_exp_f32 v77, v77
    v_exp_f32 v78, v78
    v_smfmac_f32_32x32x32_bf16 v[128:143], v[238:241], v[64:71], v15
    s_waitcnt vmcnt(29)
    s_bfm_b64 exec, 20, 0
    buffer_load_dword v14, v10, s[28:31], s47 offen offset:2560 sc1
    s_mov_b64 exec, -1
    v_exp_f32 v79, v79
    v_exp_f32 v16, v16
    v_exp_f32 v17, v17
    v_smfmac_f32_32x32x32_bf16 v[128:143], v[242:245], v[72:79], v15
    buffer_load_dwordx4 v[230:233], v6, s[24:27], 0 offen offset:0
    buffer_load_dwordx4 v[234:237], v6, s[24:27], 0 offen offset:768
    v_exp_f32 v18, v18
    v_exp_f32 v19, v19
    v_exp_f32 v20, v20
    v_mfma_f32_32x32x4bf16_1k v[48:79], v[176:177], v[154:155], 0
    v_exp_f32 v21, v21
    v_exp_f32 v22, v22
    v_exp_f32 v23, v23
    v_exp_f32 v24, v24
    v_exp_f32 v25, v25
    v_exp_f32 v26, v26
    v_exp_f32 v27, v27
    v_exp_f32 v28, v28
    v_exp_f32 v29, v29
    v_exp_f32 v30, v30
    v_smfmac_f32_32x32x32_bf16 v[80:95], v[178:181], v[16:23], v15
    v_exp_f32 v31, v31
    v_exp_f32 v32, v32
    v_exp_f32 v33, v33
    v_smfmac_f32_32x32x32_bf16 v[80:95], v[182:185], v[24:31], v15
    buffer_load_dwordx4 v[238:241], v6, s[24:27], 0 offen offset:1536
    buffer_load_dwordx4 v[242:245], v6, s[24:27], 0 offen offset:2304
    v_exp_f32 v34, v34
    v_exp_f32 v35, v35
    v_exp_f32 v36, v36
    v_mfma_f32_32x32x16_bf16 v[48:63], v[168:171], v[148:151], v[48:63]
    v_exp_f32 v37, v37
    v_exp_f32 v38, v38
    v_exp_f32 v39, v39
    v_mfma_f32_32x32x16_bf16 v[64:79], v[172:175], v[148:151], v[64:79]
    v_exp_f32 v40, v40
    v_exp_f32 v41, v41
    v_exp_f32 v42, v42
    v_exp_f32 v43, v43
    v_exp_f32 v44, v44
    v_exp_f32 v45, v45
    v_exp_f32 v46, v46
    v_smfmac_f32_32x32x32_bf16 v[80:95], v[186:189], v[32:39], v15
    s_add_u32 s24, s24, 5632
    s_addc_u32 s25, s25, 0
    v_exp_f32 v47, v47
    v_exp_f32 v48, v48
    v_exp_f32 v49, v49
    v_smfmac_f32_32x32x32_bf16 v[80:95], v[190:193], v[40:47], v15
    v_exp_f32 v50, v50
    v_exp_f32 v51, v51
    v_exp_f32 v52, v52
    v_mfma_f32_32x32x4bf16_1k v[16:47], v[176:177], v[164:165], 0
    v_exp_f32 v53, v53
    v_exp_f32 v54, v54
    v_exp_f32 v55, v55
    v_exp_f32 v56, v56
    v_exp_f32 v57, v57
    v_exp_f32 v58, v58
    v_exp_f32 v59, v59
    v_exp_f32 v60, v60
    v_exp_f32 v61, v61
    v_exp_f32 v62, v62
    v_smfmac_f32_32x32x32_bf16 v[96:111], v[178:181], v[48:55], v15
    buffer_load_dwordx4 v4, s[20:23], 0 offen offset:3072 sc1 lds
    s_add_u32 m0, m0, 4096
    s_nop 0
    buffer_load_dwordx4 v9, s[20:23], 0 offen sc1 lds
    s_add_u32 m0, s11, 5120
    s_add_u32 s20, s48, 40960
    s_addc_u32 s21, s49, 0
    buffer_load_dwordx4 v4, s[20:23], 0 offen offset:0 sc1 lds
    v_exp_f32 v63, v63
    v_exp_f32 v64, v64
    v_exp_f32 v65, v65
    v_smfmac_f32_32x32x32_bf16 v[96:111], v[182:185], v[56:63], v15
    v_exp_f32 v66, v66
    v_exp_f32 v67, v67
    v_exp_f32 v68, v68
    v_mfma_f32_32x32x16_bf16 v[16:31], v[168:171], v[156:159], v[16:31]
    v_exp_f32 v69, v69
    v_exp_f32 v70, v70
    v_exp_f32 v71, v71
    v_mfma_f32_32x32x16_bf16 v[32:47], v[172:175], v[156:159], v[32:47]
    v_exp_f32 v72, v72
    v_exp_f32 v73, v73
    v_exp_f32 v74, v74
    v_exp_f32 v75, v75
    v_exp_f32 v76, v76
    v_exp_f32 v77, v77
    v_exp_f32 v78, v78
    v_smfmac_f32_32x32x32_bf16 v[96:111], v[186:189], v[64:71], v15
    buffer_load_dwordx4 v4, s[20:23], 0 offen offset:1024 sc1 lds
    buffer_load_dwordx4 v4, s[20:23], 0 offen offset:2048 sc1 lds
    buffer_load_dwordx4 v4, s[20:23], 0 offen offset:3072 sc1 lds
    v_exp_f32 v79, v79
    v_exp_f32 v16, v16
    v_exp_f32 v17, v17
    v_smfmac_f32_32x32x32_bf16 v[96:111], v[190:193], v[72:79], v15
    v_exp_f32 v18, v18
    v_exp_f32 v19, v19
    v_exp_f32 v20, v20
    v_mfma_f32_32x32x4bf16_1k v[48:79], v[176:177], v[166:167], 0
    v_exp_f32 v21, v21
    v_exp_f32 v22, v22
    v_exp_f32 v23, v23
    v_exp_f32 v24, v24
    v_exp_f32 v25, v25
    v_exp_f32 v26, v26
    v_exp_f32 v27, v27
    v_exp_f32 v28, v28
    v_exp_f32 v29, v29
    v_exp_f32 v30, v30
    v_smfmac_f32_32x32x32_bf16 v[112:127], v[178:181], v[16:23], v15
    s_add_u32 m0, m0, 4096
    v_exp_f32 v31, v31
    v_exp_f32 v32, v32
    v_exp_f32 v33, v33
    v_smfmac_f32_32x32x32_bf16 v[112:127], v[182:185], v[24:31], v15
    buffer_load_dwordx4 v9, s[20:23], 0 offen sc1 lds
    s_add_u32 m0, s11, 10240
    s_add_u32 s20, s48, 81920
    s_addc_u32 s21, s49, 0
    buffer_load_dwordx4 v4, s[20:23], 0 offen offset:0 sc1 lds
    buffer_load_dwordx4 v4, s[20:23], 0 offen offset:1024 sc1 lds
    v_exp_f32 v34, v34
    v_exp_f32 v35, v35
    v_exp_f32 v36, v36
    v_mfma_f32_32x32x16_bf16 v[48:63], v[168:171], v[160:163], v[48:63]
    v_exp_f32 v37, v37
    v_exp_f32 v38, v38
    v_exp_f32 v39, v39
    v_mfma_f32_32x32x16_bf16 v[64:79], v[172:175], v[160:163], v[64:79]
    v_exp_f32 v40, v40
    v_exp_f32 v41, v41
    v_exp_f32 v42, v42
    v_exp_f32 v43, v43
    v_exp_f32 v44, v44
    v_exp_f32 v45, v45
    v_exp_f32 v46, v46
    v_smfmac_f32_32x32x32_bf16 v[112:127], v[186:189], v[32:39], v15
    s_getpc_b64 s[12:13]
L_pc1:
    s_lshl_b32 s8, s55, 8
    v_exp_f32 v47, v47
    v_exp_f32 v48, v48
    v_exp_f32 v49, v49
    v_smfmac_f32_32x32x32_bf16 v[112:127], v[190:193], v[40:47], v15
    s_waitcnt vmcnt(31)
    v_add_u32 v254, s8, v10
        v_min_u32 v254, L_code_end-L_pc1-128, v254
    v_exp_f32 v50, v50
    v_exp_f32 v51, v51
    v_exp_f32 v52, v52
    v_mfma_f32_32x32x4bf16_1k v[16:47], v[202:203], v[152:153], 0
    v_exp_f32 v53, v53
    v_exp_f32 v54, v54
    v_exp_f32 v55, v55
    v_exp_f32 v56, v56
    v_exp_f32 v57, v57
    v_exp_f32 v58, v58
    v_exp_f32 v59, v59
    v_exp_f32 v60, v60
    v_exp_f32 v61, v61
    v_exp_f32 v62, v62
    v_smfmac_f32_32x32x32_bf16 v[128:143], v[178:181], v[48:55], v15
    buffer_load_dwordx4 v[168:171], v4, s[24:27], 0 offen
    buffer_load_dwordx4 v[172:175], v4, s[24:27], 0 offen offset:1024
    buffer_load_dwordx2 v[176:177], v5, s[24:27], 0 offen offset:2048
    v_exp_f32 v63, v63
    v_exp_f32 v64, v64
    v_exp_f32 v65, v65
    v_smfmac_f32_32x32x32_bf16 v[128:143], v[182:185], v[56:63], v15
    v_exp_f32 v66, v66
    v_exp_f32 v67, v67
    v_exp_f32 v68, v68
    v_mfma_f32_32x32x16_bf16 v[16:31], v[194:197], v[144:147], v[16:31]
    s_mul_i32 s8, s32, 768
    v_exp_f32 v69, v69
    v_exp_f32 v70, v70
    v_exp_f32 v71, v71
    v_mfma_f32_32x32x16_bf16 v[32:47], v[198:201], v[144:147], v[32:47]
    s_add_u32 s8, s8, s3
    v_exp_f32 v72, v72
    v_exp_f32 v73, v73
    v_exp_f32 v74, v74
    v_exp_f32 v75, v75
    v_exp_f32 v76, v76
    v_exp_f32 v77, v77
    v_exp_f32 v78, v78
    v_smfmac_f32_32x32x32_bf16 v[128:143], v[186:189], v[64:71], v15
    s_waitcnt vmcnt(29)
    s_mov_b64 exec, 3
    global_load_dword v14, v254, s[12:13]
    s_mov_b64 exec, 63
    buffer_load_dword v14, v10, s[28:31], s8 offen sc1
    s_mov_b64 exec, -1
    v_exp_f32 v79, v79
    v_exp_f32 v16, v16
    v_exp_f32 v17, v17
    v_smfmac_f32_32x32x32_bf16 v[128:143], v[190:193], v[72:79], v15
    buffer_load_dwordx4 v[178:181], v6, s[24:27], 0 offen offset:0
    buffer_load_dwordx4 v[182:185], v6, s[24:27], 0 offen offset:768
    v_exp_f32 v18, v18
    v_exp_f32 v19, v19
    v_exp_f32 v20, v20
    v_mfma_f32_32x32x4bf16_1k v[48:79], v[202:203], v[154:155], 0
    v_exp_f32 v21, v21
    v_exp_f32 v22, v22
    v_exp_f32 v23, v23
    v_exp_f32 v24, v24
    v_exp_f32 v25, v25
    v_exp_f32 v26, v26
    v_exp_f32 v27, v27
    v_exp_f32 v28, v28
    v_exp_f32 v29, v29
    v_exp_f32 v30, v30
    v_smfmac_f32_32x32x32_bf16 v[80:95], v[204:207], v[16:23], v15
    v_exp_f32 v31, v31
    v_exp_f32 v32, v32
    v_exp_f32 v33, v33
    v_smfmac_f32_32x32x32_bf16 v[80:95], v[208:211], v[24:31], v15
    buffer_load_dwordx4 v[186:189], v6, s[24:27], 0 offen offset:1536
    buffer_load_dwordx4 v[190:193], v6, s[24:27], 0 offen offset:2304
    v_exp_f32 v34, v34
    v_exp_f32 v35, v35
    v_exp_f32 v36, v36
    v_mfma_f32_32x32x16_bf16 v[48:63], v[194:197], v[148:151], v[48:63]
    v_exp_f32 v37, v37
    v_exp_f32 v38, v38
    v_exp_f32 v39, v39
    v_mfma_f32_32x32x16_bf16 v[64:79], v[198:201], v[148:151], v[64:79]
    v_exp_f32 v40, v40
    v_exp_f32 v41, v41
    v_exp_f32 v42, v42
    v_exp_f32 v43, v43
    v_exp_f32 v44, v44
    v_exp_f32 v45, v45
    v_exp_f32 v46, v46
    v_smfmac_f32_32x32x32_bf16 v[80:95], v[212:215], v[32:39], v15
    v_exp_f32 v47, v47
    v_exp_f32 v48, v48
    v_exp_f32 v49, v49
    v_smfmac_f32_32x32x32_bf16 v[80:95], v[216:219], v[40:47], v15
    v_exp_f32 v50, v50
    v_exp_f32 v51, v51
    v_exp_f32 v52, v52
    v_mfma_f32_32x32x4bf16_1k v[16:47], v[202:203], v[164:165], 0
    v_exp_f32 v53, v53
    v_exp_f32 v54, v54
    v_exp_f32 v55, v55
    v_exp_f32 v56, v56
    v_exp_f32 v57, v57
    v_exp_f32 v58, v58
    v_exp_f32 v59, v59
    v_exp_f32 v60, v60
    v_exp_f32 v61, v61
    v_exp_f32 v62, v62
    v_smfmac_f32_32x32x32_bf16 v[96:111], v[204:207], v[48:55], v15
    buffer_load_dwordx4 v4, s[20:23], 0 offen offset:2048 sc1 lds
    buffer_load_dwordx4 v4, s[20:23], 0 offen offset:3072 sc1 lds
    s_add_u32 m0, m0, 4096
    s_nop 0
    buffer_load_dwordx4 v9, s[20:23], 0 offen sc1 lds
    v_exp_f32 v63, v63
    v_exp_f32 v64, v64
    v_exp_f32 v65, v65
    v_smfmac_f32_32x32x32_bf16 v[96:111], v[208:211], v[56:63], v15
    v_exp_f32 v66, v66
    v_exp_f32 v67, v67
    v_exp_f32 v68, v68
    v_mfma_f32_32x32x16_bf16 v[16:31], v[194:197], v[156:159], v[16:31]
    v_exp_f32 v69, v69
    v_exp_f32 v70, v70
    v_exp_f32 v71, v71
    v_mfma_f32_32x32x16_bf16 v[32:47], v[198:201], v[156:159], v[32:47]
    s_add_u32 m0, s11, 15360
    s_add_u32 s20, s48, 122880
    s_addc_u32 s21, s49, 0
    v_exp_f32 v72, v72
    v_exp_f32 v73, v73
    v_exp_f32 v74, v74
    v_exp_f32 v75, v75
    v_exp_f32 v76, v76
    v_exp_f32 v77, v77
    v_exp_f32 v78, v78
    v_smfmac_f32_32x32x32_bf16 v[96:111], v[212:215], v[64:71], v15
    buffer_load_dwordx4 v4, s[20:23], 0 offen offset:0 sc1 lds
    buffer_load_dwordx4 v4, s[20:23], 0 offen offset:1024 sc1 lds
    buffer_load_dwordx4 v4, s[20:23], 0 offen offset:2048 sc1 lds
    v_exp_f32 v79, v79
    v_exp_f32 v16, v16
    v_exp_f32 v17, v17
    v_smfmac_f32_32x32x32_bf16 v[96:111], v[216:219], v[72:79], v15
    v_exp_f32 v18, v18
    v_exp_f32 v19, v19
    v_exp_f32 v20, v20
    v_mfma_f32_32x32x4bf16_1k v[48:79], v[202:203], v[166:167], 0
    v_exp_f32 v21, v21
    v_exp_f32 v22, v22
    v_exp_f32 v23, v23
    v_exp_f32 v24, v24
    v_exp_f32 v25, v25
    v_exp_f32 v26, v26
    v_exp_f32 v27, v27
    v_exp_f32 v28, v28
    v_exp_f32 v29, v29
    v_exp_f32 v30, v30
    v_smfmac_f32_32x32x32_bf16 v[112:127], v[204:207], v[16:23], v15
    v_exp_f32 v31, v31
    v_exp_f32 v32, v32
    v_exp_f32 v33, v33
    v_smfmac_f32_32x32x32_bf16 v[112:127], v[208:211], v[24:31], v15
    buffer_load_dwordx4 v4, s[20:23], 0 offen offset:3072 sc1 lds
    s_add_u32 m0, m0, 4096
    s_nop 0
    buffer_load_dwordx4 v9, s[20:23], 0 offen sc1 lds
    s_add_u32 m0, s11, 20480
    s_add_u32 s20, s48, 163840
    s_addc_u32 s21, s49, 0
    buffer_load_dwordx4 v4, s[20:23], 0 offen offset:0 sc1 lds
    v_exp_f32 v34, v34
    v_exp_f32 v35, v35
    v_exp_f32 v36, v36
    v_mfma_f32_32x32x16_bf16 v[48:63], v[194:197], v[160:163], v[48:63]
    v_exp_f32 v37, v37
    v_exp_f32 v38, v38
    v_exp_f32 v39, v39
    v_mfma_f32_32x32x16_bf16 v[64:79], v[198:201], v[160:163], v[64:79]
    v_exp_f32 v40, v40
    v_exp_f32 v41, v41
    v_exp_f32 v42, v42
    v_exp_f32 v43, v43
    v_exp_f32 v44, v44
    v_exp_f32 v45, v45
    v_exp_f32 v46, v46
    v_smfmac_f32_32x32x32_bf16 v[112:127], v[212:215], v[32:39], v15
    v_exp_f32 v47, v47
    v_exp_f32 v48, v48
    v_exp_f32 v49, v49
    v_smfmac_f32_32x32x32_bf16 v[112:127], v[216:219], v[40:47], v15
    s_waitcnt vmcnt(32)
    v_exp_f32 v50, v50
    v_exp_f32 v51, v51
    v_exp_f32 v52, v52
    v_mfma_f32_32x32x4bf16_1k v[16:47], v[228:229], v[152:153], 0
    v_exp_f32 v53, v53
    v_exp_f32 v54, v54
    v_exp_f32 v55, v55
    v_exp_f32 v56, v56
    v_exp_f32 v57, v57
    v_exp_f32 v58, v58
    v_exp_f32 v59, v59
    v_exp_f32 v60, v60
    v_exp_f32 v61, v61
    v_exp_f32 v62, v62
    v_smfmac_f32_32x32x32_bf16 v[128:143], v[204:207], v[48:55], v15
    buffer_load_dwordx4 v4, s[20:23], 0 offen offset:1024 sc1 lds
    buffer_load_dwordx4 v4, s[20:23], 0 offen offset:2048 sc1 lds
    buffer_load_dwordx4 v4, s[20:23], 0 offen offset:3072 sc1 lds
    v_exp_f32 v63, v63
    v_exp_f32 v64, v64
    v_exp_f32 v65, v65
    v_smfmac_f32_32x32x32_bf16 v[128:143], v[208:211], v[56:63], v15
    v_exp_f32 v66, v66
    v_exp_f32 v67, v67
    v_exp_f32 v68, v68
    v_mfma_f32_32x32x16_bf16 v[16:31], v[220:223], v[144:147], v[16:31]
    v_exp_f32 v69, v69
    v_exp_f32 v70, v70
    v_exp_f32 v71, v71
    v_mfma_f32_32x32x16_bf16 v[32:47], v[224:227], v[144:147], v[32:47]
    v_exp_f32 v72, v72
    v_exp_f32 v73, v73
    v_exp_f32 v74, v74
    v_exp_f32 v75, v75
    v_exp_f32 v76, v76
    v_exp_f32 v77, v77
    v_exp_f32 v78, v78
    v_smfmac_f32_32x32x32_bf16 v[128:143], v[212:215], v[64:71], v15
    s_waitcnt vmcnt(30)
    v_exp_f32 v79, v79
    v_exp_f32 v16, v16
    v_exp_f32 v17, v17
    v_smfmac_f32_32x32x32_bf16 v[128:143], v[216:219], v[72:79], v15
    s_add_u32 m0, m0, 4096
    v_exp_f32 v18, v18
    v_exp_f32 v19, v19
    v_exp_f32 v20, v20
    v_mfma_f32_32x32x4bf16_1k v[48:79], v[228:229], v[154:155], 0
    v_exp_f32 v21, v21
    v_exp_f32 v22, v22
    v_exp_f32 v23, v23
    v_exp_f32 v24, v24
    v_exp_f32 v25, v25
    v_exp_f32 v26, v26
    v_exp_f32 v27, v27
    v_exp_f32 v28, v28
    v_exp_f32 v29, v29
    v_exp_f32 v30, v30
    v_smfmac_f32_32x32x32_bf16 v[80:95], v[230:233], v[16:23], v15
    buffer_load_dwordx4 v9, s[20:23], 0 offen sc1 lds
    s_add_u32 m0, s43, 125952
    s_add_u32 s20, s52, 286720
    s_addc_u32 s21, s53, 0
    buffer_load_dwordx4 v4, s[20:23], 0 offen offset:1024 sc1 lds
    buffer_load_dwordx4 v4, s[20:23], 0 offen offset:2048 sc1 lds
    v_exp_f32 v31, v31
    v_exp_f32 v32, v32
    v_exp_f32 v33, v33
    v_smfmac_f32_32x32x32_bf16 v[80:95], v[234:237], v[24:31], v15
    v_exp_f32 v34, v34
    v_exp_f32 v35, v35
    v_exp_f32 v36, v36
    v_mfma_f32_32x32x16_bf16 v[48:63], v[220:223], v[148:151], v[48:63]
    v_exp_f32 v37, v37
    v_exp_f32 v38, v38
    v_exp_f32 v39, v39
    v_mfma_f32_32x32x16_bf16 v[64:79], v[224:227], v[148:151], v[64:79]
    v_exp_f32 v40, v40
    v_exp_f32 v41, v41
    v_exp_f32 v42, v42
    v_exp_f32 v43, v43
    v_exp_f32 v44, v44
    v_exp_f32 v45, v45
    v_exp_f32 v46, v46
    v_smfmac_f32_32x32x32_bf16 v[80:95], v[238:241], v[32:39], v15
    buffer_load_dwordx4 v4, s[20:23], 0 offen offset:3072 sc1 lds
    s_add_u32 m0, s43, 130048
    s_nop 0
    buffer_load_dwordx4 v9, s[20:23], 0 offen offset:0 sc1 lds
    s_add_u32 m0, s43, 131072
    s_add_u32 s20, s52, 327680
    s_addc_u32 s21, s53, 0
    buffer_load_dwordx4 v4, s[20:23], 0 offen offset:0 sc1 lds
    v_exp_f32 v47, v47
    v_exp_f32 v48, v48
    v_exp_f32 v49, v49
    v_smfmac_f32_32x32x32_bf16 v[80:95], v[242:245], v[40:47], v15
    v_exp_f32 v50, v50
    v_exp_f32 v51, v51
    v_exp_f32 v52, v52
    v_mfma_f32_32x32x4bf16_1k v[16:47], v[228:229], v[164:165], 0
    v_exp_f32 v53, v53
    v_exp_f32 v54, v54
    v_exp_f32 v55, v55
    v_exp_f32 v56, v56
    v_exp_f32 v57, v57
    v_exp_f32 v58, v58
    v_exp_f32 v59, v59
    v_exp_f32 v60, v60
    v_exp_f32 v61, v61
    v_exp_f32 v62, v62
    v_smfmac_f32_32x32x32_bf16 v[96:111], v[230:233], v[48:55], v15
    buffer_load_dwordx4 v4, s[20:23], 0 offen offset:1024 sc1 lds
    buffer_load_dwordx4 v4, s[20:23], 0 offen offset:2048 sc1 lds
    buffer_load_dwordx4 v4, s[20:23], 0 offen offset:3072 sc1 lds
    v_exp_f32 v63, v63
    v_exp_f32 v64, v64
    v_exp_f32 v65, v65
    v_smfmac_f32_32x32x32_bf16 v[96:111], v[234:237], v[56:63], v15
    v_exp_f32 v66, v66
    v_exp_f32 v67, v67
    v_exp_f32 v68, v68
    v_mfma_f32_32x32x16_bf16 v[16:31], v[220:223], v[156:159], v[16:31]
    v_exp_f32 v69, v69
    v_exp_f32 v70, v70
    v_exp_f32 v71, v71
    v_mfma_f32_32x32x16_bf16 v[32:47], v[224:227], v[156:159], v[32:47]
    s_add_u32 m0, s43, 135168
    v_exp_f32 v72, v72
    v_exp_f32 v73, v73
    v_exp_f32 v74, v74
    v_exp_f32 v75, v75
    v_exp_f32 v76, v76
    v_exp_f32 v77, v77
    v_exp_f32 v78, v78
    v_smfmac_f32_32x32x32_bf16 v[96:111], v[238:241], v[64:71], v15
    buffer_load_dwordx4 v9, s[20:23], 0 offen offset:0 sc1 lds
    s_add_u32 s20, s52, 0
    s_addc_u32 s21, s53, 0
    buffer_load_dwordx4 v[208:211], v4, s[20:23], 0 offen offset:0 sc1
    buffer_load_dwordx4 v[212:215], v4, s[20:23], 0 offen offset:1024 sc1
    v_exp_f32 v79, v79
    v_exp_f32 v16, v16
    v_exp_f32 v17, v17
    v_smfmac_f32_32x32x32_bf16 v[96:111], v[242:245], v[72:79], v15
    v_exp_f32 v18, v18
    v_exp_f32 v19, v19
    v_exp_f32 v20, v20
    v_mfma_f32_32x32x4bf16_1k v[48:79], v[228:229], v[166:167], 0
    v_exp_f32 v21, v21
    v_exp_f32 v22, v22
    v_exp_f32 v23, v23
    v_exp_f32 v24, v24
    v_exp_f32 v25, v25
    v_exp_f32 v26, v26
    v_exp_f32 v27, v27
    v_exp_f32 v28, v28
    v_exp_f32 v29, v29
    v_exp_f32 v30, v30
    v_smfmac_f32_32x32x32_bf16 v[112:127], v[230:233], v[16:23], v15
    v_exp_f32 v31, v31
    v_exp_f32 v32, v32
    v_exp_f32 v33, v33
    v_smfmac_f32_32x32x32_bf16 v[112:127], v[234:237], v[24:31], v15
    buffer_load_dwordx4 v[216:219], v4, s[20:23], 0 offen offset:2048 sc1
    v_exp_f32 v34, v34
    v_exp_f32 v35, v35
    v_exp_f32 v36, v36
    v_mfma_f32_32x32x16_bf16 v[48:63], v[220:223], v[160:163], v[48:63]
    v_exp_f32 v37, v37
    v_exp_f32 v38, v38
    v_exp_f32 v39, v39
    v_mfma_f32_32x32x16_bf16 v[64:79], v[224:227], v[160:163], v[64:79]
    v_exp_f32 v40, v40
    v_exp_f32 v41, v41
    v_exp_f32 v42, v42
    v_exp_f32 v43, v43
    v_exp_f32 v44, v44
    v_exp_f32 v45, v45
    v_exp_f32 v46, v46
    v_smfmac_f32_32x32x32_bf16 v[112:127], v[238:241], v[32:39], v15
    v_exp_f32 v47, v47
    v_exp_f32 v48, v48
    v_exp_f32 v49, v49
    v_smfmac_f32_32x32x32_bf16 v[112:127], v[242:245], v[40:47], v15
    s_waitcnt vmcnt(31)
    v_exp_f32 v50, v50
    v_exp_f32 v51, v51
    v_exp_f32 v52, v52
    v_mfma_f32_32x32x4bf16_1k v[16:47], v[176:177], v[152:153], 0
    v_exp_f32 v53, v53
    v_exp_f32 v54, v54
    v_exp_f32 v55, v55
    v_exp_f32 v56, v56
    v_exp_f32 v57, v57
    v_exp_f32 v58, v58
    v_exp_f32 v59, v59
    v_exp_f32 v60, v60
    v_exp_f32 v61, v61
    v_exp_f32 v62, v62
    v_smfmac_f32_32x32x32_bf16 v[128:143], v[230:233], v[48:55], v15
    v_exp_f32 v63, v63
    v_exp_f32 v64, v64
    v_exp_f32 v65, v65
    v_smfmac_f32_32x32x32_bf16 v[128:143], v[234:237], v[56:63], v15
    v_exp_f32 v66, v66
    v_exp_f32 v67, v67
    v_exp_f32 v68, v68
    v_mfma_f32_32x32x16_bf16 v[16:31], v[168:171], v[144:147], v[16:31]
    v_exp_f32 v69, v69
    v_exp_f32 v70, v70
    v_exp_f32 v71, v71
    v_mfma_f32_32x32x16_bf16 v[32:47], v[172:175], v[144:147], v[32:47]
    v_exp_f32 v72, v72
    v_exp_f32 v73, v73
    v_exp_f32 v74, v74
    v_exp_f32 v75, v75
    v_exp_f32 v76, v76
    v_exp_f32 v77, v77
    v_exp_f32 v78, v78
    v_smfmac_f32_32x32x32_bf16 v[128:143], v[238:241], v[64:71], v15
    s_waitcnt vmcnt(25)
    v_exp_f32 v79, v79
    v_exp_f32 v16, v16
    v_exp_f32 v17, v17
    v_smfmac_f32_32x32x32_bf16 v[128:143], v[242:245], v[72:79], v15
    s_add_u32 s20, s52, 0
    s_addc_u32 s21, s53, 0
    v_exp_f32 v18, v18
    v_exp_f32 v19, v19
    v_exp_f32 v20, v20
    v_mfma_f32_32x32x4bf16_1k v[48:79], v[176:177], v[154:155], 0
    v_exp_f32 v21, v21
    v_exp_f32 v22, v22
    v_exp_f32 v23, v23
    v_exp_f32 v24, v24
    v_exp_f32 v25, v25
    v_exp_f32 v26, v26
    v_exp_f32 v27, v27
    v_exp_f32 v28, v28
    v_exp_f32 v29, v29
    v_exp_f32 v30, v30
    v_smfmac_f32_32x32x32_bf16 v[80:95], v[178:181], v[16:23], v15
    buffer_load_dwordx4 v[220:223], v4, s[20:23], 0 offen offset:3072 sc1
    buffer_load_dwordx4 v[224:227], v9, s[20:23], 0 offen offset:0 sc1
    s_add_u32 s20, s52, 40960
    s_addc_u32 s21, s53, 0
    buffer_load_dwordx4 v[228:231], v4, s[20:23], 0 offen offset:0 sc1
    v_exp_f32 v31, v31
    v_exp_f32 v32, v32
    v_exp_f32 v33, v33
    v_smfmac_f32_32x32x32_bf16 v[80:95], v[182:185], v[24:31], v15
    s_add_u32 s8, s42, 102400
    s_mov_b32 s35, 0
    v_add_u32 v12, s8, v4
    v_exp_f32 v34, v34
    v_exp_f32 v35, v35
    v_exp_f32 v36, v36
    v_mfma_f32_32x32x16_bf16 v[48:63], v[168:171], v[148:151], v[48:63]
    s_xor_b32 s9, s32, 1
    s_mul_i32 s9, s9, 6144
    v_lshrrev_b32 v10, 4, v7
    v_exp_f32 v37, v37
    v_exp_f32 v38, v38
    v_exp_f32 v39, v39
    v_mfma_f32_32x32x16_bf16 v[64:79], v[172:175], v[148:151], v[64:79]
    s_add_u32 s9, s9, 102400
    s_and_b32 s38, s33, 1
    v_add_u32 v13, s9, v4
    v_exp_f32 v40, v40
    v_exp_f32 v41, v41
    v_exp_f32 v42, v42
    v_exp_f32 v43, v43
    v_exp_f32 v44, v44
    v_exp_f32 v45, v45
    v_exp_f32 v46, v46
    v_smfmac_f32_32x32x32_bf16 v[80:95], v[186:189], v[32:39], v15
    s_lshl1_add_u32 s38, s38, s37
    s_lshl_b32 s38, s38, 7
    v_mul_u32_u24 v10, 20480, v10
    v_exp_f32 v47, v47
    v_exp_f32 v48, v48
    v_exp_f32 v49, v49
    v_smfmac_f32_32x32x32_bf16 v[80:95], v[190:193], v[40:47], v15
    s_add_u32 s38, s38, s3
    s_lshl_b32 s39, s34, 1
    v_lshl_add_u32 v10, v2, 4, v10
    v_exp_f32 v50, v50
    v_exp_f32 v51, v51
    v_exp_f32 v52, v52
    v_mfma_f32_32x32x4bf16_1k v[16:47], v[176:177], v[164:165], 0
    v_exp_f32 v53, v53
    v_exp_f32 v54, v54
    v_exp_f32 v55, v55
    v_exp_f32 v56, v56
    v_exp_f32 v57, v57
    v_exp_f32 v58, v58
    v_exp_f32 v59, v59
    v_exp_f32 v60, v60
    v_exp_f32 v61, v61
    v_exp_f32 v62, v62
    v_smfmac_f32_32x32x32_bf16 v[96:111], v[178:181], v[48:55], v15
    buffer_load_dwordx4 v[232:235], v4, s[20:23], 0 offen offset:1024 sc1
    buffer_load_dwordx4 v[236:239], v4, s[20:23], 0 offen offset:2048 sc1
    buffer_load_dwordx4 v[240:243], v4, s[20:23], 0 offen offset:3072 sc1
    v_exp_f32 v63, v63
    v_exp_f32 v64, v64
    v_exp_f32 v65, v65
    v_smfmac_f32_32x32x32_bf16 v[96:111], v[182:185], v[56:63], v15
    ds_write_b128 v12, v[80:83] offset:0
    v_exp_f32 v66, v66
    v_exp_f32 v67, v67
    v_exp_f32 v68, v68
    v_mfma_f32_32x32x16_bf16 v[16:31], v[168:171], v[156:159], v[16:31]
    ds_write_b128 v12, v[84:87] offset:1024
    v_exp_f32 v69, v69
    v_exp_f32 v70, v70
    v_exp_f32 v71, v71
    v_mfma_f32_32x32x16_bf16 v[32:47], v[172:175], v[156:159], v[32:47]
L_warm1_3:
    s_cbranch_execz L_warm1_ret
    ds_write_b128 v12, v[88:91] offset:2048
    v_exp_f32 v72, v72
    v_exp_f32 v73, v73
    v_exp_f32 v74, v74
    v_exp_f32 v75, v75
    v_exp_f32 v76, v76
    v_exp_f32 v77, v77
    v_exp_f32 v78, v78
    v_smfmac_f32_32x32x32_bf16 v[96:111], v[186:189], v[64:71], v15
    s_add_u32 s39, s39, s36
    s_lshl_b32 s39, s39, 2
    v_lshl_add_u32 v10, v8, 8, v10
    v_exp_f32 v79, v79
    v_exp_f32 v16, v16
    v_exp_f32 v17, v17
    v_smfmac_f32_32x32x32_bf16 v[96:111], v[190:193], v[72:79], v15
    buffer_load_dwordx4 v[244:247], v9, s[20:23], 0 offen offset:0 sc1
    s_add_u32 s20, s52, 81920
    s_addc_u32 s21, s53, 0
    buffer_load_dwordx4 v[248:251], v4, s[20:23], 0 offen offset:0 sc1
    buffer_load_dwordx4 v[252:255], v4, s[20:23], 0 offen offset:1024 sc1
    v_exp_f32 v18, v18
    v_exp_f32 v19, v19
    v_exp_f32 v20, v20
    v_mfma_f32_32x32x4bf16_1k v[48:79], v[176:177], v[166:167], 0
    v_exp_f32 v21, v21
    v_exp_f32 v22, v22
    v_exp_f32 v23, v23
    v_exp_f32 v24, v24
    v_exp_f32 v25, v25
    v_exp_f32 v26, v26
    v_exp_f32 v27, v27
    v_exp_f32 v28, v28
    v_exp_f32 v29, v29
    v_exp_f32 v30, v30
    v_smfmac_f32_32x32x32_bf16 v[112:127], v[178:181], v[16:23], v15
    s_add_u32 s39, s39, s38
    s_mov_b32 s8, 0x3a800000
    v_lshlrev_b32 v11, 2, v2
    v_exp_f32 v31, v31
    v_exp_f32 v32, v32
    v_exp_f32 v33, v33
    v_smfmac_f32_32x32x32_bf16 v[112:127], v[182:185], v[24:31], v15
    ds_write_b128 v12, v[96:99] offset:3072
    v_exp_f32 v34, v34
    v_exp_f32 v35, v35
    v_exp_f32 v36, v36
    v_mfma_f32_32x32x16_bf16 v[48:63], v[168:171], v[160:163], v[48:63]
    ds_write_b128 v12, v[100:103] offset:4096
    v_exp_f32 v37, v37
    v_exp_f32 v38, v38
    v_exp_f32 v39, v39
    v_mfma_f32_32x32x16_bf16 v[64:79], v[172:175], v[160:163], v[64:79]
    ds_write_b128 v12, v[104:107] offset:5120
    v_exp_f32 v40, v40
    v_exp_f32 v41, v41
    v_exp_f32 v42, v42
    v_exp_f32 v43, v43
    v_exp_f32 v44, v44
    v_exp_f32 v45, v45
    v_exp_f32 v46, v46
    v_smfmac_f32_32x32x32_bf16 v[112:127], v[186:189], v[32:39], v15
    s_mov_b32 s9, 0x5d800000
    v_exp_f32 v47, v47
    v_exp_f32 v48, v48
    v_exp_f32 v49, v49
    v_smfmac_f32_32x32x32_bf16 v[112:127], v[190:193], v[40:47], v15
    s_waitcnt vmcnt(21) lgkmcnt(0)
    s_barrier
    v_exp_f32 v50, v50
    v_exp_f32 v51, v51
    v_exp_f32 v52, v52
    v_exp_f32 v53, v53
    v_exp_f32 v54, v54
    v_exp_f32 v55, v55
    v_exp_f32 v56, v56
    v_exp_f32 v57, v57
    v_exp_f32 v58, v58
    v_exp_f32 v59, v59
    v_exp_f32 v60, v60
    v_exp_f32 v61, v61
    v_exp_f32 v62, v62
    v_smfmac_f32_32x32x32_bf16 v[128:143], v[178:181], v[48:55], v15
    ds_read_b128 v[16:19], v13 offset:0
    ds_read_b128 v[20:23], v13 offset:1024
    ds_read_b128 v[24:27], v13 offset:2048
    v_exp_f32 v63, v63
    v_exp_f32 v64, v64
    v_exp_f32 v65, v65
    v_smfmac_f32_32x32x32_bf16 v[128:143], v[182:185], v[56:63], v15
    ds_read_b128 v[32:35], v13 offset:3072
    ds_read_b128 v[36:39], v13 offset:4096
    ds_read_b128 v[40:43], v13 offset:5120
    v_exp_f32 v66, v66
    v_exp_f32 v67, v67
    v_exp_f32 v68, v68
    v_exp_f32 v69, v69
    v_exp_f32 v70, v70
    v_exp_f32 v71, v71
    v_exp_f32 v72, v72
    v_exp_f32 v73, v73
    v_exp_f32 v74, v74
    v_exp_f32 v75, v75
    v_exp_f32 v76, v76
    v_exp_f32 v77, v77
    v_exp_f32 v78, v78
    v_smfmac_f32_32x32x32_bf16 v[128:143], v[186:189], v[64:71], v15
    v_exp_f32 v79, v79
    s_nop 1
    v_smfmac_f32_32x32x32_bf16 v[128:143], v[190:193], v[72:79], v15
    s_waitcnt lgkmcnt(0)
    v_add_f32 v112, v112, v16
    v_add_f32 v113, v113, v17
    v_add_f32 v114, v114, v18
    v_add_f32 v115, v115, v19
    v_add_f32 v116, v116, v20
    v_add_f32 v117, v117, v21
    v_add_f32 v118, v118, v22
    v_add_f32 v119, v119, v23
    v_add_f32 v120, v120, v24
    v_add_f32 v121, v121, v25
    v_add_f32 v122, v122, v26
    v_add_f32 v123, v123, v27
    v_add_f32 v128, v128, v32
    v_add_f32 v129, v129, v33
    v_add_f32 v130, v130, v34
    v_add_f32 v131, v131, v35
    v_add_f32 v132, v132, v36
    v_add_f32 v133, v133, v37
    v_add_f32 v134, v134, v38
    v_add_f32 v135, v135, v39
    v_add_f32 v136, v136, v40
    v_add_f32 v137, v137, v41
    v_add_f32 v138, v138, v42
    v_add_f32 v139, v139, v43
L_norm:
    v_mov_b32 v124, v120
    v_mov_b32 v125, v120
    v_mov_b32 v140, v136
    v_mov_b32 v141, v136
    v_permlane32_swap_b32 v124, v125
    s_nop 0
    v_permlane32_swap_b32 v140, v141
    v_cmp_le_f32 vcc, s8, v125
    v_cmp_ge_f32 s[10:11], s9, v125
    v_cmp_le_f32 s[12:13], s8, v141
    v_cmp_ge_f32 s[56:57], s9, v141
    v_rcp_f32 v125, v125
    v_rcp_f32 v141, v141
    s_and_b64 vcc, vcc, s[10:11]
    s_and_b64 s[12:13], s[12:13], s[56:57]
    s_and_b64 s[12:13], vcc, s[12:13]
    v_pk_mul_f32 v[112:113], v[112:113], v[124:125] op_sel:[0,1] op_sel_hi:[1,1]
    v_pk_mul_f32 v[114:115], v[114:115], v[124:125] op_sel:[0,1] op_sel_hi:[1,1]
    v_pk_mul_f32 v[116:117], v[116:117], v[124:125] op_sel:[0,1] op_sel_hi:[1,1]
    v_pk_mul_f32 v[118:119], v[118:119], v[124:125] op_sel:[0,1] op_sel_hi:[1,1]
    v_pk_mul_f32 v[120:121], v[120:121], v[124:125] op_sel:[0,1] op_sel_hi:[1,1]
    v_pk_mul_f32 v[122:123], v[122:123], v[124:125] op_sel:[0,1] op_sel_hi:[1,1]
    v_pk_mul_f32 v[128:129], v[128:129], v[140:141] op_sel:[0,1] op_sel_hi:[1,1]
    v_pk_mul_f32 v[130:131], v[130:131], v[140:141] op_sel:[0,1] op_sel_hi:[1,1]
    v_pk_mul_f32 v[132:133], v[132:133], v[140:141] op_sel:[0,1] op_sel_hi:[1,1]
    v_pk_mul_f32 v[134:135], v[134:135], v[140:141] op_sel:[0,1] op_sel_hi:[1,1]
    v_pk_mul_f32 v[136:137], v[136:137], v[140:141] op_sel:[0,1] op_sel_hi:[1,1]
    v_pk_mul_f32 v[138:139], v[138:139], v[140:141] op_sel:[0,1] op_sel_hi:[1,1]
    v_cvt_pk_bf16_f32 v54, v128, v129
    v_cvt_pk_bf16_f32 v58, v136, v137
    v_cvt_pk_bf16_f32 v55, v130, v131
    v_cvt_pk_bf16_f32 v59, v138, v139
    v_cvt_pk_bf16_f32 v48, v112, v113
    v_cvt_pk_bf16_f32 v49, v114, v115
    v_cvt_pk_bf16_f32 v50, v116, v117
    v_cvt_pk_bf16_f32 v51, v118, v119
    v_permlane32_swap_b32 v54, v58
    v_permlane32_swap_b32 v55, v59
    v_cmp_lt_u32 vcc, 31, v1
    v_cvt_pk_bf16_f32 v52, v120, v121
    v_cvt_pk_bf16_f32 v56, v132, v133
    v_cvt_pk_bf16_f32 v53, v122, v123
    v_cvt_pk_bf16_f32 v57, v134, v135
    v_cndmask_b32 v58, v58, v54, vcc
    v_cndmask_b32 v59, v59, v55, vcc
    buffer_store_dwordx4 v[48:51], v10, s[28:31], s44 offen sc1
    buffer_store_dwordx4 v[56:59], v10, s[28:31], s44 offen offset:768 sc1
    s_mov_b32 exec_hi, 0
    buffer_store_dwordx4 v[52:55], v10, s[28:31], s44 offen offset:512 sc1
    s_mov_b32 exec_hi, -1
    v_pk_mul_f32 v[16:17], v[112:113], 0 op_sel_hi:[1,0]
    v_pk_fma_f32 v[16:17], v[114:115], 0, v[16:17] op_sel_hi:[1,0,1]
    v_pk_fma_f32 v[16:17], v[116:117], 0, v[16:17] op_sel_hi:[1,0,1]
    v_pk_fma_f32 v[16:17], v[118:119], 0, v[16:17] op_sel_hi:[1,0,1]
    v_pk_fma_f32 v[16:17], v[120:121], 0, v[16:17] op_sel_hi:[1,0,1]
    v_pk_fma_f32 v[16:17], v[122:123], 0, v[16:17] op_sel_hi:[1,0,1]
    v_pk_fma_f32 v[16:17], v[128:129], 0, v[16:17] op_sel_hi:[1,0,1]
    v_pk_fma_f32 v[16:17], v[130:131], 0, v[16:17] op_sel_hi:[1,0,1]
    v_pk_fma_f32 v[16:17], v[132:133], 0, v[16:17] op_sel_hi:[1,0,1]
    v_pk_fma_f32 v[16:17], v[134:135], 0, v[16:17] op_sel_hi:[1,0,1]
    v_pk_fma_f32 v[16:17], v[136:137], 0, v[16:17] op_sel_hi:[1,0,1]
    v_pk_fma_f32 v[16:17], v[138:139], 0, v[16:17] op_sel_hi:[1,0,1]
    v_cmp_o_f32 vcc, v16, v17
    s_nop 0
    s_and_b64 vcc, vcc, s[12:13]
    s_cmp_eq_u64 vcc, -1
    s_cbranch_scc0 L_safe
L_norm2:
    v_cmp_eq_u32 vcc, 0, v2
    v_mov_b32 v104, 0x3f803f80
    v_lshlrev_b32 v120, 2, v1
    v_min_u32 v15, 1, v1
    v_lshlrev_b32 v15, 30, v15
    v_cndmask_b32 v100, 0, v104, vcc
    v_cndmask_b32 v101, 0, v104, vcc
    v_cndmask_b32 v102, 0, v104, vcc
    v_cndmask_b32 v103, 0, v104, vcc
    s_waitcnt vmcnt(63)
    s_nop 0
    v_mfma_f32_16x16x32_bf16 v[108:111], a[0:3], v[100:103], 0
    s_add_u32 s12, s54, 327680
    s_mov_b32 s18, 4096
    s_add_u32 s16, s58, s12
    s_addc_u32 s17, s59, 0
    v_mfma_f32_16x16x32_bf16 v[108:111], a[12:15], v[100:103], v[108:111]
    v_add_u32 v13, 51200, v4
    ds_read_b128 v[144:147], v4 offset:0
    v_mfma_f32_16x16x32_bf16 v[112:115], a[4:7], v[100:103], 0
    v_accvgpr_read_b32 v96, a240
    ds_read_b128 v[148:151], v4 offset:5120
    v_mfma_f32_16x16x32_bf16 v[112:115], a[16:19], v[100:103], v[112:115]
    v_lshlrev_b32 v124, 16, v96
    ds_read_b128 v[152:155], v4 offset:1024
    v_mfma_f32_16x16x32_bf16 v[116:119], a[8:11], v[100:103], 0
    s_barrier
    s_add_u32 m0, s42, 102400
    s_add_u32 s20, s52, 245760
    s_addc_u32 s21, s53, 0
    buffer_load_dwordx4 v4, s[20:23], 0 offen offset:0 sc1 lds
    v_mfma_f32_16x16x32_bf16 v[116:119], a[20:23], v[100:103], v[116:119]
    v_and_b32 v125, 0xffff0000, v96
    ds_read_b128 v[156:159], v4 offset:6144
    v_mfma_f32_16x16x32_bf16 v[108:111], a[24:27], v[100:103], v[108:111]
    v_accvgpr_read_b32 v97, a241
    ds_read_b128 v[160:163], v4 offset:2048
    v_mfma_f32_16x16x32_bf16 v[108:111], a[36:39], v[100:103], v[108:111]
    v_lshlrev_b32 v126, 16, v97
    ds_read_b128 v[164:167], v4 offset:7168
    v_mfma_f32_16x16x32_bf16 v[112:115], a[28:31], v[100:103], v[112:115]
    v_and_b32 v127, 0xffff0000, v97
    ds_read_b128 v[168:171], v4 offset:3072
    v_mfma_f32_16x16x32_bf16 v[112:115], a[40:43], v[100:103], v[112:115]
    buffer_load_dwordx4 v4, s[20:23], 0 offen offset:1024 sc1 lds
    v_mfma_f32_16x16x32_bf16 v[116:119], a[32:35], v[100:103], v[116:119]
    v_accvgpr_read_b32 v96, a242
    ds_read_b128 v[172:175], v4 offset:8192
    v_mfma_f32_16x16x32_bf16 v[116:119], a[44:47], v[100:103], v[116:119]
    v_lshlrev_b32 v128, 16, v96
    ds_read_b128 v[176:179], v4 offset:4096
    v_mfma_f32_16x16x32_bf16 v[108:111], a[48:51], v[100:103], v[108:111]
    v_and_b32 v129, 0xffff0000, v96
    ds_read_b128 v[180:183], v4 offset:9216
    v_mfma_f32_16x16x32_bf16 v[108:111], a[60:63], v[100:103], v[108:111]
    v_accvgpr_read_b32 v97, a243
    ds_read_b128 v[184:187], v4 offset:10240
    v_mfma_f32_16x16x32_bf16 v[112:115], a[52:55], v[100:103], v[112:115]
    buffer_load_dwordx4 v4, s[20:23], 0 offen offset:2048 sc1 lds
    v_mfma_f32_16x16x32_bf16 v[112:115], a[64:67], v[100:103], v[112:115]
    v_lshlrev_b32 v130, 16, v97
    ds_read_b128 v[188:191], v4 offset:15360
    v_mfma_f32_16x16x32_bf16 v[116:119], a[56:59], v[100:103], v[116:119]
    v_and_b32 v131, 0xffff0000, v97
    ds_read_b128 v[192:195], v4 offset:11264
    v_mfma_f32_16x16x32_bf16 v[116:119], a[68:71], v[100:103], v[116:119]
    v_accvgpr_read_b32 v96, a244
    ds_read_b128 v[196:199], v4 offset:16384
    v_mfma_f32_16x16x32_bf16 v[108:111], a[72:75], v[100:103], v[108:111]
    v_lshlrev_b32 v132, 16, v96
    ds_read_b128 v[200:203], v4 offset:12288
    v_mfma_f32_16x16x32_bf16 v[108:111], a[84:87], v[100:103], v[108:111]
    buffer_load_dwordx4 v4, s[20:23], 0 offen offset:3072 sc1 lds
    v_mfma_f32_16x16x32_bf16 v[112:115], a[76:79], v[100:103], v[112:115]
    v_and_b32 v133, 0xffff0000, v96
    ds_read_b128 v[204:207], v4 offset:17408
    v_mfma_f32_16x16x32_bf16 v[112:115], a[88:91], v[100:103], v[112:115]
    v_accvgpr_read_b32 v97, a245
    ds_read_b128 v[64:67], v4 offset:13312
    v_mfma_f32_16x16x32_bf16 v[116:119], a[80:83], v[100:103], v[116:119]
    v_lshlrev_b32 v134, 16, v97
    ds_read_b128 v[68:71], v4 offset:18432
    v_mfma_f32_16x16x32_bf16 v[116:119], a[92:95], v[100:103], v[116:119]
    v_and_b32 v135, 0xffff0000, v97
    ds_read_b128 v[72:75], v4 offset:14336
    v_mfma_f32_16x16x32_bf16 v[108:111], a[96:99], v[100:103], v[108:111]
    s_add_u32 m0, s42, 106496
    s_nop 0
    buffer_load_dwordx4 v9, s[20:23], 0 offen offset:0 sc1 lds
    v_mfma_f32_16x16x32_bf16 v[108:111], a[108:111], v[100:103], v[108:111]
    v_accvgpr_read_b32 v96, a246
    ds_read_b128 v[76:79], v4 offset:19456
    v_mfma_f32_16x16x32_bf16 v[112:115], a[100:103], v[100:103], v[112:115]
    v_lshlrev_b32 v136, 16, v96
    ds_read_b128 v[80:83], v4 offset:20480
    v_mfma_f32_16x16x32_bf16 v[112:115], a[112:115], v[100:103], v[112:115]
    v_and_b32 v137, 0xffff0000, v96
    ds_read_b128 v[84:87], v4 offset:25600
    v_mfma_f32_16x16x32_bf16 v[116:119], a[104:107], v[100:103], v[116:119]
    v_accvgpr_read_b32 v97, a247
    ds_read_b128 v[88:91], v4 offset:21504
    v_mfma_f32_16x16x32_bf16 v[116:119], a[116:119], v[100:103], v[116:119]
    s_add_u32 m0, s42, 107520
    s_add_u32 s20, s52, 286720
    s_addc_u32 s21, s53, 0
    buffer_load_dwordx4 v4, s[20:23], 0 offen offset:0 sc1 lds
    s_waitcnt vmcnt(6)
    s_cmp_eq_u32 s61, 0
    s_cbranch_scc1 L_st1_g
    buffer_store_dword v0, v15, s[28:31], s39 offen offset:512
L_st1_j:
    v_mfma_f32_16x16x32_bf16 v[108:111], a[120:123], v[100:103], v[108:111]
    v_lshlrev_b32 v138, 16, v97
    v_and_b32 v139, 0xffff0000, v97
    v_mfma_f32_16x16x32_bf16 v[108:111], a[132:135], v[100:103], v[108:111]
    v_accvgpr_read_b32 v96, a248
    v_lshlrev_b32 v140, 16, v96
    v_mfma_f32_16x16x32_bf16 v[112:115], a[124:127], v[100:103], v[112:115]
    v_and_b32 v141, 0xffff0000, v96
    v_accvgpr_read_b32 v97, a249
    v_mfma_f32_16x16x32_bf16 v[112:115], a[136:139], v[100:103], v[112:115]
    v_lshlrev_b32 v142, 16, v97
    v_and_b32 v143, 0xffff0000, v97
    v_mfma_f32_16x16x32_bf16 v[116:119], a[128:131], v[100:103], v[116:119]
    s_lshl_b32 s35, s33, 2
    v_lshrrev_b32 v96, 1, v3
    v_and_b32 v97, 1, v3
    v_mfma_f32_16x16x32_bf16 v[116:119], a[140:143], v[100:103], v[116:119]
    s_add_u32 s35, s35, s32
    v_lshlrev_b32 v6, 4, v2
    v_lshl_add_u32 v10, v96, 8, v6
    v_mfma_f32_16x16x32_bf16 v[108:111], a[144:147], v[100:103], v[108:111]
    s_lshl_b32 s56, s35, 10
    v_lshl_add_u32 v7, v97, 3, v10
    v_lshl_add_u32 v10, v97, 9, v10
    v_mfma_f32_16x16x32_bf16 v[108:111], a[156:159], v[100:103], v[108:111]
    s_lshl_b32 s12, s34, 7
    v_lshl_add_u32 v6, v97, 3, v6
    s_add_u32 s56, s56, s12
    v_mfma_f32_16x16x32_bf16 v[112:115], a[148:151], v[100:103], v[112:115]
    s_add_u32 s56, s56, 5570560
    s_and_b32 s35, s35, 7
    s_lshl_b32 s35, s35, 5
    v_mfma_f32_16x16x32_bf16 v[112:115], a[160:163], v[100:103], v[112:115]
    s_lshl2_add_u32 s11, s34, s35
    s_add_u32 s11, s11, s3
    v_mfma_f32_16x16x32_bf16 v[116:119], a[152:155], v[100:103], v[116:119]
    v_mfma_f32_16x16x32_bf16 v[116:119], a[164:167], v[100:103], v[116:119]
    buffer_load_dword v14, v11, s[28:31], s38 offen offset:512 sc1
    v_mfma_f32_16x16x32_bf16 v[108:111], a[168:171], v[100:103], v[108:111]
    v_mfma_f32_16x16x32_bf16 v[108:111], a[180:183], v[100:103], v[108:111]
    v_mfma_f32_16x16x32_bf16 v[112:115], a[172:175], v[100:103], v[112:115]
    v_mfma_f32_16x16x32_bf16 v[112:115], a[184:187], v[100:103], v[112:115]
    v_mfma_f32_16x16x32_bf16 v[116:119], a[176:179], v[100:103], v[116:119]
    v_mfma_f32_16x16x32_bf16 v[116:119], a[188:191], v[100:103], v[116:119]
    s_waitcnt vmcnt(0)
    v_cmp_eq_u32 vcc, 0, v14
    s_nop 0
    s_cmp_eq_u64 vcc, 0
    s_cbranch_scc1 L_o_ok
    s_mov_b32 s60, 200000
L_o_spin:
    buffer_load_dword v14, v11, s[28:31], s38 offen offset:512 sc1
    s_sub_u32 s60, s60, 1
    s_waitcnt vmcnt(0)
    v_cmp_eq_u32 vcc, 0, v14
    s_nop 0
    s_cmp_eq_u64 vcc, 0
    s_cbranch_scc1 L_o_ok
    s_cmp_lg_u32 s60, 0
    s_cbranch_scc1 L_o_spin
L_o_ok:
    buffer_load_dwordx4 v[16:19], v4, s[16:19], 0 offen offset:0 sc1
    buffer_load_dwordx4 v[20:23], v4, s[16:19], 0 offen offset:1024 sc1
    buffer_load_dwordx4 v[24:27], v4, s[16:19], 0 offen offset:2048 sc1
    buffer_load_dwordx4 v[28:31], v4, s[16:19], 0 offen offset:3072 sc1
    s_add_u32 s16, s16, 4096
    s_addc_u32 s17, s17, 0
    buffer_load_dwordx4 v[32:35], v4, s[16:19], 0 offen offset:0 sc1
    buffer_load_dwordx4 v[36:39], v4, s[16:19], 0 offen offset:1024 sc1
    buffer_load_dwordx4 v[40:43], v4, s[16:19], 0 offen offset:2048 sc1
    buffer_load_dwordx4 v[44:47], v4, s[16:19], 0 offen offset:3072 sc1
    s_add_u32 s16, s16, 4096
    s_addc_u32 s17, s17, 0
    buffer_load_dwordx4 v[48:51], v4, s[16:19], 0 offen offset:0 sc1
    v_mfma_f32_16x16x32_bf16 v[108:111], a[192:195], v[100:103], v[108:111]
    v_mfma_f32_16x16x32_bf16 v[108:111], a[204:207], v[100:103], v[108:111]
    v_mfma_f32_16x16x32_bf16 v[112:115], a[196:199], v[100:103], v[112:115]
    v_mfma_f32_16x16x32_bf16 v[112:115], a[208:211], v[100:103], v[112:115]
    v_mfma_f32_16x16x32_bf16 v[116:119], a[200:203], v[100:103], v[116:119]
    v_mfma_f32_16x16x32_bf16 v[116:119], a[212:215], v[100:103], v[116:119]
    v_mfma_f32_16x16x32_bf16 v[108:111], a[216:219], v[100:103], v[108:111]
    v_mfma_f32_16x16x32_bf16 v[108:111], a[228:231], v[100:103], v[108:111]
    v_mfma_f32_16x16x32_bf16 v[112:115], a[220:223], v[100:103], v[112:115]
    v_mfma_f32_16x16x32_bf16 v[112:115], a[232:235], v[100:103], v[112:115]
    v_mfma_f32_16x16x32_bf16 v[116:119], a[224:227], v[100:103], v[116:119]
    v_mfma_f32_16x16x32_bf16 v[116:119], a[236:239], v[100:103], v[116:119]
    s_waitcnt vmcnt(8) lgkmcnt(15)
    v_mfma_f32_16x16x32_bf16 v[124:127], v[144:147], v[16:19], v[124:127]
    s_waitcnt vmcnt(7) lgkmcnt(15)
    ds_read_b128 v[92:95], v4 offset:26624
    v_mfma_f32_16x16x32_bf16 v[124:127], v[148:151], v[20:23], v[124:127]
    s_waitcnt lgkmcnt(15)
    buffer_load_dwordx4 v[52:55], v4, s[16:19], 0 offen offset:1024 sc1
    v_mfma_f32_16x16x32_bf16 v[128:131], v[152:155], v[16:19], v[128:131]
    s_waitcnt lgkmcnt(15)
    ds_read_b128 v[144:147], v4 offset:22528
    v_mfma_f32_16x16x32_bf16 v[128:131], v[156:159], v[20:23], v[128:131]
    s_waitcnt lgkmcnt(15)
    ds_read_b128 v[148:151], v4 offset:27648
    v_mfma_f32_16x16x32_bf16 v[132:135], v[160:163], v[16:19], v[132:135]
    s_waitcnt lgkmcnt(15)
    ds_read_b128 v[152:155], v4 offset:23552
    v_mfma_f32_16x16x32_bf16 v[132:135], v[164:167], v[20:23], v[132:135]
    s_waitcnt lgkmcnt(15)
    ds_read_b128 v[156:159], v4 offset:28672
    v_mfma_f32_16x16x32_bf16 v[136:139], v[168:171], v[16:19], v[136:139]
    s_waitcnt lgkmcnt(15)
    ds_read_b128 v[160:163], v4 offset:24576
    v_mfma_f32_16x16x32_bf16 v[136:139], v[172:175], v[20:23], v[136:139]
    s_waitcnt lgkmcnt(15)
    buffer_load_dwordx4 v[56:59], v4, s[16:19], 0 offen offset:2048 sc1
    v_mfma_f32_16x16x32_bf16 v[140:143], v[176:179], v[16:19], v[140:143]
    s_waitcnt lgkmcnt(15)
    ds_read_b128 v[164:167], v4 offset:29696
    v_mfma_f32_16x16x32_bf16 v[140:143], v[180:183], v[20:23], v[140:143]
    s_waitcnt vmcnt(8) lgkmcnt(15)
    ds_read_b128 v[168:171], v4 offset:30720
    v_mfma_f32_16x16x32_bf16 v[124:127], v[184:187], v[24:27], v[124:127]
    s_waitcnt vmcnt(7) lgkmcnt(15)
    ds_read_b128 v[172:175], v4 offset:35840
    v_mfma_f32_16x16x32_bf16 v[124:127], v[188:191], v[28:31], v[124:127]
    s_waitcnt lgkmcnt(15)
    buffer_load_dwordx4 v[60:63], v4, s[16:19], 0 offen offset:3072 sc1
    v_mfma_f32_16x16x32_bf16 v[128:131], v[192:195], v[24:27], v[128:131]
    s_waitcnt lgkmcnt(15)
    ds_read_b128 v[176:179], v4 offset:31744
    v_mfma_f32_16x16x32_bf16 v[128:131], v[196:199], v[28:31], v[128:131]
    s_waitcnt lgkmcnt(15)
    ds_read_b128 v[180:183], v4 offset:36864
    v_mfma_f32_16x16x32_bf16 v[132:135], v[200:203], v[24:27], v[132:135]
    s_waitcnt lgkmcnt(15)
    ds_read_b128 v[184:187], v4 offset:32768
    v_mfma_f32_16x16x32_bf16 v[132:135], v[204:207], v[28:31], v[132:135]
    s_waitcnt lgkmcnt(15)
    ds_read_b128 v[188:191], v4 offset:37888
    v_mfma_f32_16x16x32_bf16 v[136:139], v[64:67], v[24:27], v[136:139]
    s_waitcnt lgkmcnt(15)
    ds_read_b128 v[192:195], v4 offset:33792
    v_mfma_f32_16x16x32_bf16 v[136:139], v[68:71], v[28:31], v[136:139]
    s_waitcnt lgkmcnt(15)
    s_add_u32 s16, s16, 4096
    s_addc_u32 s17, s17, 0
    buffer_load_dwordx4 v[16:19], v4, s[16:19], 0 offen offset:0 sc1
    v_mfma_f32_16x16x32_bf16 v[140:143], v[72:75], v[24:27], v[140:143]
    s_waitcnt lgkmcnt(15)
    ds_read_b128 v[196:199], v4 offset:38912
    v_mfma_f32_16x16x32_bf16 v[140:143], v[76:79], v[28:31], v[140:143]
    s_waitcnt vmcnt(8) lgkmcnt(15)
    ds_read_b128 v[200:203], v4 offset:34816
    v_mfma_f32_16x16x32_bf16 v[124:127], v[80:83], v[32:35], v[124:127]
    s_waitcnt vmcnt(7) lgkmcnt(15)
    ds_read_b128 v[204:207], v4 offset:39936
    v_mfma_f32_16x16x32_bf16 v[124:127], v[84:87], v[36:39], v[124:127]
    s_waitcnt lgkmcnt(15)
    buffer_load_dwordx4 v[20:23], v4, s[16:19], 0 offen offset:1024 sc1
    v_mfma_f32_16x16x32_bf16 v[128:131], v[88:91], v[32:35], v[128:131]
    s_waitcnt lgkmcnt(15)
    ds_read_b128 v[64:67], v4 offset:40960
    v_mfma_f32_16x16x32_bf16 v[128:131], v[92:95], v[36:39], v[128:131]
    s_waitcnt lgkmcnt(15)
    ds_read_b128 v[68:71], v4 offset:46080
    v_mfma_f32_16x16x32_bf16 v[132:135], v[144:147], v[32:35], v[132:135]
    s_waitcnt lgkmcnt(15)
    ds_read_b128 v[72:75], v4 offset:41984
    v_mfma_f32_16x16x32_bf16 v[132:135], v[148:151], v[36:39], v[132:135]
    s_waitcnt lgkmcnt(15)
    ds_read_b128 v[76:79], v4 offset:47104
    v_mfma_f32_16x16x32_bf16 v[136:139], v[152:155], v[32:35], v[136:139]
    s_waitcnt lgkmcnt(15)
    ds_read_b128 v[80:83], v4 offset:43008
    v_mfma_f32_16x16x32_bf16 v[136:139], v[156:159], v[36:39], v[136:139]
    s_waitcnt lgkmcnt(15)
    buffer_load_dwordx4 v[24:27], v4, s[16:19], 0 offen offset:2048 sc1
    v_mfma_f32_16x16x32_bf16 v[140:143], v[160:163], v[32:35], v[140:143]
    s_waitcnt lgkmcnt(15)
    ds_read_b128 v[84:87], v4 offset:48128
    v_mfma_f32_16x16x32_bf16 v[140:143], v[164:167], v[36:39], v[140:143]
    s_waitcnt vmcnt(8) lgkmcnt(15)
    ds_read_b128 v[88:91], v4 offset:44032
    v_mfma_f32_16x16x32_bf16 v[124:127], v[168:171], v[40:43], v[124:127]
    s_waitcnt vmcnt(7) lgkmcnt(15)
    ds_read_b128 v[92:95], v4 offset:49152
    v_mfma_f32_16x16x32_bf16 v[124:127], v[172:175], v[44:47], v[124:127]
    s_waitcnt lgkmcnt(15)
    buffer_load_dwordx4 v[28:31], v4, s[16:19], 0 offen offset:3072 sc1
    v_mfma_f32_16x16x32_bf16 v[128:131], v[176:179], v[40:43], v[128:131]
    s_waitcnt lgkmcnt(14)
    ds_read_b128 v[144:147], v4 offset:45056
    v_mfma_f32_16x16x32_bf16 v[128:131], v[180:183], v[44:47], v[128:131]
    s_waitcnt lgkmcnt(14)
    ds_read_b128 v[148:151], v4 offset:50176
    v_mfma_f32_16x16x32_bf16 v[132:135], v[184:187], v[40:43], v[132:135]
    s_waitcnt lgkmcnt(14)
    ds_read_b128 v[152:155], v13 offset:0
    v_mfma_f32_16x16x32_bf16 v[132:135], v[188:191], v[44:47], v[132:135]
    s_waitcnt lgkmcnt(14)
    ds_read_b128 v[156:159], v13 offset:5120
    v_mfma_f32_16x16x32_bf16 v[136:139], v[192:195], v[40:43], v[136:139]
    s_waitcnt lgkmcnt(14)
    ds_read_b128 v[160:163], v13 offset:1024
    v_mfma_f32_16x16x32_bf16 v[136:139], v[196:199], v[44:47], v[136:139]
    s_waitcnt lgkmcnt(14)
    s_add_u32 s16, s16, 4096
    s_addc_u32 s17, s17, 0
    buffer_load_dwordx4 v[32:35], v4, s[16:19], 0 offen offset:0 sc1
    v_mfma_f32_16x16x32_bf16 v[140:143], v[200:203], v[40:43], v[140:143]
    s_waitcnt lgkmcnt(13)
    ds_read_b128 v[164:167], v13 offset:6144
    v_mfma_f32_16x16x32_bf16 v[140:143], v[204:207], v[44:47], v[140:143]
    s_waitcnt vmcnt(8) lgkmcnt(13)
    ds_read_b128 v[168:171], v13 offset:2048
    v_mfma_f32_16x16x32_bf16 v[124:127], v[64:67], v[48:51], v[124:127]
    s_waitcnt vmcnt(7) lgkmcnt(13)
    ds_read_b128 v[172:175], v13 offset:7168
    v_mfma_f32_16x16x32_bf16 v[124:127], v[68:71], v[52:55], v[124:127]
    s_waitcnt lgkmcnt(13)
    buffer_load_dwordx4 v[36:39], v4, s[16:19], 0 offen offset:1024 sc1
    v_mfma_f32_16x16x32_bf16 v[128:131], v[72:75], v[48:51], v[128:131]
    s_waitcnt lgkmcnt(12)
    ds_read_b128 v[176:179], v13 offset:3072
    v_mfma_f32_16x16x32_bf16 v[128:131], v[76:79], v[52:55], v[128:131]
    s_waitcnt lgkmcnt(12)
    ds_read_b128 v[180:183], v13 offset:8192
    v_mfma_f32_16x16x32_bf16 v[132:135], v[80:83], v[48:51], v[132:135]
    s_waitcnt lgkmcnt(12)
    ds_read_b128 v[184:187], v13 offset:4096
    v_mfma_f32_16x16x32_bf16 v[132:135], v[84:87], v[52:55], v[132:135]
    s_waitcnt lgkmcnt(12)
    ds_read_b128 v[188:191], v13 offset:9216
    v_mfma_f32_16x16x32_bf16 v[136:139], v[88:91], v[48:51], v[136:139]
    s_waitcnt lgkmcnt(12)
    ds_read_b128 v[192:195], v13 offset:10240
    v_mfma_f32_16x16x32_bf16 v[136:139], v[92:95], v[52:55], v[136:139]
    s_waitcnt lgkmcnt(12)
    buffer_load_dwordx4 v[40:43], v4, s[16:19], 0 offen offset:2048 sc1
    v_mfma_f32_16x16x32_bf16 v[140:143], v[144:147], v[48:51], v[140:143]
    s_waitcnt lgkmcnt(11)
    ds_read_b128 v[196:199], v13 offset:15360
    v_mfma_f32_16x16x32_bf16 v[140:143], v[148:151], v[52:55], v[140:143]
    s_waitcnt vmcnt(8) lgkmcnt(11)
    ds_read_b128 v[200:203], v13 offset:11264
    v_mfma_f32_16x16x32_bf16 v[124:127], v[152:155], v[56:59], v[124:127]
    s_waitcnt vmcnt(7) lgkmcnt(11)
    ds_read_b128 v[204:207], v13 offset:16384
    v_mfma_f32_16x16x32_bf16 v[124:127], v[156:159], v[60:63], v[124:127]
    s_waitcnt lgkmcnt(11)
    buffer_load_dwordx4 v[44:47], v4, s[16:19], 0 offen offset:3072 sc1
    v_mfma_f32_16x16x32_bf16 v[128:131], v[160:163], v[56:59], v[128:131]
    s_waitcnt lgkmcnt(10)
    ds_read_b128 v[64:67], v13 offset:12288
    v_mfma_f32_16x16x32_bf16 v[128:131], v[164:167], v[60:63], v[128:131]
    s_waitcnt lgkmcnt(10)
    ds_read_b128 v[68:71], v13 offset:17408
    v_mfma_f32_16x16x32_bf16 v[132:135], v[168:171], v[56:59], v[132:135]
    s_waitcnt lgkmcnt(10)
    ds_read_b128 v[72:75], v13 offset:13312
    v_mfma_f32_16x16x32_bf16 v[132:135], v[172:175], v[60:63], v[132:135]
    s_waitcnt lgkmcnt(10)
    ds_read_b128 v[76:79], v13 offset:18432
    v_mfma_f32_16x16x32_bf16 v[136:139], v[176:179], v[56:59], v[136:139]
    s_waitcnt lgkmcnt(10)
    ds_read_b128 v[80:83], v13 offset:14336
    v_mfma_f32_16x16x32_bf16 v[136:139], v[180:183], v[60:63], v[136:139]
    s_waitcnt lgkmcnt(10)
    ds_read_b128 v[84:87], v13 offset:19456
    v_mfma_f32_16x16x32_bf16 v[140:143], v[184:187], v[56:59], v[140:143]
    s_waitcnt lgkmcnt(10)
    ds_read_b128 v[88:91], v13 offset:20480
    v_mfma_f32_16x16x32_bf16 v[140:143], v[188:191], v[60:63], v[140:143]
    s_waitcnt vmcnt(7) lgkmcnt(10)
    ds_read_b128 v[92:95], v13 offset:25600
    v_mfma_f32_16x16x32_bf16 v[124:127], v[192:195], v[16:19], v[124:127]
    s_waitcnt vmcnt(6) lgkmcnt(10)
    ds_read_b128 v[144:147], v13 offset:21504
    v_mfma_f32_16x16x32_bf16 v[124:127], v[196:199], v[20:23], v[124:127]
    s_waitcnt lgkmcnt(10)
    ds_read_b128 v[148:151], v13 offset:26624
    v_mfma_f32_16x16x32_bf16 v[128:131], v[200:203], v[16:19], v[128:131]
    s_waitcnt lgkmcnt(10)
    ds_read_b128 v[152:155], v13 offset:22528
    v_mfma_f32_16x16x32_bf16 v[128:131], v[204:207], v[20:23], v[128:131]
    s_waitcnt lgkmcnt(10)
    ds_read_b128 v[156:159], v13 offset:27648
    v_mfma_f32_16x16x32_bf16 v[132:135], v[64:67], v[16:19], v[132:135]
    s_waitcnt lgkmcnt(10)
    ds_read_b128 v[160:163], v13 offset:23552
    v_mfma_f32_16x16x32_bf16 v[132:135], v[68:71], v[20:23], v[132:135]
    s_waitcnt lgkmcnt(10)
    ds_read_b128 v[164:167], v13 offset:28672
    v_mfma_f32_16x16x32_bf16 v[136:139], v[72:75], v[16:19], v[136:139]
    s_waitcnt lgkmcnt(10)
    ds_read_b128 v[168:171], v13 offset:24576
    v_mfma_f32_16x16x32_bf16 v[136:139], v[76:79], v[20:23], v[136:139]
    s_waitcnt lgkmcnt(10)
    ds_read_b128 v[172:175], v13 offset:29696
    v_mfma_f32_16x16x32_bf16 v[140:143], v[80:83], v[16:19], v[140:143]
    s_waitcnt lgkmcnt(10)
    ds_read_b128 v[176:179], v13 offset:30720
    v_mfma_f32_16x16x32_bf16 v[140:143], v[84:87], v[20:23], v[140:143]
    s_waitcnt vmcnt(5) lgkmcnt(10)
    ds_read_b128 v[180:183], v13 offset:35840
    v_mfma_f32_16x16x32_bf16 v[124:127], v[88:91], v[24:27], v[124:127]
    s_waitcnt vmcnt(4) lgkmcnt(10)
    ds_read_b128 v[184:187], v13 offset:31744
    v_mfma_f32_16x16x32_bf16 v[124:127], v[92:95], v[28:31], v[124:127]
    s_waitcnt lgkmcnt(10)
    ds_read_b128 v[188:191], v13 offset:36864
    v_mfma_f32_16x16x32_bf16 v[128:131], v[144:147], v[24:27], v[128:131]
    s_waitcnt lgkmcnt(10)
    ds_read_b128 v[192:195], v13 offset:32768
    v_mfma_f32_16x16x32_bf16 v[128:131], v[148:151], v[28:31], v[128:131]
    s_waitcnt lgkmcnt(10)
    ds_read_b128 v[196:199], v13 offset:37888
    v_mfma_f32_16x16x32_bf16 v[132:135], v[152:155], v[24:27], v[132:135]
    s_waitcnt lgkmcnt(10)
    ds_read_b128 v[200:203], v13 offset:33792
    v_mfma_f32_16x16x32_bf16 v[132:135], v[156:159], v[28:31], v[132:135]
    s_waitcnt lgkmcnt(10)
    ds_read_b128 v[204:207], v13 offset:38912
    v_mfma_f32_16x16x32_bf16 v[136:139], v[160:163], v[24:27], v[136:139]
    s_waitcnt lgkmcnt(10)
    ds_read_b128 v[64:67], v13 offset:34816
    v_mfma_f32_16x16x32_bf16 v[136:139], v[164:167], v[28:31], v[136:139]
    s_waitcnt lgkmcnt(10)
    ds_read_b128 v[68:71], v13 offset:39936
    v_mfma_f32_16x16x32_bf16 v[140:143], v[168:171], v[24:27], v[140:143]
    s_waitcnt lgkmcnt(10)
    ds_read_b128 v[72:75], v13 offset:40960
    v_mfma_f32_16x16x32_bf16 v[140:143], v[172:175], v[28:31], v[140:143]
    s_waitcnt vmcnt(3) lgkmcnt(10)
    ds_read_b128 v[76:79], v13 offset:46080
    v_mfma_f32_16x16x32_bf16 v[124:127], v[176:179], v[32:35], v[124:127]
    s_waitcnt vmcnt(2) lgkmcnt(10)
    ds_read_b128 v[80:83], v13 offset:41984
    v_mfma_f32_16x16x32_bf16 v[124:127], v[180:183], v[36:39], v[124:127]
    s_waitcnt lgkmcnt(10)
    ds_read_b128 v[84:87], v13 offset:47104
L_warm1_0_1:
    s_cbranch_execz L_warm1_ret
    v_mfma_f32_16x16x32_bf16 v[128:131], v[184:187], v[32:35], v[128:131]
    s_waitcnt lgkmcnt(10)
    ds_read_b128 v[88:91], v13 offset:43008
    v_mfma_f32_16x16x32_bf16 v[128:131], v[188:191], v[36:39], v[128:131]
    s_waitcnt lgkmcnt(10)
    ds_read_b128 v[92:95], v13 offset:48128
    v_mfma_f32_16x16x32_bf16 v[132:135], v[192:195], v[32:35], v[132:135]
    s_waitcnt lgkmcnt(10)
    ds_read_b128 v[144:147], v13 offset:44032
    v_mfma_f32_16x16x32_bf16 v[132:135], v[196:199], v[36:39], v[132:135]
    s_waitcnt lgkmcnt(10)
    ds_read_b128 v[148:151], v13 offset:49152
    v_mfma_f32_16x16x32_bf16 v[136:139], v[200:203], v[32:35], v[136:139]
    s_waitcnt lgkmcnt(10)
    ds_read_b128 v[152:155], v13 offset:45056
    v_mfma_f32_16x16x32_bf16 v[136:139], v[204:207], v[36:39], v[136:139]
    s_waitcnt lgkmcnt(10)
    ds_read_b128 v[156:159], v13 offset:50176
    v_mfma_f32_16x16x32_bf16 v[140:143], v[64:67], v[32:35], v[140:143]
    s_waitcnt lgkmcnt(10)
    v_mfma_f32_16x16x32_bf16 v[140:143], v[68:71], v[36:39], v[140:143]
    s_waitcnt vmcnt(1) lgkmcnt(9)
    v_mfma_f32_16x16x32_bf16 v[124:127], v[72:75], v[40:43], v[124:127]
    s_waitcnt vmcnt(0) lgkmcnt(8)
    v_mfma_f32_16x16x32_bf16 v[124:127], v[76:79], v[44:47], v[124:127]
    s_waitcnt lgkmcnt(7)
    v_mfma_f32_16x16x32_bf16 v[128:131], v[80:83], v[40:43], v[128:131]
    s_waitcnt lgkmcnt(6)
    v_mfma_f32_16x16x32_bf16 v[128:131], v[84:87], v[44:47], v[128:131]
    s_waitcnt lgkmcnt(5)
    v_mfma_f32_16x16x32_bf16 v[132:135], v[88:91], v[40:43], v[132:135]
    s_waitcnt lgkmcnt(4)
    v_mfma_f32_16x16x32_bf16 v[132:135], v[92:95], v[44:47], v[132:135]
    s_waitcnt lgkmcnt(3)
    v_mfma_f32_16x16x32_bf16 v[136:139], v[144:147], v[40:43], v[136:139]
    s_waitcnt lgkmcnt(2)
    v_mfma_f32_16x16x32_bf16 v[136:139], v[148:151], v[44:47], v[136:139]
    s_waitcnt lgkmcnt(1)
    v_mfma_f32_16x16x32_bf16 v[140:143], v[152:155], v[40:43], v[140:143]
    s_waitcnt lgkmcnt(0)
    v_mfma_f32_16x16x32_bf16 v[140:143], v[156:159], v[44:47], v[140:143]
    v_mov_b32 v28, 0
    v_mov_b32 v29, 0
    v_cvt_pk_bf16_f32 v16, v124, v125
    v_cvt_pk_bf16_f32 v17, v126, v127
    v_cvt_pk_bf16_f32 v18, v128, v129
    v_cvt_pk_bf16_f32 v19, v130, v131
    v_cvt_pk_bf16_f32 v20, v132, v133
    v_cvt_pk_bf16_f32 v21, v134, v135
    v_cvt_pk_bf16_f32 v22, v136, v137
    v_cvt_pk_bf16_f32 v23, v138, v139
    v_cvt_pk_bf16_f32 v24, v140, v141
    v_cvt_pk_bf16_f32 v25, v142, v143
    v_permlane16_swap_b32 v16, v18
    v_permlane16_swap_b32 v17, v19
    v_permlane16_swap_b32 v20, v22
    v_permlane16_swap_b32 v21, v23
    buffer_store_dwordx4 v[16:19], v10, s[28:31], s45 offen sc1
    buffer_store_dwordx4 v[20:23], v10, s[28:31], s45 offen offset:1024 sc1
    buffer_store_dwordx2 v[24:25], v7, s[28:31], s45 offen offset:2048 sc1
    v_dot2c_f32_bf16 v28, v16, v104
    v_dot2c_f32_bf16 v29, v16, v16
    v_dot2c_f32_bf16 v28, v17, v104
    v_dot2c_f32_bf16 v29, v17, v17
    v_dot2c_f32_bf16 v28, v18, v104
    v_dot2c_f32_bf16 v29, v18, v18
    v_dot2c_f32_bf16 v28, v19, v104
    v_dot2c_f32_bf16 v29, v19, v19
    v_dot2c_f32_bf16 v28, v20, v104
    v_dot2c_f32_bf16 v29, v20, v20
    v_dot2c_f32_bf16 v28, v21, v104
    v_dot2c_f32_bf16 v29, v21, v21
    v_dot2c_f32_bf16 v28, v22, v104
    v_dot2c_f32_bf16 v29, v22, v22
    v_dot2c_f32_bf16 v28, v23, v104
    v_dot2c_f32_bf16 v29, v23, v23
    v_dot2c_f32_bf16 v28, v24, v104
    v_dot2c_f32_bf16 v29, v24, v24
    v_dot2c_f32_bf16 v28, v25, v104
    v_dot2c_f32_bf16 v29, v25, v25
    s_nop 1
    v_mov_b32 v30, v28
    v_mov_b32 v31, v29
    s_nop 0
    v_permlane16_swap_b32 v28, v30
    v_permlane16_swap_b32 v29, v31
    v_add_f32 v28, v28, v30
    v_add_f32 v29, v29, v31
    v_mov_b32 v30, v28
    v_mov_b32 v31, v29
    s_nop 0
    v_permlane32_swap_b32 v28, v30
    v_permlane32_swap_b32 v29, v31
    v_add_f32 v28, v28, v30
    v_add_f32 v29, v29, v31
    s_mov_b64 exec, 0xffff
    buffer_store_dwordx2 v[28:29], v5, s[28:31], s56 offen sc1
    s_mov_b64 exec, -1
    s_waitcnt vmcnt(0)
    s_cmp_eq_u32 s61, 0
    s_cbranch_scc1 L_st2_g
    buffer_store_dword v0, v15, s[28:31], s11 offen offset:256
L_st2_j:
    s_add_u32 s20, s52, 163840
    s_addc_u32 s21, s53, 0
    buffer_load_dwordx4 v[172:175], v4, s[20:23], 0 offen offset:2048 sc1
    buffer_load_dwordx4 v[176:179], v4, s[20:23], 0 offen offset:3072 sc1
    buffer_load_dwordx4 v[180:183], v9, s[20:23], 0 offen offset:0 sc1
    s_add_u32 s20, s52, 204800
    s_addc_u32 s21, s53, 0
    buffer_load_dwordx4 v[184:187], v4, s[20:23], 0 offen offset:0 sc1
    buffer_load_dwordx4 v[188:191], v4, s[20:23], 0 offen offset:1024 sc1
    buffer_load_dwordx4 v[192:195], v4, s[20:23], 0 offen offset:2048 sc1
    buffer_load_dwordx4 v[196:199], v4, s[20:23], 0 offen offset:3072 sc1
    buffer_load_dwordx4 v[200:203], v9, s[20:23], 0 offen offset:0 sc1
    s_mul_i32 s12, s14, 163840
    s_add_u32 s12, s12, s41
    s_add_u32 s12, s12, 2949120
    s_add_u32 s48, s58, s12
    s_addc_u32 s49, s59, 0
    s_mov_b32 s18, 5120
    s_lshl_b32 s35, s32, 10
    v_add_u32 v13, s35, v4
    v_lshlrev_b32 v131, 4, v2
    s_lshl_b32 s12, s14, 13
    s_add_u32 s12, s12, s35
    s_add_u32 s12, s12, 5570560
    s_add_u32 s24, s58, s12
    s_addc_u32 s25, s59, 0
    s_mov_b32 s26, 5120
    v_lshlrev_b32 v12, 3, v2
    v_and_b32 v8, 1, v3
    v_lshl_add_u32 v12, v8, 9, v12
    v_lshrrev_b32 v8, 1, v3
    v_lshl_add_u32 v12, v8, 12, v12
    v_mul_u32_u24 v8, 196608, v8
    v_add_u32 v8, v8, v6
    s_add_u32 s8, s3, 1024
    s_lshr_b32 s35, s15, 2
    s_lshl_b32 s35, s35, 7
    s_add_u32 s39, s8, s35
    s_and_b32 s35, s15, 3
    s_lshl_b32 s35, s35, 4
    s_add_u32 s39, s39, s35
    s_lshl_b32 s35, s32, 2
    s_add_u32 s39, s39, s35
    s_lshl_b32 s35, s32, 7
    s_add_u32 s8, s8, s35
    s_mul_i32 s12, s33, 196608
    s_mul_i32 s35, s32, 12288
    s_add_u32 s12, s12, s35
    s_add_u32 s12, s12, 5701632
    s_add_u32 s56, s58, s12
    s_addc_u32 s57, s59, 0
    s_mul_i32 s35, s32, 5376
    v_mul_u32_u24 v121, 336, v2
    v_lshl_add_u32 v121, v3, 4, v121
    v_add_u32 v121, s35, v121
    v_mul_u32_u24 v5, 6554, v1
    v_lshrrev_b32 v5, 16, v5
    v_mul_u32_u24 v6, 10, v5
    v_sub_u32 v6, v1, v6
    v_min_u32 v5, 3, v5
    s_lshl_b32 s35, s32, 2
    v_add_u32 v5, s35, v5
    v_mul_u32_u24 v122, 336, v5
    v_lshl_add_u32 v122, v6, 5, v122
    v_lshlrev_b32 v130, 4, v5
    v_lshl_add_u32 v130, v6, 8, v130
    v_mul_u32_u24 v123, 1280, v5
    v_lshl_add_u32 v123, v6, 4, v123
    v_mov_b32 v5, 0x7ff00000
    v_cmp_gt_u32 vcc, 40, v1
    s_mul_i32 s40, s33, 81920
    s_mul_i32 s35, s34, 2560
    s_add_u32 s45, s40, s35
    s_add_u32 s45, s45, 2949120
    v_cndmask_b32 v123, v5, v123, vcc
    s_mul_i32 s35, s34, 160
    s_add_u32 s40, s40, s35
    s_mov_b32 s4, s50
    s_and_b32 s5, s51, 0xffff
    s_mov_b32 s6, 2621440
    s_mov_b32 s7, 0x20000
    v_mov_b32_dpp v108, v108 row_newbcast:0 row_mask:0xf bank_mask:0xf
    v_mov_b32_dpp v109, v109 row_newbcast:0 row_mask:0xf bank_mask:0xf
    v_mov_b32_dpp v110, v110 row_newbcast:0 row_mask:0xf bank_mask:0xf
    v_mov_b32_dpp v111, v111 row_newbcast:0 row_mask:0xf bank_mask:0xf
    v_mov_b32_dpp v112, v112 row_newbcast:0 row_mask:0xf bank_mask:0xf
    v_mov_b32_dpp v113, v113 row_newbcast:0 row_mask:0xf bank_mask:0xf
    v_mov_b32_dpp v114, v114 row_newbcast:0 row_mask:0xf bank_mask:0xf
    v_mov_b32_dpp v115, v115 row_newbcast:0 row_mask:0xf bank_mask:0xf
    v_mov_b32_dpp v116, v116 row_newbcast:0 row_mask:0xf bank_mask:0xf
    v_mov_b32_dpp v117, v117 row_newbcast:0 row_mask:0xf bank_mask:0xf
    v_mov_b32_dpp v118, v118 row_newbcast:0 row_mask:0xf bank_mask:0xf
    v_mov_b32_dpp v119, v119 row_newbcast:0 row_mask:0xf bank_mask:0xf
    s_mov_b64 exec, 0
    s_cmp_eq_u32 s32, 0
    s_cbranch_scc1 L_warm2_0
    s_cmp_eq_u32 s32, 1
    s_cbranch_scc1 L_warm2_1
    s_cmp_eq_u32 s32, 2
    s_cbranch_scc1 L_warm2_2
    s_branch L_warm2_3
L_warm2_ret:
    s_mov_b64 exec, -1
    s_add_u32 m0, s41, 0
    s_add_u32 s16, s48, 0
    s_addc_u32 s17, s49, 0
    s_mov_b32 s60, 200000
L_h_spin:
    buffer_load_dword v14, v120, s[28:31], s3 offen offset:256 sc1
    s_sub_u32 s60, s60, 1
    s_waitcnt vmcnt(0)
    v_cmp_eq_u32 vcc, 0, v14
    s_nop 0
    s_cmp_eq_u64 vcc, 0
    s_cbranch_scc1 L_h_ok
    s_cmp_lg_u32 s60, 0
    s_cbranch_scc1 L_h_spin
L_h_ok:
    buffer_load_dwordx4 v4, s[16:19], 0 offen offset:0 sc1 lds
    buffer_load_dwordx4 v4, s[16:19], 0 offen offset:1024 sc1 lds
    buffer_load_dwordx4 v4, s[16:19], 0 offen offset:2048 sc1 lds
    buffer_load_dwordx4 v4, s[16:19], 0 offen offset:3072 sc1 lds
    s_add_u32 m0, m0, 4096
    s_nop 0
    buffer_load_dwordx4 v9, s[16:19], 0 offen sc1 lds
    buffer_load_dwordx2 v[64:65], v12, s[24:27], 0 offen offset:0 sc1
    buffer_load_dwordx2 v[66:67], v12, s[24:27], 0 offen offset:128 sc1
    buffer_load_dwordx2 v[68:69], v12, s[24:27], 0 offen offset:256 sc1
    buffer_load_dwordx2 v[70:71], v12, s[24:27], 0 offen offset:384 sc1
    s_waitcnt vmcnt(4)
    s_barrier
    ds_read_b128 v[16:19], v4 offset:0
    ds_read_b128 v[20:23], v4 offset:1024
    ds_read_b128 v[24:27], v4 offset:2048
    ds_read_b128 v[28:31], v4 offset:3072
    s_waitcnt lgkmcnt(2)
    v_mfma_f32_16x16x32_bf16 v[40:43], a[0:3], v[16:19], 0
    ds_read_b128 v[32:35], v4 offset:4096
    v_mfma_f32_16x16x32_bf16 v[40:43], a[12:15], v[20:23], v[40:43]
    s_add_u32 m0, s41, 20480
    s_add_u32 s16, s48, 81920
    s_addc_u32 s17, s49, 0
    buffer_load_dwordx4 v4, s[16:19], 0 offen offset:0 sc1 lds
    v_mfma_f32_16x16x32_bf16 v[44:47], a[4:7], v[16:19], 0
    ds_read_b128 v[36:39], v4 offset:5120
    v_mfma_f32_16x16x32_bf16 v[44:47], a[16:19], v[20:23], v[44:47]
    buffer_load_dwordx4 v4, s[16:19], 0 offen offset:1024 sc1 lds
    v_mfma_f32_16x16x32_bf16 v[48:51], a[8:11], v[16:19], 0
    v_mfma_f32_16x16x32_bf16 v[48:51], a[20:23], v[20:23], v[48:51]
    s_waitcnt lgkmcnt(2)
    v_mfma_f32_16x16x32_bf16 v[40:43], a[24:27], v[24:27], v[40:43]
    ds_read_b128 v[16:19], v4 offset:6144
    v_mfma_f32_16x16x32_bf16 v[40:43], a[36:39], v[28:31], v[40:43]
    buffer_load_dwordx4 v4, s[16:19], 0 offen offset:2048 sc1 lds
    v_mfma_f32_16x16x32_bf16 v[44:47], a[28:31], v[24:27], v[44:47]
    ds_read_b128 v[20:23], v4 offset:7168
    v_mfma_f32_16x16x32_bf16 v[44:47], a[40:43], v[28:31], v[44:47]
    s_waitcnt vmcnt(3)
    v_add_f32 v64, v64, v66
    v_add_f32 v65, v65, v67
    v_mfma_f32_16x16x32_bf16 v[48:51], a[32:35], v[24:27], v[48:51]
    v_add_f32 v68, v68, v70
    v_add_f32 v69, v69, v71
    v_mfma_f32_16x16x32_bf16 v[48:51], a[44:47], v[28:31], v[48:51]
    s_waitcnt lgkmcnt(2)
    buffer_load_dwordx4 v4, s[16:19], 0 offen offset:3072 sc1 lds
    v_mfma_f32_16x16x32_bf16 v[40:43], a[48:51], v[32:35], v[40:43]
    ds_read_b128 v[24:27], v4 offset:8192
    v_add_f32 v64, v64, v68
    v_mfma_f32_16x16x32_bf16 v[40:43], a[60:63], v[36:39], v[40:43]
    v_add_f32 v65, v65, v69
    v_mov_b32 v66, v64
    v_mfma_f32_16x16x32_bf16 v[44:47], a[52:55], v[32:35], v[44:47]
    ds_read_b128 v[28:31], v4 offset:9216
    v_mov_b32 v67, v65
    v_mfma_f32_16x16x32_bf16 v[44:47], a[64:67], v[36:39], v[44:47]
    s_add_u32 m0, m0, 4096
    s_nop 0
    buffer_load_dwordx4 v9, s[16:19], 0 offen sc1 lds
    v_mfma_f32_16x16x32_bf16 v[48:51], a[56:59], v[32:35], v[48:51]
    s_nop 0
    v_permlane16_swap_b32 v64, v66
    v_permlane16_swap_b32 v65, v67
    v_mfma_f32_16x16x32_bf16 v[48:51], a[68:71], v[36:39], v[48:51]
    s_waitcnt lgkmcnt(2)
    v_add_f32 v64, v64, v66
    v_add_f32 v65, v65, v67
    v_mfma_f32_16x16x32_bf16 v[40:43], a[72:75], v[16:19], v[40:43]
    ds_read_b128 v[32:35], v4 offset:10240
    v_mul_f32 v64, 0x3acccccd, v64
    v_mfma_f32_16x16x32_bf16 v[40:43], a[84:87], v[20:23], v[40:43]
    s_add_u32 m0, s41, 40960
    s_add_u32 s16, s48, 20480
    s_addc_u32 s17, s49, 0
    buffer_load_dwordx4 v4, s[16:19], 0 offen offset:0 sc1 lds
    v_mfma_f32_16x16x32_bf16 v[44:47], a[76:79], v[16:19], v[44:47]
    ds_read_b128 v[36:39], v4 offset:11264
    v_mul_f32 v65, 0x3acccccd, v65
    v_mfma_f32_16x16x32_bf16 v[44:47], a[88:91], v[20:23], v[44:47]
    v_fma_f32 v65, -v64, v64, v65
    v_max_f32 v65, 0, v65
    v_mfma_f32_16x16x32_bf16 v[48:51], a[80:83], v[16:19], v[48:51]
    v_add_f32 v65, 0x3727c5ac, v65
    v_mfma_f32_16x16x32_bf16 v[48:51], a[92:95], v[20:23], v[48:51]
    s_waitcnt lgkmcnt(2)
    buffer_load_dwordx4 v4, s[16:19], 0 offen offset:1024 sc1 lds
    v_mfma_f32_16x16x32_bf16 v[40:43], a[96:99], v[24:27], v[40:43]
    ds_read_b128 v[16:19], v4 offset:12288
    v_mfma_f32_16x16x32_bf16 v[40:43], a[108:111], v[28:31], v[40:43]
    v_rsq_f32 v66, v65
    v_mfma_f32_16x16x32_bf16 v[44:47], a[100:103], v[24:27], v[44:47]
    ds_read_b128 v[20:23], v4 offset:13312
    v_mul_f32 v66, 0xbfb8aa3b, v66
    v_mfma_f32_16x16x32_bf16 v[44:47], a[112:115], v[28:31], v[44:47]
    buffer_load_dwordx4 v4, s[16:19], 0 offen offset:2048 sc1 lds
    v_mfma_f32_16x16x32_bf16 v[48:51], a[104:107], v[24:27], v[48:51]
    ds_write_b128 v13, v[64:67] offset:61440
    v_mfma_f32_16x16x32_bf16 v[48:51], a[116:119], v[28:31], v[48:51]
    s_waitcnt lgkmcnt(3)
    v_mfma_f32_16x16x32_bf16 v[40:43], a[120:123], v[32:35], v[40:43]
    ds_read_b128 v[24:27], v4 offset:14336
    v_mfma_f32_16x16x32_bf16 v[40:43], a[132:135], v[36:39], v[40:43]
    buffer_load_dwordx4 v4, s[16:19], 0 offen offset:3072 sc1 lds
    v_mfma_f32_16x16x32_bf16 v[44:47], a[124:127], v[32:35], v[44:47]
    ds_read_b128 v[28:31], v4 offset:15360
    v_mfma_f32_16x16x32_bf16 v[44:47], a[136:139], v[36:39], v[44:47]
    v_mfma_f32_16x16x32_bf16 v[48:51], a[128:131], v[32:35], v[48:51]
    v_mfma_f32_16x16x32_bf16 v[48:51], a[140:143], v[36:39], v[48:51]
    s_waitcnt lgkmcnt(3)
    v_mfma_f32_16x16x32_bf16 v[40:43], a[144:147], v[16:19], v[40:43]
    ds_read_b128 v[32:35], v4 offset:16384
    v_mfma_f32_16x16x32_bf16 v[40:43], a[156:159], v[20:23], v[40:43]
    s_add_u32 m0, m0, 4096
    s_nop 0
    buffer_load_dwordx4 v9, s[16:19], 0 offen sc1 lds
    v_mfma_f32_16x16x32_bf16 v[44:47], a[148:151], v[16:19], v[44:47]
    ds_read_b128 v[36:39], v4 offset:17408
    v_mfma_f32_16x16x32_bf16 v[44:47], a[160:163], v[20:23], v[44:47]
    s_add_u32 m0, s43, 65536
    s_add_u32 s20, s52, 368640
    s_addc_u32 s21, s53, 0
    buffer_load_dwordx4 v4, s[20:23], 0 offen offset:0 sc1 lds
    v_mfma_f32_16x16x32_bf16 v[48:51], a[152:155], v[16:19], v[48:51]
    v_mfma_f32_16x16x32_bf16 v[48:51], a[164:167], v[20:23], v[48:51]
    s_waitcnt lgkmcnt(2)
    v_mfma_f32_16x16x32_bf16 v[40:43], a[168:171], v[24:27], v[40:43]
    ds_read_b128 v[16:19], v4 offset:18432
    v_mfma_f32_16x16x32_bf16 v[40:43], a[180:183], v[28:31], v[40:43]
    buffer_load_dwordx4 v4, s[20:23], 0 offen offset:1024 sc1 lds
    v_mfma_f32_16x16x32_bf16 v[44:47], a[172:175], v[24:27], v[44:47]
    ds_read_b128 v[20:23], v4 offset:19456
    v_mfma_f32_16x16x32_bf16 v[44:47], a[184:187], v[28:31], v[44:47]
    v_mfma_f32_16x16x32_bf16 v[48:51], a[176:179], v[24:27], v[48:51]
    v_mfma_f32_16x16x32_bf16 v[48:51], a[188:191], v[28:31], v[48:51]
    s_waitcnt lgkmcnt(2)
    buffer_load_dwordx4 v4, s[20:23], 0 offen offset:2048 sc1 lds
    v_mfma_f32_16x16x32_bf16 v[40:43], a[192:195], v[32:35], v[40:43]
    s_waitcnt vmcnt(8) lgkmcnt(6)
    s_barrier
    ds_read_b128 v[24:27], v4 offset:20480
    v_mfma_f32_16x16x32_bf16 v[40:43], a[204:207], v[36:39], v[40:43]
    v_mfma_f32_16x16x32_bf16 v[44:47], a[196:199], v[32:35], v[44:47]
    ds_read_b128 v[28:31], v4 offset:21504
    v_mfma_f32_16x16x32_bf16 v[44:47], a[208:211], v[36:39], v[44:47]
    ds_read_b128 v[76:79], v131 offset:61440
    v_mfma_f32_16x16x32_bf16 v[48:51], a[200:203], v[32:35], v[48:51]
    v_mfma_f32_16x16x32_bf16 v[48:51], a[212:215], v[36:39], v[48:51]
    s_waitcnt lgkmcnt(3)
    buffer_load_dwordx4 v4, s[20:23], 0 offen offset:3072 sc1 lds
    v_mfma_f32_16x16x32_bf16 v[40:43], a[216:219], v[16:19], v[40:43]
    ds_read_b128 v[32:35], v4 offset:22528
    v_mfma_f32_16x16x32_bf16 v[40:43], a[228:231], v[20:23], v[40:43]
    s_add_u32 m0, s43, 69632
    s_nop 0
    buffer_load_dwordx4 v9, s[20:23], 0 offen offset:0 sc1 lds
    v_mfma_f32_16x16x32_bf16 v[44:47], a[220:223], v[16:19], v[44:47]
    ds_read_b128 v[36:39], v4 offset:23552
    v_mfma_f32_16x16x32_bf16 v[44:47], a[232:235], v[20:23], v[44:47]
    v_mfma_f32_16x16x32_bf16 v[48:51], a[224:227], v[16:19], v[48:51]
    v_mfma_f32_16x16x32_bf16 v[48:51], a[236:239], v[20:23], v[48:51]
    s_waitcnt lgkmcnt(3)
    v_mfma_f32_16x16x32_bf16 v[52:55], a[0:3], v[24:27], 0
    ds_read_b128 v[16:19], v4 offset:24576
    v_mfma_f32_16x16x32_bf16 v[52:55], a[12:15], v[28:31], v[52:55]
    s_add_u32 m0, s43, 70656
    s_add_u32 s20, s52, 409600
    s_addc_u32 s21, s53, 0
    buffer_load_dwordx4 v4, s[20:23], 0 offen offset:0 sc1 lds
    v_mfma_f32_16x16x32_bf16 v[56:59], a[4:7], v[24:27], 0
    ds_read_b128 v[20:23], v4 offset:25600
    v_mfma_f32_16x16x32_bf16 v[56:59], a[16:19], v[28:31], v[56:59]
    buffer_load_dwordx4 v4, s[20:23], 0 offen offset:1024 sc1 lds
    v_mfma_f32_16x16x32_bf16 v[60:63], a[8:11], v[24:27], 0
    v_mfma_f32_16x16x32_bf16 v[60:63], a[20:23], v[28:31], v[60:63]
    s_waitcnt lgkmcnt(2)
    v_mfma_f32_16x16x32_bf16 v[52:55], a[24:27], v[32:35], v[52:55]
    ds_read_b128 v[24:27], v4 offset:26624
    s_waitcnt lgkmcnt(5)
    v_mfma_f32_16x16x32_bf16 v[52:55], a[36:39], v[36:39], v[52:55]
    v_fma_f32 v64, -v76, v108, v40
    v_fma_f32 v65, -v76, v109, v41
    v_mfma_f32_16x16x32_bf16 v[56:59], a[28:31], v[32:35], v[56:59]
    ds_read_b128 v[28:31], v4 offset:27648
    v_fma_f32 v66, -v76, v110, v42
    v_mfma_f32_16x16x32_bf16 v[56:59], a[40:43], v[36:39], v[56:59]
    v_fma_f32 v67, -v76, v111, v43
    v_fma_f32 v68, -v76, v112, v44
    v_mfma_f32_16x16x32_bf16 v[60:63], a[32:35], v[32:35], v[60:63]
    v_fma_f32 v69, -v76, v113, v45
    v_fma_f32 v70, -v76, v114, v46
    v_mfma_f32_16x16x32_bf16 v[60:63], a[44:47], v[36:39], v[60:63]
    s_waitcnt lgkmcnt(2)
    v_fma_f32 v71, -v76, v115, v47
    v_fma_f32 v88, -v76, v116, v48
    v_mfma_f32_16x16x32_bf16 v[52:55], a[48:51], v[16:19], v[52:55]
    ds_read_b128 v[32:35], v4 offset:28672
    v_fma_f32 v89, -v76, v117, v49
    v_mfma_f32_16x16x32_bf16 v[52:55], a[60:63], v[20:23], v[52:55]
    v_fma_f32 v90, -v76, v118, v50
    v_fma_f32 v91, -v76, v119, v51
    v_mfma_f32_16x16x32_bf16 v[56:59], a[52:55], v[16:19], v[56:59]
    ds_read_b128 v[36:39], v4 offset:29696
    ds_read_b128 v[80:83], v131 offset:61952
    v_mfma_f32_16x16x32_bf16 v[56:59], a[64:67], v[20:23], v[56:59]
    ds_read_b128 v[84:87], v4 offset:61440
    v_mul_f32 v72, v64, v78
    v_mfma_f32_16x16x32_bf16 v[60:63], a[56:59], v[16:19], v[60:63]
    v_mul_f32 v73, v65, v78
    v_mul_f32 v74, v66, v78
    v_mfma_f32_16x16x32_bf16 v[60:63], a[68:71], v[20:23], v[60:63]
    s_waitcnt lgkmcnt(4)
    v_mul_f32 v75, v67, v78
    v_mul_f32 v64, v64, v68
    v_mfma_f32_16x16x32_bf16 v[52:55], a[72:75], v[24:27], v[52:55]
    ds_read_b128 v[16:19], v4 offset:30720
    v_mul_f32 v65, v65, v69
    v_mfma_f32_16x16x32_bf16 v[52:55], a[84:87], v[28:31], v[52:55]
    buffer_load_dwordx4 v4, s[20:23], 0 offen offset:2048 sc1 lds
    v_mfma_f32_16x16x32_bf16 v[56:59], a[76:79], v[24:27], v[56:59]
    ds_read_b128 v[20:23], v4 offset:31744
    v_mul_f32 v66, v66, v70
    v_mfma_f32_16x16x32_bf16 v[56:59], a[88:91], v[28:31], v[56:59]
    s_barrier
    buffer_load_dwordx4 v4, s[20:23], 0 offen offset:3072 sc1 lds
    v_mfma_f32_16x16x32_bf16 v[60:63], a[80:83], v[24:27], v[60:63]
    v_exp_f32 v72, v72
    v_mfma_f32_16x16x32_bf16 v[60:63], a[92:95], v[28:31], v[60:63]
    s_waitcnt lgkmcnt(4)
    v_exp_f32 v73, v73
    v_mfma_f32_16x16x32_bf16 v[52:55], a[96:99], v[32:35], v[52:55]
    ds_read_b128 v[24:27], v4 offset:32768
    v_mul_f32 v67, v67, v71
    v_mfma_f32_16x16x32_bf16 v[52:55], a[108:111], v[36:39], v[52:55]
    s_add_u32 m0, s41, 0
    s_add_u32 s16, s48, 102400
    s_addc_u32 s17, s49, 0
    buffer_load_dwordx4 v4, s[16:19], 0 offen offset:0 sc1 lds
    v_mfma_f32_16x16x32_bf16 v[56:59], a[100:103], v[32:35], v[56:59]
    ds_read_b128 v[28:31], v4 offset:33792
    v_fma_f32 v72, v72, v77, v77
    v_mfma_f32_16x16x32_bf16 v[56:59], a[112:115], v[36:39], v[56:59]
    v_exp_f32 v74, v74
    v_mfma_f32_16x16x32_bf16 v[60:63], a[104:107], v[32:35], v[60:63]
    v_exp_f32 v75, v75
    v_mfma_f32_16x16x32_bf16 v[60:63], a[116:119], v[36:39], v[60:63]
    s_waitcnt lgkmcnt(2)
    buffer_load_dwordx4 v4, s[16:19], 0 offen offset:1024 sc1 lds
    v_mfma_f32_16x16x32_bf16 v[52:55], a[120:123], v[16:19], v[52:55]
    ds_read_b128 v[32:35], v4 offset:34816
    v_fma_f32 v73, v73, v77, v77
    v_mfma_f32_16x16x32_bf16 v[52:55], a[132:135], v[20:23], v[52:55]
    v_fma_f32 v74, v74, v77, v77
    v_fma_f32 v75, v75, v77, v77
    v_mfma_f32_16x16x32_bf16 v[56:59], a[124:127], v[16:19], v[56:59]
    ds_read_b128 v[36:39], v4 offset:35840
    v_mfma_f32_16x16x32_bf16 v[56:59], a[136:139], v[20:23], v[56:59]
    buffer_load_dwordx4 v4, s[16:19], 0 offen offset:2048 sc1 lds
    v_mfma_f32_16x16x32_bf16 v[60:63], a[128:131], v[16:19], v[60:63]
    v_rcp_f32 v72, v72
    v_mfma_f32_16x16x32_bf16 v[60:63], a[140:143], v[20:23], v[60:63]
    s_waitcnt lgkmcnt(2)
    v_rcp_f32 v73, v73
    v_mfma_f32_16x16x32_bf16 v[52:55], a[144:147], v[24:27], v[52:55]
    ds_read_b128 v[16:19], v4 offset:36864
    v_mul_f32 v64, v64, v72
    v_mfma_f32_16x16x32_bf16 v[52:55], a[156:159], v[28:31], v[52:55]
    buffer_load_dwordx4 v4, s[16:19], 0 offen offset:3072 sc1 lds
    v_mfma_f32_16x16x32_bf16 v[56:59], a[148:151], v[24:27], v[56:59]
    ds_read_b128 v[20:23], v4 offset:37888
    v_mul_f32 v65, v65, v73
    v_mfma_f32_16x16x32_bf16 v[56:59], a[160:163], v[28:31], v[56:59]
    v_rcp_f32 v74, v74
    v_mfma_f32_16x16x32_bf16 v[60:63], a[152:155], v[24:27], v[60:63]
    v_rcp_f32 v75, v75
    v_mfma_f32_16x16x32_bf16 v[60:63], a[164:167], v[28:31], v[60:63]
    s_waitcnt lgkmcnt(2)
    v_mul_f32 v66, v66, v74
    v_mul_f32 v67, v67, v75
    v_mfma_f32_16x16x32_bf16 v[52:55], a[168:171], v[32:35], v[52:55]
    ds_read_b128 v[24:27], v4 offset:38912
    v_cvt_pk_bf16_f32 v124, v64, v65
    v_mfma_f32_16x16x32_bf16 v[52:55], a[180:183], v[36:39], v[52:55]
    s_add_u32 m0, m0, 4096
    s_nop 0
    buffer_load_dwordx4 v9, s[16:19], 0 offen sc1 lds
    v_mfma_f32_16x16x32_bf16 v[56:59], a[172:175], v[32:35], v[56:59]
    ds_read_b128 v[28:31], v4 offset:39936
    v_cvt_pk_bf16_f32 v125, v66, v67
    v_mfma_f32_16x16x32_bf16 v[56:59], a[184:187], v[36:39], v[56:59]
    s_add_u32 s20, s52, 81920
    s_addc_u32 s21, s53, 0
    buffer_load_dwordx4 v[132:135], v4, s[20:23], 0 offen offset:2048 sc1
    v_mfma_f32_16x16x32_bf16 v[60:63], a[176:179], v[32:35], v[60:63]
    v_mfma_f32_16x16x32_bf16 v[60:63], a[188:191], v[36:39], v[60:63]
    s_waitcnt lgkmcnt(2)
    buffer_store_dwordx2 v[124:125], v7, s[28:31], s46 offen sc1
    v_mfma_f32_16x16x32_bf16 v[52:55], a[192:195], v[16:19], v[52:55]
    s_waitcnt vmcnt(16)
    s_barrier
    ds_read_b128 v[32:35], v4 offset:40960
    v_mfma_f32_16x16x32_bf16 v[52:55], a[204:207], v[20:23], v[52:55]
    buffer_load_dwordx4 v[136:139], v4, s[20:23], 0 offen offset:3072 sc1
    v_mfma_f32_16x16x32_bf16 v[56:59], a[196:199], v[16:19], v[56:59]
    ds_read_b128 v[36:39], v4 offset:41984
    v_mfma_f32_16x16x32_bf16 v[56:59], a[208:211], v[20:23], v[56:59]
    v_mfma_f32_16x16x32_bf16 v[60:63], a[200:203], v[16:19], v[60:63]
    v_mfma_f32_16x16x32_bf16 v[60:63], a[212:215], v[20:23], v[60:63]
    s_waitcnt lgkmcnt(2)
    buffer_load_dwordx4 v[140:143], v9, s[20:23], 0 offen offset:0 sc1
    v_mfma_f32_16x16x32_bf16 v[52:55], a[216:219], v[24:27], v[52:55]
    ds_read_b128 v[16:19], v4 offset:43008
    v_mfma_f32_16x16x32_bf16 v[52:55], a[228:231], v[28:31], v[52:55]
    v_mfma_f32_16x16x32_bf16 v[56:59], a[220:223], v[24:27], v[56:59]
    ds_read_b128 v[20:23], v4 offset:44032
    v_mfma_f32_16x16x32_bf16 v[56:59], a[232:235], v[28:31], v[56:59]
    s_add_u32 s20, s52, 122880
    s_addc_u32 s21, s53, 0
    buffer_load_dwordx4 v[144:147], v4, s[20:23], 0 offen offset:0 sc1
    v_mfma_f32_16x16x32_bf16 v[60:63], a[224:227], v[24:27], v[60:63]
    v_mfma_f32_16x16x32_bf16 v[60:63], a[236:239], v[28:31], v[60:63]
    s_waitcnt lgkmcnt(2)
    v_mfma_f32_16x16x32_bf16 v[40:43], a[0:3], v[32:35], 0
    ds_read_b128 v[24:27], v4 offset:45056
    v_mfma_f32_16x16x32_bf16 v[40:43], a[12:15], v[36:39], v[40:43]
    buffer_load_dwordx4 v[148:151], v4, s[20:23], 0 offen offset:1024 sc1
    v_mfma_f32_16x16x32_bf16 v[44:47], a[4:7], v[32:35], 0
    ds_read_b128 v[28:31], v4 offset:46080
    v_mfma_f32_16x16x32_bf16 v[44:47], a[16:19], v[36:39], v[44:47]
    v_mfma_f32_16x16x32_bf16 v[48:51], a[8:11], v[32:35], 0
    v_mfma_f32_16x16x32_bf16 v[48:51], a[20:23], v[36:39], v[48:51]
    s_waitcnt lgkmcnt(2)
    buffer_load_dwordx4 v[152:155], v4, s[20:23], 0 offen offset:2048 sc1
    v_mfma_f32_16x16x32_bf16 v[40:43], a[24:27], v[16:19], v[40:43]
    ds_read_b128 v[32:35], v4 offset:47104
    s_waitcnt lgkmcnt(15)
    v_mfma_f32_16x16x32_bf16 v[40:43], a[36:39], v[20:23], v[40:43]
    v_fma_f32 v92, -v80, v116, v60
    v_fma_f32 v93, -v80, v117, v61
    v_mfma_f32_16x16x32_bf16 v[44:47], a[28:31], v[16:19], v[44:47]
    ds_read_b128 v[36:39], v4 offset:48128
    v_fma_f32 v94, -v80, v118, v62
    v_mfma_f32_16x16x32_bf16 v[44:47], a[40:43], v[20:23], v[44:47]
    v_fma_f32 v95, -v80, v119, v63
    v_fma_f32 v64, -v80, v108, v52
    v_mfma_f32_16x16x32_bf16 v[48:51], a[32:35], v[16:19], v[48:51]
    v_fma_f32 v65, -v80, v109, v53
    v_fma_f32 v66, -v80, v110, v54
    v_mfma_f32_16x16x32_bf16 v[48:51], a[44:47], v[20:23], v[48:51]
    s_waitcnt lgkmcnt(2)
    v_fma_f32 v67, -v80, v111, v55
    v_fma_f32 v68, -v80, v112, v56
    v_mfma_f32_16x16x32_bf16 v[40:43], a[48:51], v[24:27], v[40:43]
    ds_read_b128 v[16:19], v4 offset:49152
    v_fma_f32 v69, -v80, v113, v57
    v_mfma_f32_16x16x32_bf16 v[40:43], a[60:63], v[28:31], v[40:43]
    v_fma_f32 v70, -v80, v114, v58
    v_fma_f32 v71, -v80, v115, v59
    v_mfma_f32_16x16x32_bf16 v[44:47], a[52:55], v[24:27], v[44:47]
    ds_read_b128 v[20:23], v4 offset:50176
    ds_read_b128 v[76:79], v131 offset:62464
    v_mfma_f32_16x16x32_bf16 v[44:47], a[64:67], v[28:31], v[44:47]
    v_mul_f32 v72, v64, v82
    v_mul_f32 v73, v65, v82
    v_mfma_f32_16x16x32_bf16 v[48:51], a[56:59], v[24:27], v[48:51]
    v_mul_f32 v74, v66, v82
    v_mul_f32 v75, v67, v82
    v_mfma_f32_16x16x32_bf16 v[48:51], a[68:71], v[28:31], v[48:51]
    s_waitcnt lgkmcnt(3)
    v_exp_f32 v72, v72
    v_mfma_f32_16x16x32_bf16 v[40:43], a[72:75], v[32:35], v[40:43]
    ds_read_b128 v[24:27], v4 offset:51200
    v_mul_f32 v64, v64, v68
    v_mfma_f32_16x16x32_bf16 v[40:43], a[84:87], v[36:39], v[40:43]
    v_exp_f32 v73, v73
    v_mfma_f32_16x16x32_bf16 v[44:47], a[76:79], v[32:35], v[44:47]
    ds_read_b128 v[28:31], v4 offset:52224
    v_mul_f32 v65, v65, v69
    v_mfma_f32_16x16x32_bf16 v[44:47], a[88:91], v[36:39], v[44:47]
    s_barrier
    v_exp_f32 v74, v74
    v_mfma_f32_16x16x32_bf16 v[48:51], a[80:83], v[32:35], v[48:51]
    v_exp_f32 v75, v75
    v_mfma_f32_16x16x32_bf16 v[48:51], a[92:95], v[36:39], v[48:51]
    s_waitcnt lgkmcnt(3)
    v_mul_f32 v66, v66, v70
    v_mul_f32 v67, v67, v71
    v_mfma_f32_16x16x32_bf16 v[40:43], a[96:99], v[16:19], v[40:43]
    ds_read_b128 v[32:35], v4 offset:53248
    v_fma_f32 v72, v72, v81, v81
    v_mfma_f32_16x16x32_bf16 v[40:43], a[108:111], v[20:23], v[40:43]
    s_add_u32 m0, s41, 20480
    s_add_u32 s16, s48, 40960
    s_addc_u32 s17, s49, 0
    buffer_load_dwordx4 v4, s[16:19], 0 offen offset:0 sc1 lds
    v_mfma_f32_16x16x32_bf16 v[44:47], a[100:103], v[16:19], v[44:47]
    ds_read_b128 v[36:39], v4 offset:54272
    v_fma_f32 v73, v73, v81, v81
    v_mfma_f32_16x16x32_bf16 v[44:47], a[112:115], v[20:23], v[44:47]
    buffer_load_dwordx4 v4, s[16:19], 0 offen offset:1024 sc1 lds
    v_mfma_f32_16x16x32_bf16 v[48:51], a[104:107], v[16:19], v[48:51]
    v_fma_f32 v74, v74, v81, v81
    v_fma_f32 v75, v75, v81, v81
    v_mfma_f32_16x16x32_bf16 v[48:51], a[116:119], v[20:23], v[48:51]
L_warm2_0:
    s_cbranch_execz L_warm2_ret
    s_waitcnt lgkmcnt(2)
    v_rcp_f32 v72, v72
    v_mfma_f32_16x16x32_bf16 v[40:43], a[120:123], v[24:27], v[40:43]
    ds_read_b128 v[16:19], v4 offset:55296
    v_mul_f32 v64, v64, v72
    v_mfma_f32_16x16x32_bf16 v[40:43], a[132:135], v[28:31], v[40:43]
    buffer_load_dwordx4 v4, s[16:19], 0 offen offset:2048 sc1 lds
    v_mfma_f32_16x16x32_bf16 v[44:47], a[124:127], v[24:27], v[44:47]
    ds_read_b128 v[20:23], v4 offset:56320
    v_mfma_f32_16x16x32_bf16 v[44:47], a[136:139], v[28:31], v[44:47]
    v_rcp_f32 v73, v73
    v_mfma_f32_16x16x32_bf16 v[48:51], a[128:131], v[24:27], v[48:51]
    v_rcp_f32 v74, v74
    v_mfma_f32_16x16x32_bf16 v[48:51], a[140:143], v[28:31], v[48:51]
    s_waitcnt lgkmcnt(2)
    buffer_load_dwordx4 v4, s[16:19], 0 offen offset:3072 sc1 lds
    v_mfma_f32_16x16x32_bf16 v[40:43], a[144:147], v[32:35], v[40:43]
    ds_read_b128 v[24:27], v4 offset:57344
    v_mul_f32 v65, v65, v73
    v_mfma_f32_16x16x32_bf16 v[40:43], a[156:159], v[36:39], v[40:43]
    v_rcp_f32 v75, v75
    v_mfma_f32_16x16x32_bf16 v[44:47], a[148:151], v[32:35], v[44:47]
    ds_read_b128 v[28:31], v4 offset:58368
    v_mul_f32 v66, v66, v74
    v_mfma_f32_16x16x32_bf16 v[44:47], a[160:163], v[36:39], v[44:47]
    s_add_u32 m0, m0, 4096
    s_nop 0
    buffer_load_dwordx4 v9, s[16:19], 0 offen sc1 lds
    v_mfma_f32_16x16x32_bf16 v[48:51], a[152:155], v[32:35], v[48:51]
    v_mul_f32 v67, v67, v75
    v_cvt_pk_bf16_f32 v126, v64, v65
    v_mfma_f32_16x16x32_bf16 v[48:51], a[164:167], v[36:39], v[48:51]
    s_waitcnt lgkmcnt(2)
    v_cvt_pk_bf16_f32 v127, v66, v67
    s_add_u32 s35, s46, 196608
    v_mfma_f32_16x16x32_bf16 v[40:43], a[168:171], v[16:19], v[40:43]
    ds_read_b128 v[32:35], v4 offset:59392
    v_mfma_f32_16x16x32_bf16 v[40:43], a[180:183], v[20:23], v[40:43]
    buffer_load_dwordx4 v[156:159], v4, s[20:23], 0 offen offset:3072 sc1
    v_mfma_f32_16x16x32_bf16 v[44:47], a[172:175], v[16:19], v[44:47]
    ds_read_b128 v[36:39], v4 offset:60416
    v_mfma_f32_16x16x32_bf16 v[44:47], a[184:187], v[20:23], v[44:47]
    buffer_store_dwordx2 v[126:127], v7, s[28:31], s35 offen sc1
    v_mfma_f32_16x16x32_bf16 v[48:51], a[176:179], v[16:19], v[48:51]
    v_permlane32_swap_b32 v88, v92
    v_permlane32_swap_b32 v89, v93
    v_mfma_f32_16x16x32_bf16 v[48:51], a[188:191], v[20:23], v[48:51]
    s_waitcnt lgkmcnt(2)
    v_permlane32_swap_b32 v90, v94
    v_permlane32_swap_b32 v91, v95
    v_mfma_f32_16x16x32_bf16 v[40:43], a[192:195], v[24:27], v[40:43]
    s_waitcnt vmcnt(14)
    s_barrier
    ds_read_b128 v[16:19], v4 offset:0
    v_mul_f32 v72, v88, v86
    v_mfma_f32_16x16x32_bf16 v[40:43], a[204:207], v[28:31], v[40:43]
    v_mul_f32 v73, v89, v86
    v_mul_f32 v74, v90, v86
    v_mfma_f32_16x16x32_bf16 v[44:47], a[196:199], v[24:27], v[44:47]
    ds_read_b128 v[20:23], v4 offset:1024
    v_mul_f32 v75, v91, v86
    v_mfma_f32_16x16x32_bf16 v[44:47], a[208:211], v[28:31], v[44:47]
    v_exp_f32 v72, v72
    v_mfma_f32_16x16x32_bf16 v[48:51], a[200:203], v[24:27], v[48:51]
    v_exp_f32 v73, v73
    v_mfma_f32_16x16x32_bf16 v[48:51], a[212:215], v[28:31], v[48:51]
    s_waitcnt lgkmcnt(2)
    v_exp_f32 v74, v74
    v_mfma_f32_16x16x32_bf16 v[40:43], a[216:219], v[32:35], v[40:43]
    ds_read_b128 v[24:27], v4 offset:2048
    v_mul_f32 v88, v88, v92
    v_mfma_f32_16x16x32_bf16 v[40:43], a[228:231], v[36:39], v[40:43]
    v_exp_f32 v75, v75
    v_mfma_f32_16x16x32_bf16 v[44:47], a[220:223], v[32:35], v[44:47]
    ds_read_b128 v[28:31], v4 offset:3072
    v_mul_f32 v89, v89, v93
    v_mfma_f32_16x16x32_bf16 v[44:47], a[232:235], v[36:39], v[44:47]
    v_mul_f32 v90, v90, v94
    v_mul_f32 v91, v91, v95
    v_mfma_f32_16x16x32_bf16 v[48:51], a[224:227], v[32:35], v[48:51]
    v_fma_f32 v72, v72, v85, v85
    v_fma_f32 v73, v73, v85, v85
    v_mfma_f32_16x16x32_bf16 v[48:51], a[236:239], v[36:39], v[48:51]
    s_waitcnt lgkmcnt(2)
    buffer_load_dwordx4 v[160:163], v9, s[20:23], 0 offen offset:0 sc1
    v_mfma_f32_16x16x32_bf16 v[52:55], a[0:3], v[16:19], 0
    ds_read_b128 v[32:35], v4 offset:4096
    v_fma_f32 v74, v74, v85, v85
    v_mfma_f32_16x16x32_bf16 v[52:55], a[12:15], v[20:23], v[52:55]
    v_fma_f32 v75, v75, v85, v85
    v_mfma_f32_16x16x32_bf16 v[56:59], a[4:7], v[16:19], 0
    ds_read_b128 v[36:39], v4 offset:5120
    v_mfma_f32_16x16x32_bf16 v[56:59], a[16:19], v[20:23], v[56:59]
    v_rcp_f32 v72, v72
    v_mfma_f32_16x16x32_bf16 v[60:63], a[8:11], v[16:19], 0
    v_rcp_f32 v73, v73
    v_mfma_f32_16x16x32_bf16 v[60:63], a[20:23], v[20:23], v[60:63]
    s_waitcnt lgkmcnt(2)
    v_rcp_f32 v74, v74
    v_mfma_f32_16x16x32_bf16 v[52:55], a[24:27], v[24:27], v[52:55]
    ds_read_b128 v[16:19], v4 offset:6144
    v_mul_f32 v88, v88, v72
    v_mfma_f32_16x16x32_bf16 v[52:55], a[36:39], v[28:31], v[52:55]
    v_rcp_f32 v75, v75
    v_mfma_f32_16x16x32_bf16 v[56:59], a[28:31], v[24:27], v[56:59]
    ds_read_b128 v[20:23], v4 offset:7168
    v_mul_f32 v89, v89, v73
    v_mfma_f32_16x16x32_bf16 v[56:59], a[40:43], v[28:31], v[56:59]
    v_mul_f32 v90, v90, v74
    v_mul_f32 v91, v91, v75
    v_mfma_f32_16x16x32_bf16 v[60:63], a[32:35], v[24:27], v[60:63]
    v_cvt_pk_bf16_f32 v128, v88, v89
    v_cvt_pk_bf16_f32 v129, v90, v91
    v_mfma_f32_16x16x32_bf16 v[60:63], a[44:47], v[28:31], v[60:63]
    s_waitcnt lgkmcnt(2)
    buffer_store_dwordx2 v[128:129], v8, s[28:31], s46 offen offset:512 sc1
    v_mfma_f32_16x16x32_bf16 v[52:55], a[48:51], v[32:35], v[52:55]
    ds_read_b128 v[24:27], v4 offset:8192
    s_add_u32 s46, s46, 49152
    v_mfma_f32_16x16x32_bf16 v[52:55], a[60:63], v[36:39], v[52:55]
    s_waitcnt lgkmcnt(15)
    v_fma_f32 v64, -v76, v108, v40
    v_fma_f32 v65, -v76, v109, v41
    v_mfma_f32_16x16x32_bf16 v[56:59], a[52:55], v[32:35], v[56:59]
    ds_read_b128 v[28:31], v4 offset:9216
    v_fma_f32 v66, -v76, v110, v42
    v_mfma_f32_16x16x32_bf16 v[56:59], a[64:67], v[36:39], v[56:59]
    s_add_u32 s20, s52, 163840
    s_addc_u32 s21, s53, 0
    buffer_load_dwordx4 v[164:167], v4, s[20:23], 0 offen offset:0 sc1
    v_mfma_f32_16x16x32_bf16 v[60:63], a[56:59], v[32:35], v[60:63]
    v_fma_f32 v67, -v76, v111, v43
    v_fma_f32 v68, -v76, v112, v44
    v_mfma_f32_16x16x32_bf16 v[60:63], a[68:71], v[36:39], v[60:63]
    s_waitcnt lgkmcnt(2)
    v_fma_f32 v69, -v76, v113, v45
    v_fma_f32 v70, -v76, v114, v46
    v_mfma_f32_16x16x32_bf16 v[52:55], a[72:75], v[16:19], v[52:55]
    ds_read_b128 v[32:35], v4 offset:10240
    v_fma_f32 v71, -v76, v115, v47
    v_mfma_f32_16x16x32_bf16 v[52:55], a[84:87], v[20:23], v[52:55]
    v_fma_f32 v88, -v76, v116, v48
    v_fma_f32 v89, -v76, v117, v49
    v_mfma_f32_16x16x32_bf16 v[56:59], a[76:79], v[16:19], v[56:59]
    ds_read_b128 v[36:39], v4 offset:11264
    v_fma_f32 v90, -v76, v118, v50
    v_mfma_f32_16x16x32_bf16 v[56:59], a[88:91], v[20:23], v[56:59]
    s_barrier
    v_fma_f32 v91, -v76, v119, v51
    ds_read_b128 v[80:83], v131 offset:62976
    v_mfma_f32_16x16x32_bf16 v[60:63], a[80:83], v[16:19], v[60:63]
    ds_read_b128 v[84:87], v4 offset:62464
    v_mul_f32 v72, v64, v78
    v_mfma_f32_16x16x32_bf16 v[60:63], a[92:95], v[20:23], v[60:63]
    s_waitcnt lgkmcnt(4)
    v_mul_f32 v73, v65, v78
    v_mul_f32 v74, v66, v78
    v_mfma_f32_16x16x32_bf16 v[52:55], a[96:99], v[24:27], v[52:55]
    ds_read_b128 v[16:19], v4 offset:12288
    v_mul_f32 v75, v67, v78
    v_mfma_f32_16x16x32_bf16 v[52:55], a[108:111], v[28:31], v[52:55]
    s_add_u32 m0, s41, 40960
    s_add_u32 s16, s48, 122880
    s_addc_u32 s17, s49, 0
    buffer_load_dwordx4 v4, s[16:19], 0 offen offset:0 sc1 lds
    v_mfma_f32_16x16x32_bf16 v[56:59], a[100:103], v[24:27], v[56:59]
    ds_read_b128 v[20:23], v4 offset:13312
    v_mul_f32 v64, v64, v68
    v_mfma_f32_16x16x32_bf16 v[56:59], a[112:115], v[28:31], v[56:59]
    buffer_load_dwordx4 v4, s[16:19], 0 offen offset:1024 sc1 lds
    v_mfma_f32_16x16x32_bf16 v[60:63], a[104:107], v[24:27], v[60:63]
    v_exp_f32 v72, v72
    v_mfma_f32_16x16x32_bf16 v[60:63], a[116:119], v[28:31], v[60:63]
    s_waitcnt lgkmcnt(4)
    v_exp_f32 v73, v73
    v_mfma_f32_16x16x32_bf16 v[52:55], a[120:123], v[32:35], v[52:55]
    ds_read_b128 v[24:27], v4 offset:14336
    v_mul_f32 v65, v65, v69
    v_mfma_f32_16x16x32_bf16 v[52:55], a[132:135], v[36:39], v[52:55]
    buffer_load_dwordx4 v4, s[16:19], 0 offen offset:2048 sc1 lds
    v_mfma_f32_16x16x32_bf16 v[56:59], a[124:127], v[32:35], v[56:59]
    ds_read_b128 v[28:31], v4 offset:15360
    v_mul_f32 v66, v66, v70
    v_mfma_f32_16x16x32_bf16 v[56:59], a[136:139], v[36:39], v[56:59]
    v_exp_f32 v74, v74
    v_mfma_f32_16x16x32_bf16 v[60:63], a[128:131], v[32:35], v[60:63]
    v_exp_f32 v75, v75
    v_mfma_f32_16x16x32_bf16 v[60:63], a[140:143], v[36:39], v[60:63]
    s_waitcnt lgkmcnt(2)
    buffer_load_dwordx4 v4, s[16:19], 0 offen offset:3072 sc1 lds
    v_mfma_f32_16x16x32_bf16 v[52:55], a[144:147], v[16:19], v[52:55]
    ds_read_b128 v[32:35], v4 offset:16384
    v_mul_f32 v67, v67, v71
    v_mfma_f32_16x16x32_bf16 v[52:55], a[156:159], v[20:23], v[52:55]
    v_fma_f32 v72, v72, v77, v77
    v_fma_f32 v73, v73, v77, v77
    v_mfma_f32_16x16x32_bf16 v[56:59], a[148:151], v[16:19], v[56:59]
    ds_read_b128 v[36:39], v4 offset:17408
    v_fma_f32 v74, v74, v77, v77
    v_mfma_f32_16x16x32_bf16 v[56:59], a[160:163], v[20:23], v[56:59]
    s_add_u32 m0, m0, 4096
    s_nop 0
    buffer_load_dwordx4 v9, s[16:19], 0 offen sc1 lds
    v_mfma_f32_16x16x32_bf16 v[60:63], a[152:155], v[16:19], v[60:63]
    v_fma_f32 v75, v75, v77, v77
    v_mfma_f32_16x16x32_bf16 v[60:63], a[164:167], v[20:23], v[60:63]
    s_waitcnt lgkmcnt(2)
    v_rcp_f32 v72, v72
    v_mfma_f32_16x16x32_bf16 v[52:55], a[168:171], v[24:27], v[52:55]
    ds_read_b128 v[16:19], v4 offset:18432
    v_mul_f32 v64, v64, v72
    v_mfma_f32_16x16x32_bf16 v[52:55], a[180:183], v[28:31], v[52:55]
    buffer_load_dwordx4 v[168:171], v4, s[20:23], 0 offen offset:1024 sc1
    v_mfma_f32_16x16x32_bf16 v[56:59], a[172:175], v[24:27], v[56:59]
    ds_read_b128 v[20:23], v4 offset:19456
    v_mfma_f32_16x16x32_bf16 v[56:59], a[184:187], v[28:31], v[56:59]
    v_rcp_f32 v73, v73
    v_mfma_f32_16x16x32_bf16 v[60:63], a[176:179], v[24:27], v[60:63]
    v_rcp_f32 v74, v74
    v_mfma_f32_16x16x32_bf16 v[60:63], a[188:191], v[28:31], v[60:63]
    s_waitcnt lgkmcnt(2)
    v_rcp_f32 v75, v75
    v_mfma_f32_16x16x32_bf16 v[52:55], a[192:195], v[32:35], v[52:55]
    s_waitcnt vmcnt(11)
    s_barrier
    ds_read_b128 v[24:27], v4 offset:20480
    v_mul_f32 v65, v65, v73
    v_mfma_f32_16x16x32_bf16 v[52:55], a[204:207], v[36:39], v[52:55]
    v_mul_f32 v66, v66, v74
    v_mul_f32 v67, v67, v75
    v_mfma_f32_16x16x32_bf16 v[56:59], a[196:199], v[32:35], v[56:59]
    ds_read_b128 v[28:31], v4 offset:21504
    v_cvt_pk_bf16_f32 v124, v64, v65
    v_mfma_f32_16x16x32_bf16 v[56:59], a[208:211], v[36:39], v[56:59]
    v_cvt_pk_bf16_f32 v125, v66, v67
    v_mfma_f32_16x16x32_bf16 v[60:63], a[200:203], v[32:35], v[60:63]
    v_mfma_f32_16x16x32_bf16 v[60:63], a[212:215], v[36:39], v[60:63]
    s_waitcnt lgkmcnt(2)
    buffer_store_dwordx2 v[124:125], v7, s[28:31], s46 offen sc1
    v_mfma_f32_16x16x32_bf16 v[52:55], a[216:219], v[16:19], v[52:55]
    ds_read_b128 v[32:35], v4 offset:22528
    v_mfma_f32_16x16x32_bf16 v[52:55], a[228:231], v[20:23], v[52:55]
    s_add_u32 s20, s52, 409600
    s_addc_u32 s21, s53, 0
    buffer_load_dwordx4 v[204:207], v9, s[20:23], 0 offen offset:0 sc1
    v_mfma_f32_16x16x32_bf16 v[56:59], a[220:223], v[16:19], v[56:59]
    ds_read_b128 v[36:39], v4 offset:23552
    v_mfma_f32_16x16x32_bf16 v[56:59], a[232:235], v[20:23], v[56:59]
    s_add_u32 s20, s52, 450560
    s_addc_u32 s21, s53, 0
    buffer_load_dwordx4 v[96:99], v4, s[20:23], 0 offen offset:0 sc1
    v_mfma_f32_16x16x32_bf16 v[60:63], a[224:227], v[16:19], v[60:63]
    v_mfma_f32_16x16x32_bf16 v[60:63], a[236:239], v[20:23], v[60:63]
    s_waitcnt lgkmcnt(2)
    v_mfma_f32_16x16x32_bf16 v[40:43], a[0:3], v[24:27], 0
    ds_read_b128 v[16:19], v4 offset:24576
    v_mfma_f32_16x16x32_bf16 v[40:43], a[12:15], v[28:31], v[40:43]
    buffer_load_dwordx4 v[100:103], v4, s[20:23], 0 offen offset:1024 sc1
    v_mfma_f32_16x16x32_bf16 v[44:47], a[4:7], v[24:27], 0
    ds_read_b128 v[20:23], v4 offset:25600
    v_mfma_f32_16x16x32_bf16 v[44:47], a[16:19], v[28:31], v[44:47]
    v_mfma_f32_16x16x32_bf16 v[48:51], a[8:11], v[24:27], 0
    v_mfma_f32_16x16x32_bf16 v[48:51], a[20:23], v[28:31], v[48:51]
    s_waitcnt lgkmcnt(2)
    buffer_load_dwordx4 v[104:107], v4, s[20:23], 0 offen offset:2048 sc1
    v_mfma_f32_16x16x32_bf16 v[40:43], a[24:27], v[32:35], v[40:43]
    ds_read_b128 v[24:27], v4 offset:26624
    s_waitcnt lgkmcnt(15)
    v_mfma_f32_16x16x32_bf16 v[40:43], a[36:39], v[36:39], v[40:43]
    v_fma_f32 v92, -v80, v116, v60
    v_fma_f32 v93, -v80, v117, v61
    v_mfma_f32_16x16x32_bf16 v[44:47], a[28:31], v[32:35], v[44:47]
    ds_read_b128 v[28:31], v4 offset:27648
    v_fma_f32 v94, -v80, v118, v62
    v_mfma_f32_16x16x32_bf16 v[44:47], a[40:43], v[36:39], v[44:47]
    v_fma_f32 v95, -v80, v119, v63
    v_fma_f32 v64, -v80, v108, v52
    v_mfma_f32_16x16x32_bf16 v[48:51], a[32:35], v[32:35], v[48:51]
    v_fma_f32 v65, -v80, v109, v53
    v_fma_f32 v66, -v80, v110, v54
    v_mfma_f32_16x16x32_bf16 v[48:51], a[44:47], v[36:39], v[48:51]
    s_waitcnt lgkmcnt(2)
    v_fma_f32 v67, -v80, v111, v55
    v_fma_f32 v68, -v80, v112, v56
    v_mfma_f32_16x16x32_bf16 v[40:43], a[48:51], v[16:19], v[40:43]
    ds_read_b128 v[32:35], v4 offset:28672
    v_fma_f32 v69, -v80, v113, v57
    v_mfma_f32_16x16x32_bf16 v[40:43], a[60:63], v[20:23], v[40:43]
    s_waitcnt vmcnt(12)
    s_cmp_eq_u32 s61, 0
    s_cbranch_scc1 L_st3_g
    buffer_store_dword v0, v15, s[28:31], s39 offen offset:0
L_st3_j:
    v_mfma_f32_16x16x32_bf16 v[44:47], a[52:55], v[16:19], v[44:47]
    ds_read_b128 v[36:39], v4 offset:29696
    v_fma_f32 v70, -v80, v114, v58
    v_mfma_f32_16x16x32_bf16 v[44:47], a[64:67], v[20:23], v[44:47]
    v_fma_f32 v71, -v80, v115, v59
    ds_read_b128 v[76:79], v131 offset:63488
    v_mfma_f32_16x16x32_bf16 v[48:51], a[56:59], v[16:19], v[48:51]
    v_mul_f32 v72, v64, v82
    v_mul_f32 v73, v65, v82
    v_mfma_f32_16x16x32_bf16 v[48:51], a[68:71], v[20:23], v[48:51]
    s_waitcnt lgkmcnt(3)
    v_mul_f32 v74, v66, v82
    v_mul_f32 v75, v67, v82
    v_mfma_f32_16x16x32_bf16 v[40:43], a[72:75], v[24:27], v[40:43]
    ds_read_b128 v[16:19], v4 offset:30720
    v_mul_f32 v64, v64, v68
    v_mfma_f32_16x16x32_bf16 v[40:43], a[84:87], v[28:31], v[40:43]
    v_exp_f32 v72, v72
    v_mfma_f32_16x16x32_bf16 v[44:47], a[76:79], v[24:27], v[44:47]
    ds_read_b128 v[20:23], v4 offset:31744
    v_mul_f32 v65, v65, v69
    v_mfma_f32_16x16x32_bf16 v[44:47], a[88:91], v[28:31], v[44:47]
    s_barrier
    v_exp_f32 v73, v73
    v_mfma_f32_16x16x32_bf16 v[48:51], a[80:83], v[24:27], v[48:51]
    v_exp_f32 v74, v74
    v_mfma_f32_16x16x32_bf16 v[48:51], a[92:95], v[28:31], v[48:51]
    s_waitcnt lgkmcnt(3)
    v_exp_f32 v75, v75
    v_mfma_f32_16x16x32_bf16 v[40:43], a[96:99], v[32:35], v[40:43]
    ds_read_b128 v[24:27], v4 offset:32768
    v_mul_f32 v66, v66, v70
    v_mfma_f32_16x16x32_bf16 v[40:43], a[108:111], v[36:39], v[40:43]
    s_add_u32 m0, s41, 0
    s_add_u32 s16, s48, 61440
    s_addc_u32 s17, s49, 0
    buffer_load_dwordx4 v4, s[16:19], 0 offen offset:0 sc1 lds
    v_mfma_f32_16x16x32_bf16 v[44:47], a[100:103], v[32:35], v[44:47]
    ds_read_b128 v[28:31], v4 offset:33792
    v_mul_f32 v67, v67, v71
    v_mfma_f32_16x16x32_bf16 v[44:47], a[112:115], v[36:39], v[44:47]
    buffer_load_dwordx4 v4, s[16:19], 0 offen offset:1024 sc1 lds
    v_mfma_f32_16x16x32_bf16 v[48:51], a[104:107], v[32:35], v[48:51]
    v_fma_f32 v72, v72, v81, v81
    v_fma_f32 v73, v73, v81, v81
    v_mfma_f32_16x16x32_bf16 v[48:51], a[116:119], v[36:39], v[48:51]
    s_waitcnt lgkmcnt(2)
    v_fma_f32 v74, v74, v81, v81
    v_fma_f32 v75, v75, v81, v81
    v_mfma_f32_16x16x32_bf16 v[40:43], a[120:123], v[16:19], v[40:43]
    ds_read_b128 v[32:35], v4 offset:34816
    v_mfma_f32_16x16x32_bf16 v[40:43], a[132:135], v[20:23], v[40:43]
    buffer_load_dwordx4 v4, s[16:19], 0 offen offset:2048 sc1 lds
    v_mfma_f32_16x16x32_bf16 v[44:47], a[124:127], v[16:19], v[44:47]
    ds_read_b128 v[36:39], v4 offset:35840
    v_mfma_f32_16x16x32_bf16 v[44:47], a[136:139], v[20:23], v[44:47]
    v_rcp_f32 v72, v72
    v_mfma_f32_16x16x32_bf16 v[48:51], a[128:131], v[16:19], v[48:51]
    v_rcp_f32 v73, v73
    v_mfma_f32_16x16x32_bf16 v[48:51], a[140:143], v[20:23], v[48:51]
    s_waitcnt lgkmcnt(2)
    buffer_load_dwordx4 v4, s[16:19], 0 offen offset:3072 sc1 lds
    v_mfma_f32_16x16x32_bf16 v[40:43], a[144:147], v[24:27], v[40:43]
    ds_read_b128 v[16:19], v4 offset:36864
    v_mul_f32 v64, v64, v72
    v_mfma_f32_16x16x32_bf16 v[40:43], a[156:159], v[28:31], v[40:43]
    v_rcp_f32 v74, v74
    v_mfma_f32_16x16x32_bf16 v[44:47], a[148:151], v[24:27], v[44:47]
    ds_read_b128 v[20:23], v4 offset:37888
    v_mul_f32 v65, v65, v73
    v_mfma_f32_16x16x32_bf16 v[44:47], a[160:163], v[28:31], v[44:47]
    s_add_u32 m0, m0, 4096
    s_nop 0
    buffer_load_dwordx4 v9, s[16:19], 0 offen sc1 lds
    v_mfma_f32_16x16x32_bf16 v[48:51], a[152:155], v[24:27], v[48:51]
    v_rcp_f32 v75, v75
    v_mfma_f32_16x16x32_bf16 v[48:51], a[164:167], v[28:31], v[48:51]
    s_waitcnt lgkmcnt(2)
    v_mul_f32 v66, v66, v74
    v_mul_f32 v67, v67, v75
    v_mfma_f32_16x16x32_bf16 v[40:43], a[168:171], v[32:35], v[40:43]
    ds_read_b128 v[24:27], v4 offset:38912
    v_cvt_pk_bf16_f32 v126, v64, v65
    v_mfma_f32_16x16x32_bf16 v[40:43], a[180:183], v[36:39], v[40:43]
    buffer_load_dwordx4 a[240:243], v130, s[28:31], s45 offen sc1
    v_mfma_f32_16x16x32_bf16 v[44:47], a[172:175], v[32:35], v[44:47]
    ds_read_b128 v[28:31], v4 offset:39936
    v_cvt_pk_bf16_f32 v127, v66, v67
    v_mfma_f32_16x16x32_bf16 v[44:47], a[184:187], v[36:39], v[44:47]
    s_add_u32 s35, s46, 196608
    buffer_store_dwordx2 v[126:127], v7, s[28:31], s35 offen sc1
    v_mfma_f32_16x16x32_bf16 v[48:51], a[176:179], v[32:35], v[48:51]
    v_permlane32_swap_b32 v88, v92
    v_permlane32_swap_b32 v89, v93
    v_mfma_f32_16x16x32_bf16 v[48:51], a[188:191], v[36:39], v[48:51]
    s_waitcnt lgkmcnt(2)
    v_permlane32_swap_b32 v90, v94
    v_permlane32_swap_b32 v91, v95
    v_mfma_f32_16x16x32_bf16 v[40:43], a[192:195], v[16:19], v[40:43]
    s_waitcnt vmcnt(14)
    s_barrier
    ds_read_b128 v[32:35], v4 offset:40960
    v_mul_f32 v72, v88, v86
    v_mfma_f32_16x16x32_bf16 v[40:43], a[204:207], v[20:23], v[40:43]
    v_mul_f32 v73, v89, v86
    v_mul_f32 v74, v90, v86
    v_mfma_f32_16x16x32_bf16 v[44:47], a[196:199], v[16:19], v[44:47]
    ds_read_b128 v[36:39], v4 offset:41984
    v_mul_f32 v75, v91, v86
    v_mfma_f32_16x16x32_bf16 v[44:47], a[208:211], v[20:23], v[44:47]
    v_exp_f32 v72, v72
    v_mfma_f32_16x16x32_bf16 v[48:51], a[200:203], v[16:19], v[48:51]
    v_exp_f32 v73, v73
    v_mfma_f32_16x16x32_bf16 v[48:51], a[212:215], v[20:23], v[48:51]
    s_waitcnt lgkmcnt(2)
    v_exp_f32 v74, v74
    v_mfma_f32_16x16x32_bf16 v[40:43], a[216:219], v[24:27], v[40:43]
    ds_read_b128 v[16:19], v4 offset:43008
    v_mul_f32 v88, v88, v92
    v_mfma_f32_16x16x32_bf16 v[40:43], a[228:231], v[28:31], v[40:43]
    v_exp_f32 v75, v75
    v_mfma_f32_16x16x32_bf16 v[44:47], a[220:223], v[24:27], v[44:47]
    ds_read_b128 v[20:23], v4 offset:44032
    v_mul_f32 v89, v89, v93
    v_mfma_f32_16x16x32_bf16 v[44:47], a[232:235], v[28:31], v[44:47]
    v_mul_f32 v90, v90, v94
    v_mul_f32 v91, v91, v95
    v_mfma_f32_16x16x32_bf16 v[48:51], a[224:227], v[24:27], v[48:51]
    v_fma_f32 v72, v72, v85, v85
    v_fma_f32 v73, v73, v85, v85
    v_mfma_f32_16x16x32_bf16 v[48:51], a[236:239], v[28:31], v[48:51]
    s_waitcnt lgkmcnt(2)
    v_fma_f32 v74, v74, v85, v85
    v_fma_f32 v75, v75, v85, v85
    v_mfma_f32_16x16x32_bf16 v[52:55], a[0:3], v[32:35], 0
    ds_read_b128 v[24:27], v4 offset:45056
    v_mfma_f32_16x16x32_bf16 v[52:55], a[12:15], v[36:39], v[52:55]
    s_add_u32 s45, s45, 20480
    buffer_load_dwordx4 a[244:247], v130, s[28:31], s45 offen sc1
    v_mfma_f32_16x16x32_bf16 v[56:59], a[4:7], v[32:35], 0
    ds_read_b128 v[28:31], v4 offset:46080
    v_mfma_f32_16x16x32_bf16 v[56:59], a[16:19], v[36:39], v[56:59]
    v_rcp_f32 v72, v72
    v_mfma_f32_16x16x32_bf16 v[60:63], a[8:11], v[32:35], 0
    v_rcp_f32 v73, v73
    v_mfma_f32_16x16x32_bf16 v[60:63], a[20:23], v[36:39], v[60:63]
    s_waitcnt lgkmcnt(2)
    v_rcp_f32 v74, v74
    v_mfma_f32_16x16x32_bf16 v[52:55], a[24:27], v[16:19], v[52:55]
    ds_read_b128 v[32:35], v4 offset:47104
    v_mul_f32 v88, v88, v72
    v_mfma_f32_16x16x32_bf16 v[52:55], a[36:39], v[20:23], v[52:55]
    v_rcp_f32 v75, v75
    v_mfma_f32_16x16x32_bf16 v[56:59], a[28:31], v[16:19], v[56:59]
    ds_read_b128 v[36:39], v4 offset:48128
    v_mul_f32 v89, v89, v73
    v_mfma_f32_16x16x32_bf16 v[56:59], a[40:43], v[20:23], v[56:59]
    v_mul_f32 v90, v90, v74
    v_mul_f32 v91, v91, v75
    v_mfma_f32_16x16x32_bf16 v[60:63], a[32:35], v[16:19], v[60:63]
    v_cvt_pk_bf16_f32 v128, v88, v89
    v_cvt_pk_bf16_f32 v129, v90, v91
    v_mfma_f32_16x16x32_bf16 v[60:63], a[44:47], v[20:23], v[60:63]
    s_waitcnt lgkmcnt(2)
    buffer_store_dwordx2 v[128:129], v8, s[28:31], s46 offen offset:512 sc1
    v_mfma_f32_16x16x32_bf16 v[52:55], a[48:51], v[24:27], v[52:55]
    ds_read_b128 v[16:19], v4 offset:49152
    s_add_u32 s46, s46, 49152
    v_mfma_f32_16x16x32_bf16 v[52:55], a[60:63], v[28:31], v[52:55]
    s_waitcnt lgkmcnt(15)
    v_fma_f32 v64, -v76, v108, v40
    v_fma_f32 v65, -v76, v109, v41
    v_mfma_f32_16x16x32_bf16 v[56:59], a[52:55], v[24:27], v[56:59]
    ds_read_b128 v[20:23], v4 offset:50176
    v_fma_f32 v66, -v76, v110, v42
    v_mfma_f32_16x16x32_bf16 v[56:59], a[64:67], v[28:31], v[56:59]
    v_fma_f32 v67, -v76, v111, v43
    v_fma_f32 v68, -v76, v112, v44
    v_mfma_f32_16x16x32_bf16 v[60:63], a[56:59], v[24:27], v[60:63]
    v_fma_f32 v69, -v76, v113, v45
    v_fma_f32 v70, -v76, v114, v46
    v_mfma_f32_16x16x32_bf16 v[60:63], a[68:71], v[28:31], v[60:63]
    s_waitcnt lgkmcnt(2)
    v_fma_f32 v71, -v76, v115, v47
    v_fma_f32 v88, -v76, v116, v48
    v_mfma_f32_16x16x32_bf16 v[52:55], a[72:75], v[32:35], v[52:55]
    ds_read_b128 v[24:27], v4 offset:51200
    v_fma_f32 v89, -v76, v117, v49
    v_mfma_f32_16x16x32_bf16 v[52:55], a[84:87], v[36:39], v[52:55]
    s_add_u32 s45, s45, 20480
    buffer_load_dwordx4 a[248:251], v130, s[28:31], s45 offen sc1
    v_mfma_f32_16x16x32_bf16 v[56:59], a[76:79], v[32:35], v[56:59]
    ds_read_b128 v[28:31], v4 offset:52224
    v_fma_f32 v90, -v76, v118, v50
    v_mfma_f32_16x16x32_bf16 v[56:59], a[88:91], v[36:39], v[56:59]
    s_barrier
    v_fma_f32 v91, -v76, v119, v51
    ds_read_b128 v[80:83], v131 offset:64000
    v_mfma_f32_16x16x32_bf16 v[60:63], a[80:83], v[32:35], v[60:63]
    ds_read_b128 v[84:87], v4 offset:63488
    v_mul_f32 v72, v64, v78
    v_mfma_f32_16x16x32_bf16 v[60:63], a[92:95], v[36:39], v[60:63]
    s_waitcnt lgkmcnt(4)
    v_mul_f32 v73, v65, v78
    v_mul_f32 v74, v66, v78
    v_mfma_f32_16x16x32_bf16 v[52:55], a[96:99], v[16:19], v[52:55]
    ds_read_b128 v[32:35], v4 offset:53248
    v_mul_f32 v75, v67, v78
    v_mfma_f32_16x16x32_bf16 v[52:55], a[108:111], v[20:23], v[52:55]
    s_add_u32 m0, s41, 20480
    s_add_u32 s16, s48, 143360
    s_addc_u32 s17, s49, 0
    buffer_load_dwordx4 v4, s[16:19], 0 offen offset:0 sc1 lds
    v_mfma_f32_16x16x32_bf16 v[56:59], a[100:103], v[16:19], v[56:59]
    ds_read_b128 v[36:39], v4 offset:54272
    v_mul_f32 v64, v64, v68
    v_mfma_f32_16x16x32_bf16 v[56:59], a[112:115], v[20:23], v[56:59]
    buffer_load_dwordx4 v4, s[16:19], 0 offen offset:1024 sc1 lds
    v_mfma_f32_16x16x32_bf16 v[60:63], a[104:107], v[16:19], v[60:63]
    v_exp_f32 v72, v72
    v_mfma_f32_16x16x32_bf16 v[60:63], a[116:119], v[20:23], v[60:63]
    s_waitcnt lgkmcnt(4)
    v_exp_f32 v73, v73
    v_mfma_f32_16x16x32_bf16 v[52:55], a[120:123], v[24:27], v[52:55]
    ds_read_b128 v[16:19], v4 offset:55296
    v_mul_f32 v65, v65, v69
    v_mfma_f32_16x16x32_bf16 v[52:55], a[132:135], v[28:31], v[52:55]
    buffer_load_dwordx4 v4, s[16:19], 0 offen offset:2048 sc1 lds
    v_mfma_f32_16x16x32_bf16 v[56:59], a[124:127], v[24:27], v[56:59]
    ds_read_b128 v[20:23], v4 offset:56320
    v_mul_f32 v66, v66, v70
    v_mfma_f32_16x16x32_bf16 v[56:59], a[136:139], v[28:31], v[56:59]
    v_exp_f32 v74, v74
    v_mfma_f32_16x16x32_bf16 v[60:63], a[128:131], v[24:27], v[60:63]
    v_exp_f32 v75, v75
    v_mfma_f32_16x16x32_bf16 v[60:63], a[140:143], v[28:31], v[60:63]
    s_waitcnt lgkmcnt(2)
    buffer_load_dwordx4 v4, s[16:19], 0 offen offset:3072 sc1 lds
    v_mfma_f32_16x16x32_bf16 v[52:55], a[144:147], v[32:35], v[52:55]
    ds_read_b128 v[24:27], v4 offset:57344
    v_mul_f32 v67, v67, v71
    v_mfma_f32_16x16x32_bf16 v[52:55], a[156:159], v[36:39], v[52:55]
    v_fma_f32 v72, v72, v77, v77
    v_fma_f32 v73, v73, v77, v77
    v_mfma_f32_16x16x32_bf16 v[56:59], a[148:151], v[32:35], v[56:59]
    ds_read_b128 v[28:31], v4 offset:58368
    v_fma_f32 v74, v74, v77, v77
    v_mfma_f32_16x16x32_bf16 v[56:59], a[160:163], v[36:39], v[56:59]
    s_add_u32 m0, m0, 4096
    s_nop 0
    buffer_load_dwordx4 v9, s[16:19], 0 offen sc1 lds
    v_mfma_f32_16x16x32_bf16 v[60:63], a[152:155], v[32:35], v[60:63]
    v_fma_f32 v75, v75, v77, v77
    v_mfma_f32_16x16x32_bf16 v[60:63], a[164:167], v[36:39], v[60:63]
    s_waitcnt lgkmcnt(2)
    v_rcp_f32 v72, v72
    v_mfma_f32_16x16x32_bf16 v[52:55], a[168:171], v[16:19], v[52:55]
    ds_read_b128 v[32:35], v4 offset:59392
    v_mul_f32 v64, v64, v72
    v_mfma_f32_16x16x32_bf16 v[52:55], a[180:183], v[20:23], v[52:55]
    s_add_u32 s45, s45, 20480
    buffer_load_dwordx4 a[252:255], v130, s[28:31], s45 offen sc1
    v_mfma_f32_16x16x32_bf16 v[56:59], a[172:175], v[16:19], v[56:59]
    ds_read_b128 v[36:39], v4 offset:60416
    v_mfma_f32_16x16x32_bf16 v[56:59], a[184:187], v[20:23], v[56:59]
    v_rcp_f32 v73, v73
    v_mfma_f32_16x16x32_bf16 v[60:63], a[176:179], v[16:19], v[60:63]
    v_rcp_f32 v74, v74
    v_mfma_f32_16x16x32_bf16 v[60:63], a[188:191], v[20:23], v[60:63]
    s_waitcnt lgkmcnt(2)
    v_rcp_f32 v75, v75
    v_mfma_f32_16x16x32_bf16 v[52:55], a[192:195], v[24:27], v[52:55]
    s_waitcnt vmcnt(11)
    s_barrier
    ds_read_b128 v[16:19], v4 offset:0
    v_mul_f32 v65, v65, v73
    v_mfma_f32_16x16x32_bf16 v[52:55], a[204:207], v[28:31], v[52:55]
    v_mul_f32 v66, v66, v74
    v_mul_f32 v67, v67, v75
    v_mfma_f32_16x16x32_bf16 v[56:59], a[196:199], v[24:27], v[56:59]
    ds_read_b128 v[20:23], v4 offset:1024
    v_cvt_pk_bf16_f32 v124, v64, v65
    v_mfma_f32_16x16x32_bf16 v[56:59], a[208:211], v[28:31], v[56:59]
    v_cvt_pk_bf16_f32 v125, v66, v67
    v_mfma_f32_16x16x32_bf16 v[60:63], a[200:203], v[24:27], v[60:63]
    v_mfma_f32_16x16x32_bf16 v[60:63], a[212:215], v[28:31], v[60:63]
    s_waitcnt lgkmcnt(2)
    buffer_store_dwordx2 v[124:125], v7, s[28:31], s46 offen sc1
    v_mfma_f32_16x16x32_bf16 v[52:55], a[216:219], v[32:35], v[52:55]
    ds_read_b128 v[24:27], v4 offset:2048
    v_mfma_f32_16x16x32_bf16 v[52:55], a[228:231], v[36:39], v[52:55]
    v_mfma_f32_16x16x32_bf16 v[56:59], a[220:223], v[32:35], v[56:59]
    ds_read_b128 v[28:31], v4 offset:3072
    v_mfma_f32_16x16x32_bf16 v[56:59], a[232:235], v[36:39], v[56:59]
    v_mfma_f32_16x16x32_bf16 v[60:63], a[224:227], v[32:35], v[60:63]
    v_mfma_f32_16x16x32_bf16 v[60:63], a[236:239], v[36:39], v[60:63]
    s_waitcnt lgkmcnt(2)
    v_mfma_f32_16x16x32_bf16 v[40:43], a[0:3], v[16:19], 0
    ds_read_b128 v[32:35], v4 offset:4096
    v_mfma_f32_16x16x32_bf16 v[40:43], a[12:15], v[20:23], v[40:43]
    v_mfma_f32_16x16x32_bf16 v[44:47], a[4:7], v[16:19], 0
    ds_read_b128 v[36:39], v4 offset:5120
    v_mfma_f32_16x16x32_bf16 v[44:47], a[16:19], v[20:23], v[44:47]
    v_mfma_f32_16x16x32_bf16 v[48:51], a[8:11], v[16:19], 0
    v_mfma_f32_16x16x32_bf16 v[48:51], a[20:23], v[20:23], v[48:51]
    s_waitcnt lgkmcnt(2)
    v_mfma_f32_16x16x32_bf16 v[40:43], a[24:27], v[24:27], v[40:43]
    ds_read_b128 v[16:19], v4 offset:6144
    s_waitcnt lgkmcnt(15)
    v_mfma_f32_16x16x32_bf16 v[40:43], a[36:39], v[28:31], v[40:43]
L_warm2_1:
    s_cbranch_execz L_warm2_ret
    v_fma_f32 v92, -v80, v116, v60
    v_fma_f32 v93, -v80, v117, v61
    v_mfma_f32_16x16x32_bf16 v[44:47], a[28:31], v[24:27], v[44:47]
    ds_read_b128 v[20:23], v4 offset:7168
    v_fma_f32 v94, -v80, v118, v62
    v_mfma_f32_16x16x32_bf16 v[44:47], a[40:43], v[28:31], v[44:47]
    v_fma_f32 v95, -v80, v119, v63
    v_fma_f32 v64, -v80, v108, v52
    v_mfma_f32_16x16x32_bf16 v[48:51], a[32:35], v[24:27], v[48:51]
    v_fma_f32 v65, -v80, v109, v53
    v_fma_f32 v66, -v80, v110, v54
    v_mfma_f32_16x16x32_bf16 v[48:51], a[44:47], v[28:31], v[48:51]
    s_waitcnt lgkmcnt(2)
    v_fma_f32 v67, -v80, v111, v55
    v_fma_f32 v68, -v80, v112, v56
    v_mfma_f32_16x16x32_bf16 v[40:43], a[48:51], v[32:35], v[40:43]
    ds_read_b128 v[24:27], v4 offset:8192
    v_fma_f32 v69, -v80, v113, v57
    v_mfma_f32_16x16x32_bf16 v[40:43], a[60:63], v[36:39], v[40:43]
    s_waitcnt vmcnt(8)
    s_cmp_eq_u32 s61, 0
    s_cbranch_scc1 L_st4_g
    buffer_store_dword v0, v15, s[28:31], s39 offen offset:512
L_st4_j:
    v_mfma_f32_16x16x32_bf16 v[44:47], a[52:55], v[32:35], v[44:47]
    ds_read_b128 v[28:31], v4 offset:9216
    v_fma_f32 v70, -v80, v114, v58
    v_mfma_f32_16x16x32_bf16 v[44:47], a[64:67], v[36:39], v[44:47]
    v_fma_f32 v71, -v80, v115, v59
    ds_read_b128 v[76:79], v131 offset:64512
    v_mfma_f32_16x16x32_bf16 v[48:51], a[56:59], v[32:35], v[48:51]
    v_mul_f32 v72, v64, v82
    v_mul_f32 v73, v65, v82
    v_mfma_f32_16x16x32_bf16 v[48:51], a[68:71], v[36:39], v[48:51]
    s_waitcnt lgkmcnt(3)
    v_mul_f32 v74, v66, v82
    v_mul_f32 v75, v67, v82
    v_mfma_f32_16x16x32_bf16 v[40:43], a[72:75], v[16:19], v[40:43]
    ds_read_b128 v[32:35], v4 offset:10240
    v_mul_f32 v64, v64, v68
    v_mfma_f32_16x16x32_bf16 v[40:43], a[84:87], v[20:23], v[40:43]
    v_exp_f32 v72, v72
    v_mfma_f32_16x16x32_bf16 v[44:47], a[76:79], v[16:19], v[44:47]
    ds_read_b128 v[36:39], v4 offset:11264
    v_mul_f32 v65, v65, v69
    v_mfma_f32_16x16x32_bf16 v[44:47], a[88:91], v[20:23], v[44:47]
    v_exp_f32 v73, v73
    v_mfma_f32_16x16x32_bf16 v[48:51], a[80:83], v[16:19], v[48:51]
    v_exp_f32 v74, v74
    v_mfma_f32_16x16x32_bf16 v[48:51], a[92:95], v[20:23], v[48:51]
    s_waitcnt lgkmcnt(3)
    v_exp_f32 v75, v75
    v_mfma_f32_16x16x32_bf16 v[40:43], a[96:99], v[24:27], v[40:43]
    ds_read_b128 v[16:19], v4 offset:12288
    v_mul_f32 v66, v66, v70
    v_mfma_f32_16x16x32_bf16 v[40:43], a[108:111], v[28:31], v[40:43]
    v_mul_f32 v67, v67, v71
    v_fma_f32 v72, v72, v81, v81
    v_mfma_f32_16x16x32_bf16 v[44:47], a[100:103], v[24:27], v[44:47]
    ds_read_b128 v[20:23], v4 offset:13312
    v_fma_f32 v73, v73, v81, v81
    v_mfma_f32_16x16x32_bf16 v[44:47], a[112:115], v[28:31], v[44:47]
    v_fma_f32 v74, v74, v81, v81
    v_fma_f32 v75, v75, v81, v81
    v_mfma_f32_16x16x32_bf16 v[48:51], a[104:107], v[24:27], v[48:51]
    v_rcp_f32 v72, v72
    v_mfma_f32_16x16x32_bf16 v[48:51], a[116:119], v[28:31], v[48:51]
    s_waitcnt lgkmcnt(2)
    v_rcp_f32 v73, v73
    v_mfma_f32_16x16x32_bf16 v[40:43], a[120:123], v[32:35], v[40:43]
    ds_read_b128 v[24:27], v4 offset:14336
    v_mul_f32 v64, v64, v72
    v_mfma_f32_16x16x32_bf16 v[40:43], a[132:135], v[36:39], v[40:43]
    buffer_load_dword v14, v11, s[28:31], s8 offen offset:0 sc1
    v_mfma_f32_16x16x32_bf16 v[44:47], a[124:127], v[32:35], v[44:47]
    ds_read_b128 v[28:31], v4 offset:15360
    v_mul_f32 v65, v65, v73
    v_mfma_f32_16x16x32_bf16 v[44:47], a[136:139], v[36:39], v[44:47]
    v_rcp_f32 v74, v74
    v_mfma_f32_16x16x32_bf16 v[48:51], a[128:131], v[32:35], v[48:51]
    v_rcp_f32 v75, v75
    v_mfma_f32_16x16x32_bf16 v[48:51], a[140:143], v[36:39], v[48:51]
    s_waitcnt lgkmcnt(2)
    v_mul_f32 v66, v66, v74
    v_mul_f32 v67, v67, v75
    v_mfma_f32_16x16x32_bf16 v[40:43], a[144:147], v[16:19], v[40:43]
    ds_read_b128 v[32:35], v4 offset:16384
    v_cvt_pk_bf16_f32 v126, v64, v65
    v_mfma_f32_16x16x32_bf16 v[40:43], a[156:159], v[20:23], v[40:43]
    v_cvt_pk_bf16_f32 v127, v66, v67
    s_add_u32 s35, s46, 196608
    v_mfma_f32_16x16x32_bf16 v[44:47], a[148:151], v[16:19], v[44:47]
    ds_read_b128 v[36:39], v4 offset:17408
    v_mfma_f32_16x16x32_bf16 v[44:47], a[160:163], v[20:23], v[44:47]
    buffer_store_dwordx2 v[126:127], v7, s[28:31], s35 offen sc1
    v_mfma_f32_16x16x32_bf16 v[48:51], a[152:155], v[16:19], v[48:51]
    v_permlane32_swap_b32 v88, v92
    v_permlane32_swap_b32 v89, v93
    v_mfma_f32_16x16x32_bf16 v[48:51], a[164:167], v[20:23], v[48:51]
    s_waitcnt lgkmcnt(2)
    v_permlane32_swap_b32 v90, v94
    v_permlane32_swap_b32 v91, v95
    v_mfma_f32_16x16x32_bf16 v[40:43], a[168:171], v[24:27], v[40:43]
    ds_read_b128 v[16:19], v4 offset:18432
    v_mul_f32 v72, v88, v86
    v_mfma_f32_16x16x32_bf16 v[40:43], a[180:183], v[28:31], v[40:43]
    v_mul_f32 v73, v89, v86
    v_mul_f32 v74, v90, v86
    v_mfma_f32_16x16x32_bf16 v[44:47], a[172:175], v[24:27], v[44:47]
    ds_read_b128 v[20:23], v4 offset:19456
    v_mul_f32 v75, v91, v86
    v_mfma_f32_16x16x32_bf16 v[44:47], a[184:187], v[28:31], v[44:47]
    v_exp_f32 v72, v72
    v_mfma_f32_16x16x32_bf16 v[48:51], a[176:179], v[24:27], v[48:51]
    v_exp_f32 v73, v73
    v_mfma_f32_16x16x32_bf16 v[48:51], a[188:191], v[28:31], v[48:51]
    s_waitcnt lgkmcnt(2)
    v_exp_f32 v74, v74
    v_mfma_f32_16x16x32_bf16 v[40:43], a[192:195], v[32:35], v[40:43]
    s_waitcnt vmcnt(5)
    s_barrier
    ds_read_b128 v[24:27], v4 offset:20480
    v_mul_f32 v88, v88, v92
    v_mfma_f32_16x16x32_bf16 v[40:43], a[204:207], v[36:39], v[40:43]
    v_exp_f32 v75, v75
    v_mfma_f32_16x16x32_bf16 v[44:47], a[196:199], v[32:35], v[44:47]
    ds_read_b128 v[28:31], v4 offset:21504
    v_mul_f32 v89, v89, v93
    v_mfma_f32_16x16x32_bf16 v[44:47], a[208:211], v[36:39], v[44:47]
    s_waitcnt vmcnt(1)
    v_cmp_eq_u32 vcc, 0, v14
    v_mfma_f32_16x16x32_bf16 v[48:51], a[200:203], v[32:35], v[48:51]
    v_mul_f32 v90, v90, v94
    v_mul_f32 v91, v91, v95
    v_mfma_f32_16x16x32_bf16 v[48:51], a[212:215], v[36:39], v[48:51]
    s_waitcnt lgkmcnt(2)
    v_fma_f32 v72, v72, v85, v85
    v_fma_f32 v73, v73, v85, v85
    v_mfma_f32_16x16x32_bf16 v[40:43], a[216:219], v[16:19], v[40:43]
    ds_read_b128 v[32:35], v4 offset:22528
    v_fma_f32 v74, v74, v85, v85
    v_mfma_f32_16x16x32_bf16 v[40:43], a[228:231], v[20:23], v[40:43]
    s_cbranch_vccnz L_a0_slow
L_a0_ok:
    v_mfma_f32_16x16x32_bf16 v[44:47], a[220:223], v[16:19], v[44:47]
    ds_read_b128 v[36:39], v4 offset:23552
    v_fma_f32 v75, v75, v85, v85
    v_mfma_f32_16x16x32_bf16 v[44:47], a[232:235], v[20:23], v[44:47]
    v_rcp_f32 v72, v72
    v_mfma_f32_16x16x32_bf16 v[48:51], a[224:227], v[16:19], v[48:51]
    v_rcp_f32 v73, v73
    v_mfma_f32_16x16x32_bf16 v[48:51], a[236:239], v[20:23], v[48:51]
    s_waitcnt lgkmcnt(2)
    v_rcp_f32 v74, v74
    v_mfma_f32_16x16x32_bf16 v[52:55], a[0:3], v[24:27], 0
    ds_read_b128 v[16:19], v4 offset:24576
    v_mul_f32 v88, v88, v72
    v_mfma_f32_16x16x32_bf16 v[52:55], a[12:15], v[28:31], v[52:55]
    buffer_load_dword v14, v11, s[28:31], s8 offen offset:512 sc1
    v_mfma_f32_16x16x32_bf16 v[56:59], a[4:7], v[24:27], 0
    ds_read_b128 v[20:23], v4 offset:25600
    v_mul_f32 v89, v89, v73
    v_mfma_f32_16x16x32_bf16 v[56:59], a[16:19], v[28:31], v[56:59]
    s_add_u32 s16, s56, 0
    s_addc_u32 s17, s57, 0
    buffer_load_dwordx4 a[0:3], v4, s[16:19], 0 offen offset:0 sc1
    v_mfma_f32_16x16x32_bf16 v[60:63], a[8:11], v[24:27], 0
    v_rcp_f32 v75, v75
    v_mfma_f32_16x16x32_bf16 v[60:63], a[20:23], v[28:31], v[60:63]
    s_waitcnt lgkmcnt(2)
    v_mul_f32 v90, v90, v74
    v_mul_f32 v91, v91, v75
    v_mfma_f32_16x16x32_bf16 v[52:55], a[24:27], v[32:35], v[52:55]
    ds_read_b128 v[24:27], v4 offset:26624
    s_add_u32 s42, s42, 102400
    v_mfma_f32_16x16x32_bf16 v[52:55], a[36:39], v[36:39], v[52:55]
    buffer_load_dwordx4 a[4:7], v4, s[16:19], 0 offen offset:1024 sc1
    v_mfma_f32_16x16x32_bf16 v[56:59], a[28:31], v[32:35], v[56:59]
    ds_read_b128 v[28:31], v4 offset:27648
    s_add_u32 s43, s43, 126976
    v_mfma_f32_16x16x32_bf16 v[56:59], a[40:43], v[36:39], v[56:59]
    v_add_u32 v12, s42, v4
    v_add_u32 v13, s43, v4
    v_mfma_f32_16x16x32_bf16 v[60:63], a[32:35], v[32:35], v[60:63]
    v_subrev_u32 v5, 61440, v13
    s_waitcnt vmcnt(57)
    v_mfma_f32_16x16x32_bf16 v[60:63], a[44:47], v[36:39], v[60:63]
    s_waitcnt lgkmcnt(2)
    buffer_load_dwordx4 a[8:11], v4, s[16:19], 0 offen offset:2048 sc1
    v_mfma_f32_16x16x32_bf16 v[52:55], a[48:51], v[16:19], v[52:55]
    ds_read_b128 v[32:35], v4 offset:28672
    v_cvt_pk_bf16_f32 v128, v88, v89
    v_mfma_f32_16x16x32_bf16 v[52:55], a[60:63], v[20:23], v[52:55]
    v_cvt_pk_bf16_f32 v129, v90, v91
    v_mfma_f32_16x16x32_bf16 v[56:59], a[52:55], v[16:19], v[56:59]
    ds_read_b128 v[36:39], v4 offset:29696
    v_mfma_f32_16x16x32_bf16 v[56:59], a[64:67], v[20:23], v[56:59]
    buffer_load_dwordx4 a[12:15], v4, s[16:19], 0 offen offset:3072 sc1
    v_mfma_f32_16x16x32_bf16 v[60:63], a[56:59], v[16:19], v[60:63]
    v_mfma_f32_16x16x32_bf16 v[60:63], a[68:71], v[20:23], v[60:63]
    s_waitcnt lgkmcnt(2)
    buffer_store_dwordx2 v[128:129], v8, s[28:31], s46 offen offset:512 sc1
    v_mfma_f32_16x16x32_bf16 v[52:55], a[72:75], v[24:27], v[52:55]
    ds_read_b128 v[16:19], v4 offset:30720
    s_add_u32 s46, s46, 49152
    v_mfma_f32_16x16x32_bf16 v[52:55], a[84:87], v[28:31], v[52:55]
    s_add_u32 s16, s56, 4096
    s_addc_u32 s17, s57, 0
    buffer_load_dwordx4 a[16:19], v4, s[16:19], 0 offen offset:0 sc1
    v_mfma_f32_16x16x32_bf16 v[56:59], a[76:79], v[24:27], v[56:59]
    ds_read_b128 v[20:23], v4 offset:31744
    s_waitcnt lgkmcnt(15)
    v_mfma_f32_16x16x32_bf16 v[56:59], a[88:91], v[28:31], v[56:59]
    v_fma_f32 v64, -v76, v108, v40
    v_fma_f32 v65, -v76, v109, v41
    v_mfma_f32_16x16x32_bf16 v[60:63], a[80:83], v[24:27], v[60:63]
    v_fma_f32 v66, -v76, v110, v42
    v_fma_f32 v67, -v76, v111, v43
    v_mfma_f32_16x16x32_bf16 v[60:63], a[92:95], v[28:31], v[60:63]
    s_waitcnt lgkmcnt(2)
    buffer_load_dwordx4 a[20:23], v4, s[16:19], 0 offen offset:1024 sc1
    v_mfma_f32_16x16x32_bf16 v[52:55], a[96:99], v[32:35], v[52:55]
    ds_read_b128 v[24:27], v4 offset:32768
    v_fma_f32 v68, -v76, v112, v44
    v_mfma_f32_16x16x32_bf16 v[52:55], a[108:111], v[36:39], v[52:55]
    v_fma_f32 v69, -v76, v113, v45
    v_fma_f32 v70, -v76, v114, v46
    v_mfma_f32_16x16x32_bf16 v[56:59], a[100:103], v[32:35], v[56:59]
    ds_read_b128 v[28:31], v4 offset:33792
    v_fma_f32 v71, -v76, v115, v47
    v_mfma_f32_16x16x32_bf16 v[56:59], a[112:115], v[36:39], v[56:59]
    buffer_load_dwordx4 a[24:27], v4, s[16:19], 0 offen offset:2048 sc1
    v_mfma_f32_16x16x32_bf16 v[60:63], a[104:107], v[32:35], v[60:63]
    v_fma_f32 v88, -v76, v116, v48
    v_fma_f32 v89, -v76, v117, v49
    v_mfma_f32_16x16x32_bf16 v[60:63], a[116:119], v[36:39], v[60:63]
    s_waitcnt lgkmcnt(2)
    v_fma_f32 v90, -v76, v118, v50
    v_fma_f32 v91, -v76, v119, v51
    v_mfma_f32_16x16x32_bf16 v[52:55], a[120:123], v[16:19], v[52:55]
    ds_read_b128 v[32:35], v4 offset:34816
    ds_read_b128 v[80:83], v131 offset:65024
    v_mfma_f32_16x16x32_bf16 v[52:55], a[132:135], v[20:23], v[52:55]
    buffer_load_dwordx4 a[28:31], v4, s[16:19], 0 offen offset:3072 sc1
    v_mfma_f32_16x16x32_bf16 v[56:59], a[124:127], v[16:19], v[56:59]
    ds_read_b128 v[36:39], v4 offset:35840
    ds_read_b128 v[84:87], v4 offset:64512
    v_mfma_f32_16x16x32_bf16 v[56:59], a[136:139], v[20:23], v[56:59]
    v_mul_f32 v72, v64, v78
    v_mul_f32 v73, v65, v78
    v_mfma_f32_16x16x32_bf16 v[60:63], a[128:131], v[16:19], v[60:63]
    v_mul_f32 v74, v66, v78
    v_mul_f32 v75, v67, v78
    v_mfma_f32_16x16x32_bf16 v[60:63], a[140:143], v[20:23], v[60:63]
    s_waitcnt lgkmcnt(4)
    v_exp_f32 v72, v72
    v_mfma_f32_16x16x32_bf16 v[52:55], a[144:147], v[24:27], v[52:55]
    ds_read_b128 v[16:19], v4 offset:36864
    v_mul_f32 v64, v64, v68
    v_mfma_f32_16x16x32_bf16 v[52:55], a[156:159], v[28:31], v[52:55]
    s_add_u32 s16, s56, 8192
    s_addc_u32 s17, s57, 0
    buffer_load_dwordx4 a[32:35], v4, s[16:19], 0 offen offset:0 sc1
    v_mfma_f32_16x16x32_bf16 v[56:59], a[148:151], v[24:27], v[56:59]
    ds_read_b128 v[20:23], v4 offset:37888
    v_mul_f32 v65, v65, v69
    v_mfma_f32_16x16x32_bf16 v[56:59], a[160:163], v[28:31], v[56:59]
    buffer_load_dwordx4 a[36:39], v4, s[16:19], 0 offen offset:1024 sc1
    v_mfma_f32_16x16x32_bf16 v[60:63], a[152:155], v[24:27], v[60:63]
    v_exp_f32 v73, v73
    v_mfma_f32_16x16x32_bf16 v[60:63], a[164:167], v[28:31], v[60:63]
    s_waitcnt lgkmcnt(3)
    v_exp_f32 v74, v74
    v_mfma_f32_16x16x32_bf16 v[52:55], a[168:171], v[32:35], v[52:55]
    ds_read_b128 v[24:27], v4 offset:38912
    v_mul_f32 v66, v66, v70
    v_mfma_f32_16x16x32_bf16 v[52:55], a[180:183], v[36:39], v[52:55]
    buffer_load_dwordx4 a[40:43], v4, s[16:19], 0 offen offset:2048 sc1
    v_mfma_f32_16x16x32_bf16 v[56:59], a[172:175], v[32:35], v[56:59]
    ds_read_b128 v[28:31], v4 offset:39936
    v_mul_f32 v67, v67, v71
    v_mfma_f32_16x16x32_bf16 v[56:59], a[184:187], v[36:39], v[56:59]
    v_exp_f32 v75, v75
    v_mfma_f32_16x16x32_bf16 v[60:63], a[176:179], v[32:35], v[60:63]
    v_fma_f32 v72, v72, v77, v77
    v_fma_f32 v73, v73, v77, v77
    v_mfma_f32_16x16x32_bf16 v[60:63], a[188:191], v[36:39], v[60:63]
    s_waitcnt lgkmcnt(2)
    buffer_load_dwordx4 a[44:47], v4, s[16:19], 0 offen offset:3072 sc1
    v_mfma_f32_16x16x32_bf16 v[52:55], a[192:195], v[16:19], v[52:55]
    v_fma_f32 v74, v74, v77, v77
    v_fma_f32 v75, v75, v77, v77
    v_mfma_f32_16x16x32_bf16 v[52:55], a[204:207], v[20:23], v[52:55]
    v_rcp_f32 v72, v72
    v_mfma_f32_16x16x32_bf16 v[56:59], a[196:199], v[16:19], v[56:59]
    v_rcp_f32 v73, v73
    v_mfma_f32_16x16x32_bf16 v[56:59], a[208:211], v[20:23], v[56:59]
    s_waitcnt vmcnt(13)
    v_cmp_eq_u32 vcc, 0, v14
    v_mfma_f32_16x16x32_bf16 v[60:63], a[200:203], v[16:19], v[60:63]
    v_rcp_f32 v74, v74
    v_mfma_f32_16x16x32_bf16 v[60:63], a[212:215], v[20:23], v[60:63]
    s_waitcnt lgkmcnt(0)
    v_rcp_f32 v75, v75
    v_mfma_f32_16x16x32_bf16 v[52:55], a[216:219], v[24:27], v[52:55]
    v_mul_f32 v64, v64, v72
    v_mul_f32 v65, v65, v73
    v_mfma_f32_16x16x32_bf16 v[52:55], a[228:231], v[28:31], v[52:55]
    s_waitcnt vmcnt(8)
    s_cmp_eq_u32 s61, 0
    s_cbranch_scc1 L_st5_g
    buffer_store_dword v0, v15, s[28:31], s39 offen offset:1024
L_st5_j:
    v_mfma_f32_16x16x32_bf16 v[56:59], a[220:223], v[24:27], v[56:59]
    v_mul_f32 v66, v66, v74
    v_mul_f32 v67, v67, v75
    v_mfma_f32_16x16x32_bf16 v[56:59], a[232:235], v[28:31], v[56:59]
    v_cvt_pk_bf16_f32 v124, v64, v65
    v_cvt_pk_bf16_f32 v125, v66, v67
    v_mfma_f32_16x16x32_bf16 v[60:63], a[224:227], v[24:27], v[60:63]
    v_mfma_f32_16x16x32_bf16 v[60:63], a[236:239], v[28:31], v[60:63]
    s_cbranch_vccnz L_a1_slow
L_a1_ok:
    s_add_u32 s16, s56, 49152
    s_addc_u32 s17, s57, 0
    buffer_load_dwordx4 a[48:51], v4, s[16:19], 0 offen offset:0 sc1
    s_waitcnt vmcnt(14)
    v_mfma_f32_16x16x32_bf16 v[16:19], v[208:211], a[0:3], 0
    s_waitcnt vmcnt(13)
    ds_read_b128 a[136:139], v12 offset:0
    v_mfma_f32_16x16x32_bf16 v[16:19], v[228:231], a[4:7], v[16:19]
    buffer_load_dwordx4 a[52:55], v4, s[16:19], 0 offen offset:1024 sc1
    v_mfma_f32_16x16x32_bf16 v[20:23], v[212:215], a[0:3], 0
    ds_read_b128 a[156:159], v12 offset:5120
    v_mfma_f32_16x16x32_bf16 v[20:23], v[232:235], a[4:7], v[20:23]
    ds_read_b128 a[140:143], v12 offset:1024
    v_mfma_f32_16x16x32_bf16 v[24:27], v[216:219], a[0:3], 0
    ds_read_b128 a[160:163], v13 offset:0
    v_mfma_f32_16x16x32_bf16 v[24:27], v[236:239], a[4:7], v[24:27]
    buffer_load_dwordx4 a[56:59], v4, s[16:19], 0 offen offset:2048 sc1
    v_mfma_f32_16x16x32_bf16 v[28:31], v[220:223], a[0:3], 0
    ds_read_b128 a[144:147], v12 offset:2048
    v_mfma_f32_16x16x32_bf16 v[28:31], v[240:243], a[4:7], v[28:31]
    buffer_load_dwordx4 a[60:63], v4, s[16:19], 0 offen offset:3072 sc1
    v_mfma_f32_16x16x32_bf16 v[32:35], v[224:227], a[0:3], 0
    ds_read_b128 a[164:167], v13 offset:1024
    v_mfma_f32_16x16x32_bf16 v[32:35], v[244:247], a[4:7], v[32:35]
    s_waitcnt vmcnt(15)
    ds_read_b128 a[148:151], v12 offset:3072
    v_mfma_f32_16x16x32_bf16 v[16:19], v[248:251], a[8:11], v[16:19]
    s_waitcnt vmcnt(14)
    ds_read_b128 a[168:171], v13 offset:2048
    v_mfma_f32_16x16x32_bf16 v[16:19], v[144:147], a[12:15], v[16:19]
    s_add_u32 s16, s56, 53248
    s_addc_u32 s17, s57, 0
    buffer_load_dwordx4 a[64:67], v4, s[16:19], 0 offen offset:0 sc1
    v_mfma_f32_16x16x32_bf16 v[20:23], v[252:255], a[8:11], v[20:23]
    ds_read_b128 a[152:155], v12 offset:4096
    v_mfma_f32_16x16x32_bf16 v[20:23], v[148:151], a[12:15], v[20:23]
    s_add_u32 s20, s52, 450560
    s_addc_u32 s21, s53, 0
    buffer_load_dwordx4 a[232:235], v4, s[20:23], 0 offen offset:3072 sc1
    v_mfma_f32_16x16x32_bf16 v[24:27], v[132:135], a[8:11], v[24:27]
    ds_read_b128 a[172:175], v13 offset:3072
    v_mfma_f32_16x16x32_bf16 v[24:27], v[152:155], a[12:15], v[24:27]
    ds_read_b128 a[176:179], v13 offset:4096
    v_mfma_f32_16x16x32_bf16 v[28:31], v[136:139], a[8:11], v[28:31]
    ds_read_b128 a[196:199], v5 offset:0
    v_mfma_f32_16x16x32_bf16 v[28:31], v[156:159], a[12:15], v[28:31]
    buffer_load_dwordx4 a[236:239], v9, s[20:23], 0 offen offset:0 sc1
    v_mfma_f32_16x16x32_bf16 v[32:35], v[140:143], a[8:11], v[32:35]
    ds_read_b128 a[180:183], v13 offset:5120
    v_mfma_f32_16x16x32_bf16 v[32:35], v[160:163], a[12:15], v[32:35]
    s_waitcnt vmcnt(15)
    buffer_load_dwordx4 a[68:71], v4, s[16:19], 0 offen offset:1024 sc1
    v_mfma_f32_16x16x32_bf16 v[16:19], v[164:167], a[16:19], v[16:19]
    s_waitcnt vmcnt(15)
    ds_read_b128 a[200:203], v5 offset:1024
    v_mfma_f32_16x16x32_bf16 v[16:19], v[184:187], a[20:23], v[16:19]
    ds_read_b128 a[184:187], v13 offset:6144
    v_mfma_f32_16x16x32_bf16 v[20:23], v[168:171], a[16:19], v[20:23]
    ds_read_b128 a[204:207], v5 offset:2048
    v_mfma_f32_16x16x32_bf16 v[20:23], v[188:191], a[20:23], v[20:23]
    buffer_load_dword v14, v11, s[28:31], s8 offen offset:1024 sc1
    v_mfma_f32_16x16x32_bf16 v[24:27], v[172:175], a[16:19], v[24:27]
    ds_read_b128 a[188:191], v13 offset:7168
    v_mfma_f32_16x16x32_bf16 v[24:27], v[192:195], a[20:23], v[24:27]
    buffer_load_dwordx4 a[72:75], v4, s[16:19], 0 offen offset:2048 sc1
    v_mfma_f32_16x16x32_bf16 v[28:31], v[176:179], a[16:19], v[28:31]
    ds_read_b128 a[208:211], v5 offset:3072
    v_mfma_f32_16x16x32_bf16 v[28:31], v[196:199], a[20:23], v[28:31]
    ds_read_b128 a[192:195], v13 offset:8192
    v_mfma_f32_16x16x32_bf16 v[32:35], v[180:183], a[16:19], v[32:35]
    ds_read_b128 a[212:215], v5 offset:4096
    v_mfma_f32_16x16x32_bf16 v[32:35], v[200:203], a[20:23], v[32:35]
    s_waitcnt vmcnt(16) lgkmcnt(15)
    buffer_load_dwordx4 a[76:79], v4, s[16:19], 0 offen offset:3072 sc1
    v_mfma_f32_16x16x32_bf16 v[16:19], a[136:139], a[24:27], v[16:19]
    s_waitcnt vmcnt(16) lgkmcnt(15)
    ds_read_b128 a[216:219], v5 offset:5120
    v_mfma_f32_16x16x32_bf16 v[16:19], a[156:159], a[28:31], v[16:19]
    s_waitcnt lgkmcnt(15)
    ds_read_b128 a[220:223], v5 offset:6144
    v_mfma_f32_16x16x32_bf16 v[20:23], a[140:143], a[24:27], v[20:23]
    s_waitcnt lgkmcnt(15)
    ds_read_b128 a[224:227], v5 offset:7168
    v_mfma_f32_16x16x32_bf16 v[20:23], a[160:163], a[28:31], v[20:23]
    s_waitcnt lgkmcnt(15)
    ds_read_b128 a[228:231], v5 offset:8192
    v_mfma_f32_16x16x32_bf16 v[24:27], a[144:147], a[24:27], v[24:27]
    s_waitcnt lgkmcnt(15)
    v_mfma_f32_16x16x32_bf16 v[24:27], a[164:167], a[28:31], v[24:27]
    s_waitcnt lgkmcnt(15)
    buffer_store_dwordx2 v[124:125], v7, s[28:31], s46 offen sc1
    v_mfma_f32_16x16x32_bf16 v[28:31], a[148:151], a[24:27], v[28:31]
    s_waitcnt lgkmcnt(15)
    s_waitcnt lgkmcnt(15)
    v_fma_f32 v92, -v80, v116, v60
    v_mfma_f32_16x16x32_bf16 v[28:31], a[168:171], a[28:31], v[28:31]
    s_waitcnt lgkmcnt(15)
    v_fma_f32 v93, -v80, v117, v61
    v_fma_f32 v94, -v80, v118, v62
    v_mfma_f32_16x16x32_bf16 v[32:35], a[152:155], a[24:27], v[32:35]
    s_waitcnt lgkmcnt(14)
    v_fma_f32 v95, -v80, v119, v63
    v_fma_f32 v64, -v80, v108, v52
    v_mfma_f32_16x16x32_bf16 v[32:35], a[172:175], a[28:31], v[32:35]
    s_waitcnt vmcnt(16) lgkmcnt(13)
    v_fma_f32 v65, -v80, v109, v53
    v_fma_f32 v66, -v80, v110, v54
    v_mfma_f32_16x16x32_bf16 v[16:19], a[176:179], a[32:35], v[16:19]
    s_waitcnt vmcnt(15) lgkmcnt(12)
    v_fma_f32 v67, -v80, v111, v55
    v_fma_f32 v68, -v80, v112, v56
    v_mfma_f32_16x16x32_bf16 v[16:19], a[196:199], a[36:39], v[16:19]
    s_waitcnt lgkmcnt(11)
    v_fma_f32 v69, -v80, v113, v57
    v_fma_f32 v70, -v80, v114, v58
    v_mfma_f32_16x16x32_bf16 v[20:23], a[180:183], a[32:35], v[20:23]
    s_waitcnt lgkmcnt(10)
    v_fma_f32 v71, -v80, v115, v59
    v_mul_f32 v72, v64, v82
    v_mfma_f32_16x16x32_bf16 v[20:23], a[200:203], a[36:39], v[20:23]
    s_waitcnt lgkmcnt(9)
    v_mul_f32 v73, v65, v82
    v_mul_f32 v74, v66, v82
    v_mfma_f32_16x16x32_bf16 v[24:27], a[184:187], a[32:35], v[24:27]
    s_waitcnt lgkmcnt(8)
    v_mul_f32 v75, v67, v82
    v_mul_f32 v64, v64, v68
    v_mfma_f32_16x16x32_bf16 v[24:27], a[204:207], a[36:39], v[24:27]
    s_waitcnt lgkmcnt(7)
    v_exp_f32 v72, v72
    v_mfma_f32_16x16x32_bf16 v[28:31], a[188:191], a[32:35], v[28:31]
    s_waitcnt lgkmcnt(6)
    v_exp_f32 v73, v73
    v_mfma_f32_16x16x32_bf16 v[28:31], a[208:211], a[36:39], v[28:31]
    s_waitcnt lgkmcnt(5)
    v_exp_f32 v74, v74
    v_mfma_f32_16x16x32_bf16 v[32:35], a[192:195], a[32:35], v[32:35]
    s_waitcnt lgkmcnt(4)
    v_exp_f32 v75, v75
    v_mfma_f32_16x16x32_bf16 v[32:35], a[212:215], a[36:39], v[32:35]
    s_waitcnt vmcnt(14) lgkmcnt(3)
    v_mul_f32 v65, v65, v69
    v_mul_f32 v66, v66, v70
    v_mfma_f32_16x16x32_bf16 v[16:19], a[216:219], a[40:43], v[16:19]
    s_waitcnt vmcnt(13)
    v_mul_f32 v67, v67, v71
    v_fma_f32 v72, v72, v81, v81
    v_mfma_f32_16x16x32_bf16 v[16:19], v[96:99], a[44:47], v[16:19]
    s_waitcnt lgkmcnt(2)
    v_fma_f32 v73, v73, v81, v81
    v_fma_f32 v74, v74, v81, v81
    v_mfma_f32_16x16x32_bf16 v[20:23], a[220:223], a[40:43], v[20:23]
    v_fma_f32 v75, v75, v81, v81
    v_mfma_f32_16x16x32_bf16 v[20:23], v[100:103], a[44:47], v[20:23]
    s_waitcnt lgkmcnt(1)
    v_rcp_f32 v72, v72
    v_mfma_f32_16x16x32_bf16 v[24:27], a[224:227], a[40:43], v[24:27]
    v_rcp_f32 v73, v73
    v_mfma_f32_16x16x32_bf16 v[24:27], v[104:107], a[44:47], v[24:27]
    s_waitcnt lgkmcnt(0)
    v_rcp_f32 v74, v74
    v_mfma_f32_16x16x32_bf16 v[28:31], a[228:231], a[40:43], v[28:31]
    s_waitcnt vmcnt(6)
    v_rcp_f32 v75, v75
    v_mfma_f32_16x16x32_bf16 v[28:31], a[232:235], a[44:47], v[28:31]
    s_add_u32 s16, s56, 57344
    s_addc_u32 s17, s57, 0
    buffer_load_dwordx4 a[80:83], v4, s[16:19], 0 offen offset:0 sc1
    v_mfma_f32_16x16x32_bf16 v[32:35], v[204:207], a[40:43], v[32:35]
    s_waitcnt vmcnt(6)
    v_mul_f32 v64, v64, v72
    v_mul_f32 v65, v65, v73
    v_mfma_f32_16x16x32_bf16 v[32:35], a[236:239], a[44:47], v[32:35]
    s_waitcnt vmcnt(12)
    buffer_load_dwordx4 a[84:87], v4, s[16:19], 0 offen offset:1024 sc1
    v_mul_f32 v66, v66, v74
    v_mul_f32 v67, v67, v75
    v_cvt_pk_bf16_f32 v126, v64, v65
    v_cvt_pk_bf16_f32 v127, v66, v67
    s_add_u32 s35, s46, 196608
    buffer_store_dwordx2 v[126:127], v7, s[28:31], s35 offen sc1
    v_permlane32_swap_b32 v88, v92
    v_permlane32_swap_b32 v89, v93
    v_permlane32_swap_b32 v90, v94
    v_permlane32_swap_b32 v91, v95
    v_mul_f32 v72, v88, v86
    v_mul_f32 v73, v89, v86
    v_mul_f32 v74, v90, v86
    v_mul_f32 v75, v91, v86
    v_exp_f32 v72, v72
    v_exp_f32 v73, v73
    v_exp_f32 v74, v74
    v_exp_f32 v75, v75
    v_mul_f32 v88, v88, v92
    v_mul_f32 v89, v89, v93
    v_mul_f32 v90, v90, v94
    v_mul_f32 v91, v91, v95
    v_fma_f32 v72, v72, v85, v85
    v_fma_f32 v73, v73, v85, v85
    v_fma_f32 v74, v74, v85, v85
    v_fma_f32 v75, v75, v85, v85
    v_rcp_f32 v72, v72
    v_rcp_f32 v73, v73
    v_rcp_f32 v74, v74
    v_rcp_f32 v75, v75
    v_mul_f32 v88, v88, v72
    v_mul_f32 v89, v89, v73
    v_mul_f32 v90, v90, v74
    v_mul_f32 v91, v91, v75
    v_cvt_pk_bf16_f32 v128, v88, v89
    v_cvt_pk_bf16_f32 v129, v90, v91
    buffer_store_dwordx2 v[128:129], v8, s[28:31], s46 offen offset:512 sc1
    s_add_u32 s46, s46, 49152
    s_barrier
    v_mfma_f32_16x16x32_bf16 v[36:39], v[208:211], a[48:51], 0
    s_waitcnt vmcnt(14)
    v_mfma_f32_16x16x32_bf16 v[36:39], v[228:231], a[52:55], v[36:39]
    buffer_load_dwordx4 a[88:91], v4, s[16:19], 0 offen offset:2048 sc1
    v_mfma_f32_16x16x32_bf16 v[40:43], v[212:215], a[48:51], 0
    v_mfma_f32_16x16x32_bf16 v[40:43], v[232:235], a[52:55], v[40:43]
    v_mfma_f32_16x16x32_bf16 v[44:47], v[216:219], a[48:51], 0
    v_mfma_f32_16x16x32_bf16 v[44:47], v[236:239], a[52:55], v[44:47]
    buffer_load_dwordx4 a[92:95], v4, s[16:19], 0 offen offset:3072 sc1
    v_mfma_f32_16x16x32_bf16 v[48:51], v[220:223], a[48:51], 0
    v_mfma_f32_16x16x32_bf16 v[48:51], v[240:243], a[52:55], v[48:51]
    s_waitcnt vmcnt(9)
    v_cmp_eq_u32 vcc, 0, v14
    v_mfma_f32_16x16x32_bf16 v[52:55], v[224:227], a[48:51], 0
    v_mfma_f32_16x16x32_bf16 v[52:55], v[244:247], a[52:55], v[52:55]
    s_waitcnt vmcnt(15)
    ds_write_b128 v121, v[16:19] offset:0
    v_mfma_f32_16x16x32_bf16 v[36:39], v[248:251], a[56:59], v[36:39]
    s_waitcnt vmcnt(14)
    v_accvgpr_read_b32 v56, a240
    v_lshlrev_b32 v60, 16, v56
    v_mfma_f32_16x16x32_bf16 v[36:39], v[144:147], a[60:63], v[36:39]
    s_cbranch_vccnz L_a2_slow
L_a2_ok:
    s_add_u32 s16, s56, 98304
    s_addc_u32 s17, s57, 0
    buffer_load_dwordx4 a[96:99], v4, s[16:19], 0 offen offset:0 sc1
    v_mfma_f32_16x16x32_bf16 v[40:43], v[252:255], a[56:59], v[40:43]
    v_and_b32 v61, 0xffff0000, v56
    v_mfma_f32_16x16x32_bf16 v[40:43], v[148:151], a[60:63], v[40:43]
    buffer_load_dwordx4 a[100:103], v4, s[16:19], 0 offen offset:1024 sc1
    v_mfma_f32_16x16x32_bf16 v[44:47], v[132:135], a[56:59], v[44:47]
    v_mfma_f32_16x16x32_bf16 v[44:47], v[152:155], a[60:63], v[44:47]
    ds_write_b128 v121, v[20:23] offset:64
    v_mfma_f32_16x16x32_bf16 v[48:51], v[136:139], a[56:59], v[48:51]
    v_accvgpr_read_b32 v57, a241
    v_lshlrev_b32 v62, 16, v57
    v_mfma_f32_16x16x32_bf16 v[48:51], v[156:159], a[60:63], v[48:51]
    buffer_load_dwordx4 a[104:107], v4, s[16:19], 0 offen offset:2048 sc1
    v_mfma_f32_16x16x32_bf16 v[52:55], v[140:143], a[56:59], v[52:55]
    v_and_b32 v63, 0xffff0000, v57
    v_mfma_f32_16x16x32_bf16 v[52:55], v[160:163], a[60:63], v[52:55]
    s_waitcnt vmcnt(16)
    buffer_load_dwordx4 a[108:111], v4, s[16:19], 0 offen offset:3072 sc1
    v_mfma_f32_16x16x32_bf16 v[36:39], v[164:167], a[64:67], v[36:39]
    s_waitcnt vmcnt(14)
    v_mfma_f32_16x16x32_bf16 v[36:39], v[184:187], a[68:71], v[36:39]
    ds_write_b128 v121, v[24:27] offset:128
    v_mfma_f32_16x16x32_bf16 v[40:43], v[168:171], a[64:67], v[40:43]
    v_accvgpr_read_b32 v58, a242
    v_lshlrev_b32 v64, 16, v58
    v_mfma_f32_16x16x32_bf16 v[40:43], v[188:191], a[68:71], v[40:43]
    s_add_u32 s16, s56, 102400
    s_addc_u32 s17, s57, 0
    buffer_load_dwordx4 a[112:115], v4, s[16:19], 0 offen offset:0 sc1
    v_mfma_f32_16x16x32_bf16 v[44:47], v[172:175], a[64:67], v[44:47]
    v_and_b32 v65, 0xffff0000, v58
    v_mfma_f32_16x16x32_bf16 v[44:47], v[192:195], a[68:71], v[44:47]
    buffer_load_dwordx4 a[116:119], v4, s[16:19], 0 offen offset:1024 sc1
    v_mfma_f32_16x16x32_bf16 v[48:51], v[176:179], a[64:67], v[48:51]
    v_mfma_f32_16x16x32_bf16 v[48:51], v[196:199], a[68:71], v[48:51]
    ds_write_b128 v121, v[28:31] offset:192
    v_mfma_f32_16x16x32_bf16 v[52:55], v[180:183], a[64:67], v[52:55]
    v_accvgpr_read_b32 v59, a243
    v_lshlrev_b32 v66, 16, v59
    v_mfma_f32_16x16x32_bf16 v[52:55], v[200:203], a[68:71], v[52:55]
    s_waitcnt vmcnt(14)
    buffer_load_dwordx4 a[120:123], v4, s[16:19], 0 offen offset:2048 sc1
    v_mfma_f32_16x16x32_bf16 v[36:39], a[136:139], a[72:75], v[36:39]
    s_waitcnt vmcnt(14)
    v_and_b32 v67, 0xffff0000, v59
    v_mfma_f32_16x16x32_bf16 v[36:39], a[156:159], a[76:79], v[36:39]
    buffer_load_dwordx4 a[124:127], v4, s[16:19], 0 offen offset:3072 sc1
    v_mfma_f32_16x16x32_bf16 v[40:43], a[140:143], a[72:75], v[40:43]
    v_mfma_f32_16x16x32_bf16 v[40:43], a[160:163], a[76:79], v[40:43]
    ds_write_b128 v121, v[32:35] offset:256
    v_mfma_f32_16x16x32_bf16 v[44:47], a[144:147], a[72:75], v[44:47]
    v_mfma_f32_16x16x32_bf16 v[44:47], a[164:167], a[76:79], v[44:47]
    s_waitcnt vmcnt(10)
    s_cmp_eq_u32 s61, 0
    s_cbranch_scc1 L_st6_g
    buffer_store_dword v0, v15, s[28:31], s39 offen offset:1536
L_st6_j:
    v_mfma_f32_16x16x32_bf16 v[48:51], a[148:151], a[72:75], v[48:51]
L_warm2_2:
    s_cbranch_execz L_warm2_ret
    v_mfma_f32_16x16x32_bf16 v[48:51], a[168:171], a[76:79], v[48:51]
    s_add_u32 s16, s56, 106496
    s_addc_u32 s17, s57, 0
    buffer_load_dwordx4 a[128:131], v4, s[16:19], 0 offen offset:0 sc1
    v_mfma_f32_16x16x32_bf16 v[52:55], a[152:155], a[72:75], v[52:55]
    v_mfma_f32_16x16x32_bf16 v[52:55], a[172:175], a[76:79], v[52:55]
    s_waitcnt vmcnt(15)
    s_waitcnt lgkmcnt(0)
    s_barrier
    v_mfma_f32_16x16x32_bf16 v[36:39], a[176:179], a[80:83], v[36:39]
    s_waitcnt vmcnt(14)
    ds_read_b128 v[72:75], v122 offset:0
    v_mfma_f32_16x16x32_bf16 v[36:39], a[196:199], a[84:87], v[36:39]
    buffer_load_dwordx4 a[132:135], v4, s[16:19], 0 offen offset:1024 sc1
    v_mfma_f32_16x16x32_bf16 v[40:43], a[180:183], a[80:83], v[40:43]
    ds_read_b128 v[76:79], v122 offset:16
    v_mfma_f32_16x16x32_bf16 v[40:43], a[200:203], a[84:87], v[40:43]
    buffer_load_dwordx4 a[0:3], v4, s[16:19], 0 offen offset:2048 sc1
    v_mfma_f32_16x16x32_bf16 v[44:47], a[184:187], a[80:83], v[44:47]
    ds_read_b128 v[80:83], v122 offset:5376
    v_mfma_f32_16x16x32_bf16 v[44:47], a[204:207], a[84:87], v[44:47]
    ds_read_b128 v[84:87], v122 offset:5392
    v_mfma_f32_16x16x32_bf16 v[48:51], a[188:191], a[80:83], v[48:51]
    ds_read_b128 v[88:91], v122 offset:10752
    v_mfma_f32_16x16x32_bf16 v[48:51], a[208:211], a[84:87], v[48:51]
    buffer_load_dwordx4 a[4:7], v4, s[16:19], 0 offen offset:3072 sc1
    v_mfma_f32_16x16x32_bf16 v[52:55], a[192:195], a[80:83], v[52:55]
    ds_read_b128 v[92:95], v122 offset:10768
    v_mfma_f32_16x16x32_bf16 v[52:55], a[212:215], a[84:87], v[52:55]
    s_waitcnt vmcnt(14)
    ds_read_b128 v[108:111], v122 offset:16128
    v_mfma_f32_16x16x32_bf16 v[36:39], a[216:219], a[88:91], v[36:39]
    s_waitcnt vmcnt(13)
    ds_read_b128 v[112:115], v122 offset:16144
    v_mfma_f32_16x16x32_bf16 v[36:39], v[96:99], a[92:95], v[36:39]
    v_mfma_f32_16x16x32_bf16 v[40:43], a[220:223], a[88:91], v[40:43]
    s_waitcnt lgkmcnt(6)
    v_add_f32 v72, v72, v60
    v_add_f32 v73, v73, v61
    v_mfma_f32_16x16x32_bf16 v[40:43], v[100:103], a[92:95], v[40:43]
    v_add_f32 v74, v74, v62
    v_add_f32 v75, v75, v63
    v_mfma_f32_16x16x32_bf16 v[44:47], a[224:227], a[88:91], v[44:47]
    v_add_f32 v76, v76, v64
    v_add_f32 v77, v77, v65
    v_mfma_f32_16x16x32_bf16 v[44:47], v[104:107], a[92:95], v[44:47]
    v_add_f32 v78, v78, v66
    v_add_f32 v79, v79, v67
    v_mfma_f32_16x16x32_bf16 v[48:51], a[228:231], a[88:91], v[48:51]
    s_waitcnt lgkmcnt(2)
    v_add_f32 v80, v80, v88
    v_add_f32 v81, v81, v89
    v_mfma_f32_16x16x32_bf16 v[48:51], a[232:235], a[92:95], v[48:51]
    v_add_f32 v82, v82, v90
    v_add_f32 v83, v83, v91
    v_mfma_f32_16x16x32_bf16 v[52:55], v[204:207], a[88:91], v[52:55]
    v_add_f32 v84, v84, v92
    v_add_f32 v85, v85, v93
    v_mfma_f32_16x16x32_bf16 v[52:55], a[236:239], a[92:95], v[52:55]
    s_waitcnt vmcnt(12)
    v_add_f32 v86, v86, v94
    v_add_f32 v87, v87, v95
    s_waitcnt lgkmcnt(0)
    v_add_f32 v72, v72, v108
    v_add_f32 v73, v73, v109
    v_add_f32 v74, v74, v110
    v_add_f32 v75, v75, v111
    v_add_f32 v76, v76, v112
    v_add_f32 v77, v77, v113
    v_add_f32 v78, v78, v114
    v_add_f32 v79, v79, v115
    v_add_f32 v72, v72, v80
    v_add_f32 v73, v73, v81
    v_add_f32 v74, v74, v82
    v_add_f32 v75, v75, v83
    v_add_f32 v76, v76, v84
    v_add_f32 v77, v77, v85
    v_add_f32 v78, v78, v86
    v_add_f32 v79, v79, v87
    v_cvt_pk_bf16_f32 v68, v72, v73
    v_cvt_pk_bf16_f32 v69, v74, v75
    v_cvt_pk_bf16_f32 v70, v76, v77
    v_cvt_pk_bf16_f32 v71, v78, v79
    buffer_store_dwordx4 v[68:71], v123, s[4:7], s40 offen
    s_add_u32 s40, s40, 20480
    v_mfma_f32_16x16x32_bf16 v[16:19], v[208:211], a[96:99], 0
    s_waitcnt vmcnt(12)
    v_mfma_f32_16x16x32_bf16 v[16:19], v[228:231], a[100:103], v[16:19]
    v_mfma_f32_16x16x32_bf16 v[20:23], v[212:215], a[96:99], 0
    v_mfma_f32_16x16x32_bf16 v[20:23], v[232:235], a[100:103], v[20:23]
    v_mfma_f32_16x16x32_bf16 v[24:27], v[216:219], a[96:99], 0
    v_mfma_f32_16x16x32_bf16 v[24:27], v[236:239], a[100:103], v[24:27]
    buffer_load_dword v14, v11, s[28:31], s8 offen offset:1536 sc1
    v_mfma_f32_16x16x32_bf16 v[28:31], v[220:223], a[96:99], 0
    v_mfma_f32_16x16x32_bf16 v[28:31], v[240:243], a[100:103], v[28:31]
    ds_write_b128 v121, v[36:39] offset:21504
    v_mfma_f32_16x16x32_bf16 v[32:35], v[224:227], a[96:99], 0
    v_accvgpr_read_b32 v56, a244
    v_lshlrev_b32 v60, 16, v56
    v_mfma_f32_16x16x32_bf16 v[32:35], v[244:247], a[100:103], v[32:35]
    s_waitcnt vmcnt(12)
    v_and_b32 v61, 0xffff0000, v56
    v_mfma_f32_16x16x32_bf16 v[16:19], v[248:251], a[104:107], v[16:19]
    s_waitcnt vmcnt(11)
    v_mfma_f32_16x16x32_bf16 v[16:19], v[144:147], a[108:111], v[16:19]
    ds_write_b128 v121, v[40:43] offset:21568
    v_mfma_f32_16x16x32_bf16 v[20:23], v[252:255], a[104:107], v[20:23]
    v_accvgpr_read_b32 v57, a245
    v_lshlrev_b32 v62, 16, v57
    v_mfma_f32_16x16x32_bf16 v[20:23], v[148:151], a[108:111], v[20:23]
    v_and_b32 v63, 0xffff0000, v57
    v_mfma_f32_16x16x32_bf16 v[24:27], v[132:135], a[104:107], v[24:27]
    v_mfma_f32_16x16x32_bf16 v[24:27], v[152:155], a[108:111], v[24:27]
    ds_write_b128 v121, v[44:47] offset:21632
    v_mfma_f32_16x16x32_bf16 v[28:31], v[136:139], a[104:107], v[28:31]
    v_accvgpr_read_b32 v58, a246
    v_lshlrev_b32 v64, 16, v58
    v_mfma_f32_16x16x32_bf16 v[28:31], v[156:159], a[108:111], v[28:31]
    v_and_b32 v65, 0xffff0000, v58
    v_mfma_f32_16x16x32_bf16 v[32:35], v[140:143], a[104:107], v[32:35]
    v_mfma_f32_16x16x32_bf16 v[32:35], v[160:163], a[108:111], v[32:35]
    s_waitcnt vmcnt(10)
    ds_write_b128 v121, v[48:51] offset:21696
    v_mfma_f32_16x16x32_bf16 v[16:19], v[164:167], a[112:115], v[16:19]
    s_waitcnt vmcnt(9)
    v_accvgpr_read_b32 v59, a247
    v_lshlrev_b32 v66, 16, v59
    v_mfma_f32_16x16x32_bf16 v[16:19], v[184:187], a[116:119], v[16:19]
    s_waitcnt vmcnt(0)
    v_cmp_eq_u32 vcc, 0, v14
    v_mfma_f32_16x16x32_bf16 v[20:23], v[168:171], a[112:115], v[20:23]
    v_and_b32 v67, 0xffff0000, v59
    v_mfma_f32_16x16x32_bf16 v[20:23], v[188:191], a[116:119], v[20:23]
    s_cbranch_vccnz L_a3_slow
L_a3_ok:
    s_add_u32 s16, s56, 147456
    s_addc_u32 s17, s57, 0
    buffer_load_dwordx4 a[8:11], v4, s[16:19], 0 offen offset:0 sc1
    v_mfma_f32_16x16x32_bf16 v[24:27], v[172:175], a[112:115], v[24:27]
    v_mfma_f32_16x16x32_bf16 v[24:27], v[192:195], a[116:119], v[24:27]
    buffer_load_dwordx4 a[12:15], v4, s[16:19], 0 offen offset:1024 sc1
    v_mfma_f32_16x16x32_bf16 v[28:31], v[176:179], a[112:115], v[28:31]
    v_mfma_f32_16x16x32_bf16 v[28:31], v[196:199], a[116:119], v[28:31]
    ds_write_b128 v121, v[52:55] offset:21760
    v_mfma_f32_16x16x32_bf16 v[32:35], v[180:183], a[112:115], v[32:35]
    v_mfma_f32_16x16x32_bf16 v[32:35], v[200:203], a[116:119], v[32:35]
    s_waitcnt vmcnt(10)
    buffer_load_dwordx4 a[16:19], v4, s[16:19], 0 offen offset:2048 sc1
    v_mfma_f32_16x16x32_bf16 v[16:19], a[136:139], a[120:123], v[16:19]
    s_waitcnt vmcnt(10)
    v_mfma_f32_16x16x32_bf16 v[16:19], a[156:159], a[124:127], v[16:19]
    buffer_load_dwordx4 a[20:23], v4, s[16:19], 0 offen offset:3072 sc1
    v_mfma_f32_16x16x32_bf16 v[20:23], a[140:143], a[120:123], v[20:23]
    v_mfma_f32_16x16x32_bf16 v[20:23], a[160:163], a[124:127], v[20:23]
    s_waitcnt lgkmcnt(0)
    s_barrier
    ds_read_b128 v[72:75], v122 offset:21504
    v_mfma_f32_16x16x32_bf16 v[24:27], a[144:147], a[120:123], v[24:27]
    ds_read_b128 v[76:79], v122 offset:21520
    v_mfma_f32_16x16x32_bf16 v[24:27], a[164:167], a[124:127], v[24:27]
    s_add_u32 s16, s56, 151552
    s_addc_u32 s17, s57, 0
    buffer_load_dwordx4 a[24:27], v4, s[16:19], 0 offen offset:0 sc1
    v_mfma_f32_16x16x32_bf16 v[28:31], a[148:151], a[120:123], v[28:31]
    ds_read_b128 v[80:83], v122 offset:26880
    v_mfma_f32_16x16x32_bf16 v[28:31], a[168:171], a[124:127], v[28:31]
    buffer_load_dwordx4 a[28:31], v4, s[16:19], 0 offen offset:1024 sc1
    v_mfma_f32_16x16x32_bf16 v[32:35], a[152:155], a[120:123], v[32:35]
    ds_read_b128 v[84:87], v122 offset:26896
    v_mfma_f32_16x16x32_bf16 v[32:35], a[172:175], a[124:127], v[32:35]
    s_waitcnt vmcnt(11)
    ds_read_b128 v[88:91], v122 offset:32256
    v_mfma_f32_16x16x32_bf16 v[16:19], a[176:179], a[128:131], v[16:19]
    s_waitcnt vmcnt(10)
    ds_read_b128 v[92:95], v122 offset:32272
    v_mfma_f32_16x16x32_bf16 v[16:19], a[196:199], a[132:135], v[16:19]
    buffer_load_dwordx4 a[32:35], v4, s[16:19], 0 offen offset:2048 sc1
    v_mfma_f32_16x16x32_bf16 v[20:23], a[180:183], a[128:131], v[20:23]
    ds_read_b128 v[108:111], v122 offset:37632
    v_mfma_f32_16x16x32_bf16 v[20:23], a[200:203], a[132:135], v[20:23]
    buffer_load_dwordx4 a[36:39], v4, s[16:19], 0 offen offset:3072 sc1
    v_mfma_f32_16x16x32_bf16 v[24:27], a[184:187], a[128:131], v[24:27]
    ds_read_b128 v[112:115], v122 offset:37648
    v_mfma_f32_16x16x32_bf16 v[24:27], a[204:207], a[132:135], v[24:27]
    v_mfma_f32_16x16x32_bf16 v[28:31], a[188:191], a[128:131], v[28:31]
    s_waitcnt lgkmcnt(6)
    v_add_f32 v72, v72, v60
    v_add_f32 v73, v73, v61
    v_mfma_f32_16x16x32_bf16 v[28:31], a[208:211], a[132:135], v[28:31]
    s_add_u32 s16, s56, 155648
    s_addc_u32 s17, s57, 0
    buffer_load_dwordx4 a[40:43], v4, s[16:19], 0 offen offset:0 sc1
    v_mfma_f32_16x16x32_bf16 v[32:35], a[192:195], a[128:131], v[32:35]
    v_add_f32 v74, v74, v62
    v_add_f32 v75, v75, v63
    v_mfma_f32_16x16x32_bf16 v[32:35], a[212:215], a[132:135], v[32:35]
    s_waitcnt vmcnt(12)
    buffer_load_dwordx4 a[44:47], v4, s[16:19], 0 offen offset:1024 sc1
    v_mfma_f32_16x16x32_bf16 v[16:19], a[216:219], a[0:3], v[16:19]
    s_waitcnt vmcnt(12)
    v_add_f32 v76, v76, v64
    v_add_f32 v77, v77, v65
    v_mfma_f32_16x16x32_bf16 v[16:19], v[96:99], a[4:7], v[16:19]
    v_add_f32 v78, v78, v66
    v_add_f32 v79, v79, v67
    v_mfma_f32_16x16x32_bf16 v[20:23], a[220:223], a[0:3], v[20:23]
    s_waitcnt lgkmcnt(2)
    v_add_f32 v80, v80, v88
    v_add_f32 v81, v81, v89
    v_mfma_f32_16x16x32_bf16 v[20:23], v[100:103], a[4:7], v[20:23]
    buffer_load_dwordx4 a[48:51], v4, s[16:19], 0 offen offset:2048 sc1
    v_mfma_f32_16x16x32_bf16 v[24:27], a[224:227], a[0:3], v[24:27]
    v_add_f32 v82, v82, v90
    v_add_f32 v83, v83, v91
    v_mfma_f32_16x16x32_bf16 v[24:27], v[104:107], a[4:7], v[24:27]
    buffer_load_dwordx4 a[52:55], v4, s[16:19], 0 offen offset:3072 sc1
    v_mfma_f32_16x16x32_bf16 v[28:31], a[228:231], a[0:3], v[28:31]
    v_add_f32 v84, v84, v92
    v_add_f32 v85, v85, v93
    v_mfma_f32_16x16x32_bf16 v[28:31], a[232:235], a[4:7], v[28:31]
    v_add_f32 v86, v86, v94
    v_add_f32 v87, v87, v95
    v_mfma_f32_16x16x32_bf16 v[32:35], v[204:207], a[0:3], v[32:35]
    s_waitcnt lgkmcnt(0)
    v_add_f32 v72, v72, v108
    v_add_f32 v73, v73, v109
    v_mfma_f32_16x16x32_bf16 v[32:35], a[236:239], a[4:7], v[32:35]
    s_waitcnt vmcnt(11)
    v_add_f32 v74, v74, v110
    v_add_f32 v75, v75, v111
    v_add_f32 v76, v76, v112
    v_add_f32 v77, v77, v113
    v_add_f32 v78, v78, v114
    v_add_f32 v79, v79, v115
    v_add_f32 v72, v72, v80
    v_add_f32 v73, v73, v81
    v_add_f32 v74, v74, v82
    v_add_f32 v75, v75, v83
    v_add_f32 v76, v76, v84
    v_add_f32 v77, v77, v85
    v_add_f32 v78, v78, v86
    v_add_f32 v79, v79, v87
    v_cvt_pk_bf16_f32 v68, v72, v73
    v_cvt_pk_bf16_f32 v69, v74, v75
    v_cvt_pk_bf16_f32 v70, v76, v77
    v_cvt_pk_bf16_f32 v71, v78, v79
    buffer_store_dwordx4 v[68:71], v123, s[4:7], s40 offen
    s_add_u32 s40, s40, 20480
    v_mfma_f32_16x16x32_bf16 v[36:39], v[208:211], a[8:11], 0
    s_waitcnt vmcnt(11)
    v_mfma_f32_16x16x32_bf16 v[36:39], v[228:231], a[12:15], v[36:39]
    v_mfma_f32_16x16x32_bf16 v[40:43], v[212:215], a[8:11], 0
    v_mfma_f32_16x16x32_bf16 v[40:43], v[232:235], a[12:15], v[40:43]
    v_mfma_f32_16x16x32_bf16 v[44:47], v[216:219], a[8:11], 0
    v_mfma_f32_16x16x32_bf16 v[44:47], v[236:239], a[12:15], v[44:47]
    ds_write_b128 v121, v[16:19] offset:0
    v_mfma_f32_16x16x32_bf16 v[48:51], v[220:223], a[8:11], 0
    v_accvgpr_read_b32 v56, a248
    v_lshlrev_b32 v60, 16, v56
    v_mfma_f32_16x16x32_bf16 v[48:51], v[240:243], a[12:15], v[48:51]
    v_and_b32 v61, 0xffff0000, v56
    v_mfma_f32_16x16x32_bf16 v[52:55], v[224:227], a[8:11], 0
    v_mfma_f32_16x16x32_bf16 v[52:55], v[244:247], a[12:15], v[52:55]
    s_waitcnt vmcnt(10)
    ds_write_b128 v121, v[20:23] offset:64
    v_mfma_f32_16x16x32_bf16 v[36:39], v[248:251], a[16:19], v[36:39]
    s_waitcnt vmcnt(9)
    v_accvgpr_read_b32 v57, a249
    v_lshlrev_b32 v62, 16, v57
    v_mfma_f32_16x16x32_bf16 v[36:39], v[144:147], a[20:23], v[36:39]
    v_and_b32 v63, 0xffff0000, v57
    v_mfma_f32_16x16x32_bf16 v[40:43], v[252:255], a[16:19], v[40:43]
    v_mfma_f32_16x16x32_bf16 v[40:43], v[148:151], a[20:23], v[40:43]
    ds_write_b128 v121, v[24:27] offset:128
    v_mfma_f32_16x16x32_bf16 v[44:47], v[132:135], a[16:19], v[44:47]
    v_accvgpr_read_b32 v58, a250
    v_lshlrev_b32 v64, 16, v58
    v_mfma_f32_16x16x32_bf16 v[44:47], v[152:155], a[20:23], v[44:47]
    v_and_b32 v65, 0xffff0000, v58
    v_mfma_f32_16x16x32_bf16 v[48:51], v[136:139], a[16:19], v[48:51]
    v_mfma_f32_16x16x32_bf16 v[48:51], v[156:159], a[20:23], v[48:51]
    ds_write_b128 v121, v[28:31] offset:192
    v_mfma_f32_16x16x32_bf16 v[52:55], v[140:143], a[16:19], v[52:55]
    v_accvgpr_read_b32 v59, a251
    v_lshlrev_b32 v66, 16, v59
    v_mfma_f32_16x16x32_bf16 v[52:55], v[160:163], a[20:23], v[52:55]
    s_waitcnt vmcnt(8)
    v_and_b32 v67, 0xffff0000, v59
    v_mfma_f32_16x16x32_bf16 v[36:39], v[164:167], a[24:27], v[36:39]
    s_waitcnt vmcnt(7)
    v_mfma_f32_16x16x32_bf16 v[36:39], v[184:187], a[28:31], v[36:39]
    ds_write_b128 v121, v[32:35] offset:256
    v_mfma_f32_16x16x32_bf16 v[40:43], v[168:171], a[24:27], v[40:43]
    v_mfma_f32_16x16x32_bf16 v[40:43], v[188:191], a[28:31], v[40:43]
    v_mfma_f32_16x16x32_bf16 v[44:47], v[172:175], a[24:27], v[44:47]
    v_mfma_f32_16x16x32_bf16 v[44:47], v[192:195], a[28:31], v[44:47]
    v_mfma_f32_16x16x32_bf16 v[48:51], v[176:179], a[24:27], v[48:51]
    v_mfma_f32_16x16x32_bf16 v[48:51], v[196:199], a[28:31], v[48:51]
    s_waitcnt lgkmcnt(0)
    s_barrier
    ds_read_b128 v[72:75], v122 offset:0
    v_mfma_f32_16x16x32_bf16 v[52:55], v[180:183], a[24:27], v[52:55]
    ds_read_b128 v[76:79], v122 offset:16
    v_mfma_f32_16x16x32_bf16 v[52:55], v[200:203], a[28:31], v[52:55]
    s_waitcnt vmcnt(6)
    ds_read_b128 v[80:83], v122 offset:5376
    v_mfma_f32_16x16x32_bf16 v[36:39], a[136:139], a[32:35], v[36:39]
    s_waitcnt vmcnt(5)
    ds_read_b128 v[84:87], v122 offset:5392
    v_mfma_f32_16x16x32_bf16 v[36:39], a[156:159], a[36:39], v[36:39]
    ds_read_b128 v[88:91], v122 offset:10752
    v_mfma_f32_16x16x32_bf16 v[40:43], a[140:143], a[32:35], v[40:43]
    ds_read_b128 v[92:95], v122 offset:10768
    v_mfma_f32_16x16x32_bf16 v[40:43], a[160:163], a[36:39], v[40:43]
    ds_read_b128 v[108:111], v122 offset:16128
    v_mfma_f32_16x16x32_bf16 v[44:47], a[144:147], a[32:35], v[44:47]
    ds_read_b128 v[112:115], v122 offset:16144
    v_mfma_f32_16x16x32_bf16 v[44:47], a[164:167], a[36:39], v[44:47]
    v_mfma_f32_16x16x32_bf16 v[48:51], a[148:151], a[32:35], v[48:51]
    s_waitcnt lgkmcnt(6)
    v_add_f32 v72, v72, v60
    v_add_f32 v73, v73, v61
    v_mfma_f32_16x16x32_bf16 v[48:51], a[168:171], a[36:39], v[48:51]
    v_add_f32 v74, v74, v62
    v_add_f32 v75, v75, v63
    v_mfma_f32_16x16x32_bf16 v[52:55], a[152:155], a[32:35], v[52:55]
    v_add_f32 v76, v76, v64
    v_add_f32 v77, v77, v65
    v_mfma_f32_16x16x32_bf16 v[52:55], a[172:175], a[36:39], v[52:55]
    s_waitcnt vmcnt(4)
    v_add_f32 v78, v78, v66
    v_add_f32 v79, v79, v67
    s_waitcnt vmcnt(1)
    v_mfma_f32_16x16x32_bf16 v[36:39], a[176:179], a[40:43], v[36:39]
    s_waitcnt lgkmcnt(2)
    v_add_f32 v80, v80, v88
    v_add_f32 v81, v81, v89
    v_mfma_f32_16x16x32_bf16 v[36:39], a[196:199], a[44:47], v[36:39]
    v_add_f32 v82, v82, v90
    v_add_f32 v83, v83, v91
    v_mfma_f32_16x16x32_bf16 v[36:39], a[216:219], a[48:51], v[36:39]
    v_add_f32 v84, v84, v92
    v_add_f32 v85, v85, v93
    v_mfma_f32_16x16x32_bf16 v[36:39], v[96:99], a[52:55], v[36:39]
    v_add_f32 v86, v86, v94
    v_add_f32 v87, v87, v95
    v_mfma_f32_16x16x32_bf16 v[40:43], a[180:183], a[40:43], v[40:43]
    s_waitcnt lgkmcnt(0)
    v_add_f32 v72, v72, v108
    v_add_f32 v73, v73, v109
    v_mfma_f32_16x16x32_bf16 v[40:43], a[200:203], a[44:47], v[40:43]
    v_add_f32 v74, v74, v110
    v_add_f32 v75, v75, v111
    v_mfma_f32_16x16x32_bf16 v[40:43], a[220:223], a[48:51], v[40:43]
    v_add_f32 v76, v76, v112
    v_add_f32 v77, v77, v113
    v_mfma_f32_16x16x32_bf16 v[40:43], v[100:103], a[52:55], v[40:43]
    ds_write_b128 v121, v[36:39] offset:21504
    v_mfma_f32_16x16x32_bf16 v[44:47], a[184:187], a[40:43], v[44:47]
    v_add_f32 v78, v78, v114
    v_add_f32 v79, v79, v115
    v_mfma_f32_16x16x32_bf16 v[44:47], a[204:207], a[44:47], v[44:47]
    v_add_f32 v72, v72, v80
    v_add_f32 v73, v73, v81
    v_mfma_f32_16x16x32_bf16 v[44:47], a[224:227], a[48:51], v[44:47]
    v_add_f32 v74, v74, v82
    v_add_f32 v75, v75, v83
    v_mfma_f32_16x16x32_bf16 v[44:47], v[104:107], a[52:55], v[44:47]
    ds_write_b128 v121, v[40:43] offset:21568
    v_mfma_f32_16x16x32_bf16 v[48:51], a[188:191], a[40:43], v[48:51]
    v_add_f32 v76, v76, v84
    v_add_f32 v77, v77, v85
    v_mfma_f32_16x16x32_bf16 v[48:51], a[208:211], a[44:47], v[48:51]
    v_add_f32 v78, v78, v86
    v_add_f32 v79, v79, v87
    v_mfma_f32_16x16x32_bf16 v[48:51], a[228:231], a[48:51], v[48:51]
    v_cvt_pk_bf16_f32 v68, v72, v73
    v_cvt_pk_bf16_f32 v69, v74, v75
    v_mfma_f32_16x16x32_bf16 v[48:51], a[232:235], a[52:55], v[48:51]
    ds_write_b128 v121, v[44:47] offset:21632
    v_mfma_f32_16x16x32_bf16 v[52:55], a[192:195], a[40:43], v[52:55]
    v_cvt_pk_bf16_f32 v70, v76, v77
    v_cvt_pk_bf16_f32 v71, v78, v79
    v_mfma_f32_16x16x32_bf16 v[52:55], a[212:215], a[44:47], v[52:55]
    buffer_store_dwordx4 v[68:71], v123, s[4:7], s40 offen
    v_mfma_f32_16x16x32_bf16 v[52:55], v[204:207], a[48:51], v[52:55]
    s_add_u32 s40, s40, 20480
    v_accvgpr_read_b32 v56, a252
    v_lshlrev_b32 v60, 16, v56
    v_mfma_f32_16x16x32_bf16 v[52:55], a[236:239], a[52:55], v[52:55]
    ds_write_b128 v121, v[48:51] offset:21696
    s_nop 6
    ds_write_b128 v121, v[52:55] offset:21760
    v_and_b32 v61, 0xffff0000, v56
    v_accvgpr_read_b32 v57, a253
    v_lshlrev_b32 v62, 16, v57
    v_and_b32 v63, 0xffff0000, v57
    v_accvgpr_read_b32 v58, a254
    v_lshlrev_b32 v64, 16, v58
    v_and_b32 v65, 0xffff0000, v58
    v_accvgpr_read_b32 v59, a255
    v_lshlrev_b32 v66, 16, v59
    v_and_b32 v67, 0xffff0000, v59
    s_waitcnt lgkmcnt(0)
    s_barrier
    ds_read_b128 v[72:75], v122 offset:21504
    ds_read_b128 v[76:79], v122 offset:21520
    ds_read_b128 v[80:83], v122 offset:26880
    ds_read_b128 v[84:87], v122 offset:26896
    ds_read_b128 v[88:91], v122 offset:32256
    ds_read_b128 v[92:95], v122 offset:32272
    ds_read_b128 v[108:111], v122 offset:37632
    ds_read_b128 v[112:115], v122 offset:37648
    s_waitcnt lgkmcnt(6)
    v_pk_add_f32 v[72:73], v[72:73], v[60:61]
    v_pk_add_f32 v[74:75], v[74:75], v[62:63]
    v_pk_add_f32 v[76:77], v[76:77], v[64:65]
    v_pk_add_f32 v[78:79], v[78:79], v[66:67]
    s_waitcnt lgkmcnt(2)
    v_pk_add_f32 v[80:81], v[80:81], v[88:89]
    v_pk_add_f32 v[82:83], v[82:83], v[90:91]
    v_pk_add_f32 v[84:85], v[84:85], v[92:93]
    v_pk_add_f32 v[86:87], v[86:87], v[94:95]
    s_waitcnt lgkmcnt(0)
    v_pk_add_f32 v[72:73], v[72:73], v[108:109]
    v_pk_add_f32 v[74:75], v[74:75], v[110:111]
    v_pk_add_f32 v[76:77], v[76:77], v[112:113]
    v_pk_add_f32 v[78:79], v[78:79], v[114:115]
    v_pk_add_f32 v[72:73], v[72:73], v[80:81]
    v_pk_add_f32 v[74:75], v[74:75], v[82:83]
    v_pk_add_f32 v[76:77], v[76:77], v[84:85]
    v_pk_add_f32 v[78:79], v[78:79], v[86:87]
    v_cvt_pk_bf16_f32 v68, v72, v73
    v_cvt_pk_bf16_f32 v69, v74, v75
    v_cvt_pk_bf16_f32 v70, v76, v77
    v_cvt_pk_bf16_f32 v71, v78, v79
    buffer_store_dwordx4 v[68:71], v123, s[4:7], s40 offen
    s_add_u32 s40, s40, 20480
L_end:
    s_endpgm
L_warm2_3:
    s_branch L_warm2_ret
L_cold:
L_a3_slow:
    s_mov_b32 s60, 200000
L_a3_spin:
    buffer_load_dword v14, v11, s[28:31], s8 offen offset:1536 sc1
    s_sub_u32 s60, s60, 1
    s_waitcnt vmcnt(0)
    v_cmp_eq_u32 vcc, 0, v14
    s_nop 0
    s_cmp_eq_u64 vcc, 0
    s_cbranch_scc1 L_a3_ok
    s_cmp_lg_u32 s60, 0
    s_cbranch_scc1 L_a3_spin
    s_branch L_a3_ok
L_a2_slow:
    s_mov_b32 s60, 200000
L_a2_spin:
    buffer_load_dword v14, v11, s[28:31], s8 offen offset:1024 sc1
    s_sub_u32 s60, s60, 1
    s_waitcnt vmcnt(0)
    v_cmp_eq_u32 vcc, 0, v14
    s_nop 0
    s_cmp_eq_u64 vcc, 0
    s_cbranch_scc1 L_a2_ok
    s_cmp_lg_u32 s60, 0
    s_cbranch_scc1 L_a2_spin
    s_branch L_a2_ok
L_a1_slow:
    s_mov_b32 s60, 200000
L_a1_spin:
    buffer_load_dword v14, v11, s[28:31], s8 offen offset:512 sc1
    s_sub_u32 s60, s60, 1
    s_waitcnt vmcnt(0)
    v_cmp_eq_u32 vcc, 0, v14
    s_nop 0
    s_cmp_eq_u64 vcc, 0
    s_cbranch_scc1 L_a1_ok
    s_cmp_lg_u32 s60, 0
    s_cbranch_scc1 L_a1_spin
    s_branch L_a1_ok
L_a0_slow:
    s_mov_b32 s60, 200000
L_a0_spin:
    buffer_load_dword v14, v11, s[28:31], s8 offen offset:0 sc1
    s_sub_u32 s60, s60, 1
    s_waitcnt vmcnt(0)
    v_cmp_eq_u32 vcc, 0, v14
    s_nop 0
    s_cmp_eq_u64 vcc, 0
    s_cbranch_scc1 L_a0_ok
    s_cmp_lg_u32 s60, 0
    s_cbranch_scc1 L_a0_spin
    s_branch L_a0_ok
L_w_slow:
    s_mov_b32 s60, 200000
L_w_spin:
    buffer_load_dword v12, v11, s[28:31], s8 offen offset:128 sc1
    s_sub_u32 s60, s60, 1
    s_waitcnt vmcnt(0)
    v_cmp_gt_u32 vcc, 32, v12
    s_nop 0
    s_cmp_eq_u64 vcc, 0
    s_cbranch_scc1 L_w_ok
    s_cmp_lg_u32 s60, 0
    s_cbranch_scc1 L_w_spin
    s_branch L_w_ok
L_g_slow:
    s_mov_b32 s60, 200000
L_g_spin:
    buffer_load_dword v12, v11, s[28:31], s8 offen sc1
    s_sub_u32 s60, s60, 1
    s_waitcnt vmcnt(0)
    v_cmp_gt_u32 vcc, 32, v12
    s_nop 0
    s_cmp_eq_u64 vcc, 0
    s_cbranch_scc1 L_g_ok
    s_cmp_lg_u32 s60, 0
    s_cbranch_scc1 L_g_spin
    s_branch L_g_ok
L_s0_slow:
    s_mov_b32 s60, 200000
L_s0_spin:
    buffer_load_dword v14, off, s[8:11], s43 sc1
    s_sub_u32 s60, s60, 1
    s_waitcnt vmcnt(0)
    v_cmp_gt_u32 vcc, 8, v14
    s_nop 0
    s_cmp_eq_u64 vcc, 0
    s_cbranch_scc1 L_s0_ok
    s_cmp_lg_u32 s60, 0
    s_cbranch_scc1 L_s0_spin
    s_branch L_s0_ok
L_x_slow:
    s_mov_b32 s60, 200000
L_x_spin:
    buffer_load_dword v14, v10, s[28:31], s3 offen sc1
    s_sub_u32 s60, s60, 1
    s_waitcnt vmcnt(0)
    v_cmp_eq_u32 vcc, 0, v14
    s_nop 0
    s_cmp_eq_u64 vcc, 0
    s_cbranch_scc1 L_x_ok
    s_cmp_lg_u32 s60, 0
    s_cbranch_scc1 L_x_spin
    s_branch L_x_ok
L_safe:
    s_cmp_lg_u32 s35, 0
    s_cbranch_scc1 L_norm2
    s_mov_b32 s35, 1
    s_waitcnt vmcnt(0)
    v_mov_b32 v80, 0xff800000
    v_mov_b32 v81, 0xff800000
    s_add_u32 s24, s58, 0
    s_addc_u32 s25, s59, 0
    s_mov_b32 s40, 32
L_safe0:
    buffer_load_dwordx4 v[168:171], v4, s[24:27], 0 offen
    buffer_load_dwordx4 v[172:175], v4, s[24:27], 0 offen offset:1024
    buffer_load_dwordx2 v[176:177], v5, s[24:27], 0 offen offset:2048
    s_add_u32 s24, s24, 5632
    s_addc_u32 s25, s25, 0
    s_waitcnt vmcnt(0)
    v_mfma_f32_32x32x4bf16_1k v[16:47], v[176:177], v[164:165], 0
    v_mfma_f32_32x32x4bf16_1k v[48:79], v[176:177], v[166:167], 0
    s_nop 15
    s_nop 0
    v_mfma_f32_32x32x16_bf16 v[16:31], v[168:171], v[156:159], v[16:31]
    v_mfma_f32_32x32x16_bf16 v[32:47], v[172:175], v[156:159], v[32:47]
    v_mfma_f32_32x32x16_bf16 v[48:63], v[168:171], v[160:163], v[48:63]
    v_mfma_f32_32x32x16_bf16 v[64:79], v[172:175], v[160:163], v[64:79]
    s_nop 8
    v_max3_f32 v80, v16, v17, v80
    v_max3_f32 v80, v18, v19, v80
    v_max3_f32 v80, v20, v21, v80
    v_max3_f32 v80, v22, v23, v80
    v_max3_f32 v80, v24, v25, v80
    v_max3_f32 v80, v26, v27, v80
    v_max3_f32 v80, v28, v29, v80
    v_max3_f32 v80, v30, v31, v80
    v_max3_f32 v80, v32, v33, v80
    v_max3_f32 v80, v34, v35, v80
    v_max3_f32 v80, v36, v37, v80
    v_max3_f32 v80, v38, v39, v80
    v_max3_f32 v80, v40, v41, v80
    v_max3_f32 v80, v42, v43, v80
    v_max3_f32 v80, v44, v45, v80
    v_max3_f32 v80, v46, v47, v80
    v_max3_f32 v81, v48, v49, v81
    v_max3_f32 v81, v50, v51, v81
    v_max3_f32 v81, v52, v53, v81
    v_max3_f32 v81, v54, v55, v81
    v_max3_f32 v81, v56, v57, v81
    v_max3_f32 v81, v58, v59, v81
    v_max3_f32 v81, v60, v61, v81
    v_max3_f32 v81, v62, v63, v81
    v_max3_f32 v81, v64, v65, v81
    v_max3_f32 v81, v66, v67, v81
    v_max3_f32 v81, v68, v69, v81
    v_max3_f32 v81, v70, v71, v81
    v_max3_f32 v81, v72, v73, v81
    v_max3_f32 v81, v74, v75, v81
    v_max3_f32 v81, v76, v77, v81
    v_max3_f32 v81, v78, v79, v81
    s_nop 7
    s_nop 7
    s_sub_u32 s40, s40, 1
    s_cmp_lg_u32 s40, 0
    s_cbranch_scc1 L_safe0
    v_mov_b32 v82, v80
    s_nop 1
    v_permlane32_swap_b32 v80, v82
    v_max_f32 v80, v80, v82
    v_mov_b32 v82, v81
    s_nop 1
    v_permlane32_swap_b32 v81, v82
    v_max_f32 v81, v81, v82
    v_mov_b32 v112, 0
    v_mov_b32 v113, 0
    v_mov_b32 v114, 0
    v_mov_b32 v115, 0
    v_mov_b32 v116, 0
    v_mov_b32 v117, 0
    v_mov_b32 v118, 0
    v_mov_b32 v119, 0
    v_mov_b32 v120, 0
    v_mov_b32 v121, 0
    v_mov_b32 v122, 0
    v_mov_b32 v123, 0
    v_mov_b32 v124, 0
    v_mov_b32 v125, 0
    v_mov_b32 v126, 0
    v_mov_b32 v127, 0
    v_mov_b32 v128, 0
    v_mov_b32 v129, 0
    v_mov_b32 v130, 0
    v_mov_b32 v131, 0
    v_mov_b32 v132, 0
    v_mov_b32 v133, 0
    v_mov_b32 v134, 0
    v_mov_b32 v135, 0
    v_mov_b32 v136, 0
    v_mov_b32 v137, 0
    v_mov_b32 v138, 0
    v_mov_b32 v139, 0
    v_mov_b32 v140, 0
    v_mov_b32 v141, 0
    v_mov_b32 v142, 0
    v_mov_b32 v143, 0
    s_add_u32 s24, s58, 0
    s_addc_u32 s25, s59, 0
    s_mov_b32 s40, 32
L_safe1:
    buffer_load_dwordx4 v[168:171], v4, s[24:27], 0 offen
    buffer_load_dwordx4 v[172:175], v4, s[24:27], 0 offen offset:1024
    buffer_load_dwordx2 v[176:177], v5, s[24:27], 0 offen offset:2048
    buffer_load_dwordx4 v[178:181], v6, s[24:27], 0 offen offset:0
    buffer_load_dwordx4 v[182:185], v6, s[24:27], 0 offen offset:768
    buffer_load_dwordx4 v[186:189], v6, s[24:27], 0 offen offset:1536
    buffer_load_dwordx4 v[190:193], v6, s[24:27], 0 offen offset:2304
    s_add_u32 s24, s24, 5632
    s_addc_u32 s25, s25, 0
    s_waitcnt vmcnt(0)
    v_mfma_f32_32x32x4bf16_1k v[16:47], v[176:177], v[164:165], 0
    v_mfma_f32_32x32x4bf16_1k v[48:79], v[176:177], v[166:167], 0
    s_nop 15
    s_nop 0
    v_mfma_f32_32x32x16_bf16 v[16:31], v[168:171], v[156:159], v[16:31]
    v_mfma_f32_32x32x16_bf16 v[32:47], v[172:175], v[156:159], v[32:47]
    v_mfma_f32_32x32x16_bf16 v[48:63], v[168:171], v[160:163], v[48:63]
    v_mfma_f32_32x32x16_bf16 v[64:79], v[172:175], v[160:163], v[64:79]
    s_nop 8
    v_sub_f32 v16, v16, v80
    v_sub_f32 v17, v17, v80
    v_sub_f32 v18, v18, v80
    v_sub_f32 v19, v19, v80
    v_sub_f32 v20, v20, v80
    v_sub_f32 v21, v21, v80
    v_sub_f32 v22, v22, v80
    v_sub_f32 v23, v23, v80
    v_sub_f32 v24, v24, v80
    v_sub_f32 v25, v25, v80
    v_sub_f32 v26, v26, v80
    v_sub_f32 v27, v27, v80
    v_sub_f32 v28, v28, v80
    v_sub_f32 v29, v29, v80
    v_sub_f32 v30, v30, v80
    v_sub_f32 v31, v31, v80
    v_sub_f32 v32, v32, v80
    v_sub_f32 v33, v33, v80
    v_sub_f32 v34, v34, v80
    v_sub_f32 v35, v35, v80
    v_sub_f32 v36, v36, v80
    v_sub_f32 v37, v37, v80
    v_sub_f32 v38, v38, v80
    v_sub_f32 v39, v39, v80
    v_sub_f32 v40, v40, v80
    v_sub_f32 v41, v41, v80
    v_sub_f32 v42, v42, v80
    v_sub_f32 v43, v43, v80
    v_sub_f32 v44, v44, v80
    v_sub_f32 v45, v45, v80
    v_sub_f32 v46, v46, v80
    v_sub_f32 v47, v47, v80
    v_exp_f32 v16, v16
    v_exp_f32 v17, v17
    v_exp_f32 v18, v18
    v_exp_f32 v19, v19
    v_exp_f32 v20, v20
    v_exp_f32 v21, v21
    v_exp_f32 v22, v22
    v_exp_f32 v23, v23
    v_exp_f32 v24, v24
    v_exp_f32 v25, v25
    v_exp_f32 v26, v26
    v_exp_f32 v27, v27
    v_exp_f32 v28, v28
    v_exp_f32 v29, v29
    v_exp_f32 v30, v30
    v_exp_f32 v31, v31
    v_exp_f32 v32, v32
    v_exp_f32 v33, v33
    v_exp_f32 v34, v34
    v_exp_f32 v35, v35
    v_exp_f32 v36, v36
    v_exp_f32 v37, v37
    v_exp_f32 v38, v38
    v_exp_f32 v39, v39
    v_exp_f32 v40, v40
    v_exp_f32 v41, v41
    v_exp_f32 v42, v42
    v_exp_f32 v43, v43
    v_exp_f32 v44, v44
    v_exp_f32 v45, v45
    v_exp_f32 v46, v46
    v_exp_f32 v47, v47
    v_smfmac_f32_32x32x32_bf16 v[112:127], v[178:181], v[16:23], v15
    v_smfmac_f32_32x32x32_bf16 v[112:127], v[182:185], v[24:31], v15
    v_smfmac_f32_32x32x32_bf16 v[112:127], v[186:189], v[32:39], v15
    v_smfmac_f32_32x32x32_bf16 v[112:127], v[190:193], v[40:47], v15
    v_sub_f32 v48, v48, v81
    v_sub_f32 v49, v49, v81
    v_sub_f32 v50, v50, v81
    v_sub_f32 v51, v51, v81
    v_sub_f32 v52, v52, v81
    v_sub_f32 v53, v53, v81
    v_sub_f32 v54, v54, v81
    v_sub_f32 v55, v55, v81
    v_sub_f32 v56, v56, v81
    v_sub_f32 v57, v57, v81
    v_sub_f32 v58, v58, v81
    v_sub_f32 v59, v59, v81
    v_sub_f32 v60, v60, v81
    v_sub_f32 v61, v61, v81
    v_sub_f32 v62, v62, v81
    v_sub_f32 v63, v63, v81
    v_sub_f32 v64, v64, v81
    v_sub_f32 v65, v65, v81
    v_sub_f32 v66, v66, v81
    v_sub_f32 v67, v67, v81
    v_sub_f32 v68, v68, v81
    v_sub_f32 v69, v69, v81
    v_sub_f32 v70, v70, v81
    v_sub_f32 v71, v71, v81
    v_sub_f32 v72, v72, v81
    v_sub_f32 v73, v73, v81
    v_sub_f32 v74, v74, v81
    v_sub_f32 v75, v75, v81
    v_sub_f32 v76, v76, v81
    v_sub_f32 v77, v77, v81
    v_sub_f32 v78, v78, v81
    v_sub_f32 v79, v79, v81
    v_exp_f32 v48, v48
    v_exp_f32 v49, v49
    v_exp_f32 v50, v50
    v_exp_f32 v51, v51
    v_exp_f32 v52, v52
    v_exp_f32 v53, v53
    v_exp_f32 v54, v54
    v_exp_f32 v55, v55
    v_exp_f32 v56, v56
    v_exp_f32 v57, v57
    v_exp_f32 v58, v58
    v_exp_f32 v59, v59
    v_exp_f32 v60, v60
    v_exp_f32 v61, v61
    v_exp_f32 v62, v62
    v_exp_f32 v63, v63
    v_exp_f32 v64, v64
    v_exp_f32 v65, v65
    v_exp_f32 v66, v66
    v_exp_f32 v67, v67
    v_exp_f32 v68, v68
    v_exp_f32 v69, v69
    v_exp_f32 v70, v70
    v_exp_f32 v71, v71
    v_exp_f32 v72, v72
    v_exp_f32 v73, v73
    v_exp_f32 v74, v74
    v_exp_f32 v75, v75
    v_exp_f32 v76, v76
    v_exp_f32 v77, v77
    v_exp_f32 v78, v78
    v_exp_f32 v79, v79
    v_smfmac_f32_32x32x32_bf16 v[128:143], v[178:181], v[48:55], v15
    v_smfmac_f32_32x32x32_bf16 v[128:143], v[182:185], v[56:63], v15
    v_smfmac_f32_32x32x32_bf16 v[128:143], v[186:189], v[64:71], v15
    v_smfmac_f32_32x32x32_bf16 v[128:143], v[190:193], v[72:79], v15
    s_nop 7
    s_nop 7
    s_sub_u32 s40, s40, 1
    s_cmp_lg_u32 s40, 0
    s_cbranch_scc1 L_safe1
    s_branch L_norm
L_st1_g:
    buffer_store_dword v0, v15, s[28:31], s39 offen offset:512 sc1
    s_branch L_st1_j
L_st2_g:
    buffer_store_dword v0, v15, s[28:31], s11 offen offset:256 sc1
    s_branch L_st2_j
L_st3_g:
    buffer_store_dword v0, v15, s[28:31], s39 offen offset:0 sc1
    s_branch L_st3_j
L_st4_g:
    buffer_store_dword v0, v15, s[28:31], s39 offen offset:512 sc1
    s_branch L_st4_j
L_st5_g:
    buffer_store_dword v0, v15, s[28:31], s39 offen offset:1024 sc1
    s_branch L_st5_j
L_st6_g:
    buffer_store_dword v0, v15, s[28:31], s39 offen offset:1536 sc1
    s_branch L_st6_j
.p2align 8
L_code_end:
.section .rodata,"a"
.p2align 6
.amdhsa_kernel sequential_preLN__grouped_kv_mqa__swiglu_ffn__prompt_kernel
  .amdhsa_next_free_vgpr 512
  .amdhsa_next_free_sgpr 102
  .amdhsa_accum_offset 256
  .amdhsa_group_segment_fixed_size 0
  .amdhsa_kernarg_size 96
  .amdhsa_user_sgpr_count 2
  .amdhsa_user_sgpr_kernarg_segment_ptr 1
  .amdhsa_system_sgpr_workgroup_id_x 1
.end_amdhsa_kernel
```
